```python
import torch

def _softmax(x, axis=-1):
    return torch.softmax(x, dim=axis)

def _gelu(x):
    return torch.nn.functional.gelu(x, approximate='tanh')

def _silu(x):
    return torch.nn.functional.silu(x)

def _sigmoid(x):
    return torch.sigmoid(x)

def _layernorm(x, axis=-1, eps=1e-05):
    m = x.mean(dim=axis, keepdim=True)
    v = x.var(dim=axis, keepdim=True, unbiased=False)
    return (x - m) / torch.sqrt(v + eps)

def _scatter_add(tgt, idx, src, axis=0):
    return tgt.clone().index_add_(axis, idx, src)

def _segment_sum(src, seg, n):
    out = torch.zeros((n,) + src.shape[1:], dtype=src.dtype)
    return out.index_add_(0, seg, src)

def _pad(x, pw):
    flat = tuple((v for pair in reversed(pw) for v in pair))
    return torch.nn.functional.pad(x, flat)
kernel_name = 'standalone__conformer_family_branchformer__speech'

def setup_inputs():

    _w = lambda a: (lambda t: t.to(torch.bfloat16) if t.is_floating_point() else t)(torch.as_tensor(a))
    B, T, D, K = (2, 1000, 512, 31)
    s = float(D) ** (-0.5)
    return {'x': _w((lambda *s: torch.randn(*s, dtype=torch.bfloat16) * 0.05)(B, T, D)), 'w_q': _w((lambda *s: torch.randn(*s, dtype=torch.bfloat16) * 1.6)(D, D) * s), 'w_k': _w((lambda *s: torch.randn(*s, dtype=torch.bfloat16) * 1.6)(D, D) * s), 'w_v': _w((lambda *s: torch.randn(*s, dtype=torch.bfloat16) * 0.8)(D, D) * s), 'w_ao': _w((lambda *s: torch.randn(*s, dtype=torch.bfloat16) * 0.8)(D, D) * s), 'w_up': _w((lambda *s: torch.randn(*s, dtype=torch.bfloat16) * 1.6)(D, 2 * D) * s), 'dw': _w((lambda *s: torch.randn(*s, dtype=torch.bfloat16) * 1.6)(K, D) * (1.0 / K)), 'w_dn': _w((lambda *s: torch.randn(*s, dtype=torch.bfloat16) * 0.8)(D, D) * s), 'w_merge': _w((lambda *s: torch.randn(*s, dtype=torch.bfloat16) * 0.8)(2 * D, D) * s)}

def reference(x, w_q, w_k, w_v, w_ao, w_up, dw, w_dn, w_merge):
    B, T, D = x.shape
    K = dw.shape[0]
    xa = _layernorm(x, axis=-1)
    q = torch.einsum('btd,de->bte', xa, w_q)
    k = torch.einsum('btd,de->bte', xa, w_k)
    v = torch.einsum('btd,de->bte', xa, w_v)
    logits = torch.einsum('btd,bsd->bts', q, k) * float(D) ** (-0.5)
    attn = _softmax(logits, axis=-1)
    ya = torch.einsum('bts,bsd->btd', attn, v)
    ya = torch.einsum('btd,de->bte', ya, w_ao)
    xc = _layernorm(x, axis=-1)
    h = _gelu(torch.einsum('btd,de->bte', xc, w_up))
    u = h[..., :D].clone()
    g = _layernorm(h[..., D:], axis=-1)
    pad = K // 2
    gp = _pad(g, ((0, 0), (pad, pad), (0, 0)))
    conv = torch.zeros_like(g)
    for i in range(K):
        conv = conv + gp[:, i:i + T, :] * dw[i][None, None, :]
    yc = torch.einsum('btd,de->bte', u * conv, w_dn)
    merged = torch.concatenate([ya, yc], axis=-1)
    out = torch.einsum('btf,fd->btd', merged, w_merge)
    return x + out
```

```asm
; @launch grid=(256,1,1) block=(256,1,1) lds=163840
.amdgcn_target "amdgcn-amd-amdhsa--gfx950"
.text
.globl standalone__conformer_family_branchformer__speech_kernel
.p2align 8
.type standalone__conformer_family_branchformer__speech_kernel,@function
standalone__conformer_family_branchformer__speech_kernel:
s_cmp_ge_u32 s2, 256
s_cbranch_scc1 L_EXIT_p1
s_load_dwordx16 s[4:19], s[0:1], 0
s_load_dwordx8 s[20:27], s[0:1], 64
v_and_b32 v1, 63, v0
v_lshrrev_b32 v2, 6, v0
s_nop 0
v_readfirstlane_b32 s28, v2
s_nop 3
s_lshr_b32 s29, s28, 1
s_and_b32 s30, s28, 1
s_and_b32 s80, s2, 7
s_lshr_b32 s81, s2, 3
s_lshl_b32 s82, s81, 2
s_add_u32 s82, s82, s28
s_cmp_ge_u32 s82, 21
s_cbranch_scc1 L_p1_selfwarm_done
s_getpc_b64 s[84:85]
L_p1_self_pc:
s_sub_u32 s84, s84, L_p1_self_pc-standalone__conformer_family_branchformer__speech_kernel
s_subb_u32 s85, s85, 0
s_lshl_b32 s82, s82, 10
v_lshlrev_b32 v3, 4, v1
v_add_u32 v3, s82, v3
v_min_u32 v3, L_EXIT_p1-standalone__conformer_family_branchformer__speech_kernel-16, v3
global_load_dwordx4 v[144:147], v3, s[84:85]
L_p1_selfwarm_done:
s_cmp_lt_u32 s81, 4
s_cbranch_scc1 L_p1_weights
s_sub_u32 s81, s81, 4
s_and_b32 s82, s80, 3
s_lshl_b32 s82, s82, 2
s_and_b32 s83, s81, 3
s_add_u32 s68, s82, s83
s_lshr_b32 s82, s80, 2
s_mul_i32 s82, s82, 7
s_lshr_b32 s83, s81, 2
s_add_u32 s69, s82, s83
s_cmp_lt_u32 s69, 12
s_cselect_b32 s73, 10, 11
s_mov_b32 s74, s73
s_mov_b32 s75, 11
v_lshrrev_b32 v2, 3, v1
v_lshrrev_b32 v3, 4, v1
v_and_b32 v4, 7, v1
v_xor_b32 v5, v4, v3
v_lshlrev_b32 v11, 10, v2
v_lshl_add_u32 v11, v5, 4, v11
s_lshl_b32 s80, s28, 15
v_add_u32 v11, s80, v11
v_xor_b32 v12, 64, v11
v_add_u32 v12, 0x2000, v12
v_add_u32 v13, 0x4000, v11
v_add_u32 v14, 0x4000, v12
v_and_b32 v3, 16, v1
v_lshlrev_b32 v3, 2, v3
v_lshlrev_b32 v4, 4, v4
v_xor_b32 v3, v3, v4
s_lshl_b32 s80, s28, 4
v_add_u32 v2, s80, v2
v_lshl_add_u32 v15, v2, s73, v3
s_lshl_b32 s80, 8, s73
v_add_u32 v16, s80, v15
v_lshl_add_u32 v19, v2, 11, v3
v_add_u32 v20, 0x4000, v19
s_lshl_b32 s63, s28, 12
s_lshl_b32 s64, s28, 11
s_add_u32 s64, s64, 65536
s_mov_b32 s56, 0
s_lshl_b32 s59, 64, s73
s_mov_b32 s57, 0
s_lshl_b32 s60, 64, s74
s_mov_b32 s58, 0
s_lshl_b32 s61, 64, s75
s_mov_b32 s66, -1
s_cmp_eq_u32 s28, 3
s_cselect_b32 s67, 0xff, -1
s_mul_i32 s82, s68, 128000
s_waitcnt lgkmcnt(0)
s_add_u32 s32, s4, s82
s_addc_u32 s33, s5, 0
s_and_b32 s33, s33, 0xffff
s_mov_b32 s34, 0x1f400
s_mov_b32 s35, 0x20000
s_mov_b32 s62, 0
s_add_u32 m0, s63, 0
s_nop 0
buffer_load_dwordx4 v11, s[32:35], s62 offen lds
s_add_u32 m0, s63, 1024
s_nop 0
buffer_load_dwordx4 v12, s[32:35], s62 offen lds
s_add_u32 m0, s63, 2048
s_nop 0
buffer_load_dwordx4 v13, s[32:35], s62 offen lds
s_add_u32 m0, s63, 3072
s_mov_b64 exec, s[66:67]
buffer_load_dwordx4 v14, s[32:35], s62 offen lds
s_mov_b64 exec, -1
s_cmp_ge_u32 s69, 12
s_cbranch_scc1 L_p1_setup_g
s_lshl_b32 s82, s69, 1
s_add_u32 s82, s82, 0
s_cmp_lt_u32 s82, 16
s_cselect_b64 s[84:85], s[8:9], s[10:11]
s_cmp_lt_u32 s82, 8
s_cselect_b64 s[84:85], s[6:7], s[84:85]
s_and_b32 s83, s82, 7
s_lshl_b32 s83, s83, 7
s_sub_u32 s86, 0x80000, s83
s_add_u32 s36, s84, s83
s_addc_u32 s37, s85, 0
s_and_b32 s37, s37, 0xffff
s_mov_b32 s38, s86
s_mov_b32 s39, 0x20000
s_lshl_b32 s82, s69, 1
s_add_u32 s82, s82, 1
s_cmp_lt_u32 s82, 16
s_cselect_b64 s[84:85], s[8:9], s[10:11]
s_cmp_lt_u32 s82, 8
s_cselect_b64 s[84:85], s[6:7], s[84:85]
s_and_b32 s83, s82, 7
s_lshl_b32 s83, s83, 7
s_sub_u32 s86, 0x80000, s83
s_add_u32 s40, s84, s83
s_addc_u32 s41, s85, 0
s_and_b32 s41, s41, 0xffff
s_mov_b32 s42, s86
s_mov_b32 s43, 0x20000
s_lshl_b32 s83, s69, 7
s_sub_u32 s86, 0x100000, s83
s_add_u32 s44, s14, s83
s_addc_u32 s45, s15, 0
s_and_b32 s45, s45, 0xffff
s_mov_b32 s46, s86
s_mov_b32 s47, 0x20000
s_branch L_p1_srd_done
L_p1_setup_g:
s_sub_u32 s82, s69, 12
s_lshl_b32 s82, s82, 1
s_add_u32 s82, s82, 12
s_lshl_b32 s83, s82, 7
s_sub_u32 s86, 0x100000, s83
s_add_u32 s36, s14, s83
s_addc_u32 s37, s15, 0
s_and_b32 s37, s37, 0xffff
s_mov_b32 s38, s86
s_mov_b32 s39, 0x20000
s_sub_u32 s82, s69, 12
s_lshl_b32 s82, s82, 1
s_add_u32 s82, s82, 13
s_lshl_b32 s83, s82, 7
s_sub_u32 s86, 0x100000, s83
s_add_u32 s40, s14, s83
s_addc_u32 s41, s15, 0
s_and_b32 s41, s41, 0xffff
s_mov_b32 s42, s86
s_mov_b32 s43, 0x20000
s_sub_u32 s82, s69, 12
s_lshl_b32 s82, s82, 1
s_add_u32 s82, s82, 12
s_lshl_b32 s83, s82, 7
s_sub_u32 s86, 0x100000, s83
s_add_u32 s44, s14, s83
s_addc_u32 s45, s15, 0
s_and_b32 s45, s45, 0xffff
s_mov_b32 s46, s86
s_mov_b32 s47, 0x20000
L_p1_srd_done:
s_add_u32 m0, s64, 0
s_nop 0
buffer_load_dwordx4 v15, s[36:39], s56 offen lds
s_add_u32 m0, s64, 1024
s_nop 0
buffer_load_dwordx4 v16, s[36:39], s56 offen lds
s_add_u32 s56, s56, s59
s_add_u32 m0, s64, 8192
s_nop 0
buffer_load_dwordx4 v15, s[40:43], s57 offen lds
s_add_u32 m0, s64, 9216
s_nop 0
buffer_load_dwordx4 v16, s[40:43], s57 offen lds
s_add_u32 s57, s57, s60
s_add_u32 m0, s64, 16384
s_nop 0
buffer_load_dwordx4 v19, s[44:47], s58 offen lds
s_add_u32 m0, s64, 17408
s_nop 0
buffer_load_dwordx4 v20, s[44:47], s58 offen lds
s_add_u32 s58, s58, s61
v_lshrrev_b32 v2, 3, v1
v_add_u32 v2, 125, v2
v_lshlrev_b32 v2, 7, v2
v_and_b32 v3, 7, v1
v_lshl_add_u32 v2, v3, 4, v2
s_lshl_b32 s80, s28, 14
v_add_u32 v2, s80, v2
v_mov_b32 v204, 0x3f803f80
v_mov_b32 v205, 0x3f803f80
v_mov_b32 v206, 0x3f803f80
v_mov_b32 v207, 0x3f803f80
v_cmp_gt_u32 vcc, 24, v1
s_nop 3
s_and_saveexec_b64 s[92:93], vcc
ds_write_b128 v2, v[204:207]
s_mov_b64 exec, s[92:93]
v_and_b32 v2, 31, v1
v_lshrrev_b32 v3, 1, v2
v_and_b32 v3, 7, v3
v_lshrrev_b32 v4, 5, v1
s_lshl_b32 s80, s29, 6
v_add_u32 v2, s80, v2
v_lshlrev_b32 v2, 7, v2
v_or_b32 v5, 0, v4
v_xor_b32 v5, v5, v3
v_lshl_add_u32 v21, v5, 4, v2
v_or_b32 v5, 2, v4
v_xor_b32 v5, v5, v3
v_lshl_add_u32 v22, v5, 4, v2
v_or_b32 v5, 4, v4
v_xor_b32 v5, v5, v3
v_lshl_add_u32 v23, v5, 4, v2
v_or_b32 v5, 6, v4
v_xor_b32 v5, v5, v3
v_lshl_add_u32 v24, v5, 4, v2
v_and_b32 v2, 15, v1
v_lshrrev_b32 v3, 2, v2
v_lshl_add_u32 v3, v4, 3, v3
v_lshlrev_b32 v3, 7, v3
v_and_b32 v5, 1, v2
v_lshl_add_u32 v3, v5, 3, v3
v_bfe_u32 v5, v1, 4, 1
v_lshlrev_b32 v5, 1, v5
v_bfe_u32 v4, v2, 1, 1
v_or_b32 v5, v5, v4
v_bfe_u32 v4, v2, 3, 1
v_lshlrev_b32 v4, 2, v4
v_xor_b32 v5, v5, v4
v_xor_b32 v25, 0, v5
v_lshl_add_u32 v25, v25, 4, v3
s_lshl_b32 s80, s30, 13
s_add_u32 s80, s80, 65536
v_add_u32 v25, s80, v25
v_xor_b32 v26, 0, v5
v_lshl_add_u32 v26, v26, 4, v3
s_lshl_b32 s80, s30, 13
s_add_u32 s80, s80, 114688
v_add_u32 v26, s80, v26
v_xor_b32 v27, 4, v5
v_lshl_add_u32 v27, v27, 4, v3
s_lshl_b32 s80, s30, 13
s_add_u32 s80, s80, 65536
v_add_u32 v27, s80, v27
v_xor_b32 v28, 4, v5
v_lshl_add_u32 v28, v28, 4, v3
s_lshl_b32 s80, s30, 13
s_add_u32 s80, s80, 114688
v_add_u32 v28, s80, v28
s_lshl_b32 s80, s30, 2
v_xor_b32 v29, s80, v5
v_lshl_add_u32 v29, v29, 4, v3
v_add_u32 v29, 81920, v29
s_lshl_b32 s80, s30, 2
v_xor_b32 v30, s80, v5
v_lshl_add_u32 v30, v30, 4, v3
v_add_u32 v30, 131072, v30
s_mov_b32 s62, 128
s_add_u32 m0, s63, 16384
s_nop 0
buffer_load_dwordx4 v11, s[32:35], s62 offen lds
s_add_u32 m0, s63, 17408
s_nop 0
buffer_load_dwordx4 v12, s[32:35], s62 offen lds
s_add_u32 m0, s63, 18432
s_nop 0
buffer_load_dwordx4 v13, s[32:35], s62 offen lds
s_add_u32 m0, s63, 19456
s_mov_b64 exec, s[66:67]
buffer_load_dwordx4 v14, s[32:35], s62 offen lds
s_mov_b64 exec, -1
s_add_u32 m0, s64, 24576
s_nop 0
buffer_load_dwordx4 v15, s[36:39], s56 offen lds
s_add_u32 m0, s64, 25600
s_nop 0
buffer_load_dwordx4 v16, s[36:39], s56 offen lds
s_add_u32 s56, s56, s59
s_add_u32 m0, s64, 32768
s_nop 0
buffer_load_dwordx4 v15, s[40:43], s57 offen lds
s_add_u32 m0, s64, 33792
s_nop 0
buffer_load_dwordx4 v16, s[40:43], s57 offen lds
s_add_u32 s57, s57, s60
s_add_u32 m0, s64, 40960
s_nop 0
buffer_load_dwordx4 v19, s[44:47], s58 offen lds
s_add_u32 m0, s64, 41984
s_nop 0
buffer_load_dwordx4 v20, s[44:47], s58 offen lds
s_add_u32 s58, s58, s61
s_waitcnt vmcnt(10) lgkmcnt(0)
s_barrier
ds_read_b128 v[144:147], v21 offset:0
ds_read_b64_tr_b16 v[160:161], v25 offset:0
ds_read_b64_tr_b16 v[162:163], v25 offset:512
ds_read_b128 v[148:151], v21 offset:4096
ds_read_b64_tr_b16 v[164:165], v27 offset:0
ds_read_b64_tr_b16 v[166:167], v27 offset:512
ds_read_b64_tr_b16 v[168:169], v29 offset:0
ds_read_b64_tr_b16 v[170:171], v29 offset:512
s_waitcnt lgkmcnt(0)
v_mfma_f32_32x32x16_bf16 v[48:63], v[160:163], v[144:147], 0
ds_read_b128 v[152:155], v22 offset:0
ds_read_b64_tr_b16 v[172:173], v25 offset:2048
s_mov_b32 s62, 256
v_mfma_f32_32x32x16_bf16 v[64:79], v[160:163], v[148:151], 0
ds_read_b64_tr_b16 v[174:175], v25 offset:2560
ds_read_b128 v[156:159], v22 offset:4096
v_mfma_f32_32x32x16_bf16 v[80:95], v[164:167], v[144:147], 0
ds_read_b64_tr_b16 v[176:177], v27 offset:2048
s_add_u32 m0, s63, 32768
s_nop 0
buffer_load_dwordx4 v11, s[32:35], s62 offen lds
v_mfma_f32_32x32x16_bf16 v[96:111], v[164:167], v[148:151], 0
ds_read_b64_tr_b16 v[178:179], v27 offset:2560
ds_read_b64_tr_b16 v[180:181], v29 offset:2048
v_mfma_f32_32x32x16_bf16 v[112:127], v[168:171], v[144:147], 0
ds_read_b64_tr_b16 v[182:183], v29 offset:2560
s_add_u32 m0, s63, 33792
s_nop 0
buffer_load_dwordx4 v12, s[32:35], s62 offen lds
v_mfma_f32_32x32x16_bf16 v[128:143], v[168:171], v[148:151], 0
s_waitcnt lgkmcnt(0)
v_mfma_f32_32x32x16_bf16 v[48:63], v[172:175], v[152:155], v[48:63]
ds_read_b128 v[144:147], v23 offset:0
ds_read_b64_tr_b16 v[160:161], v25 offset:4096
s_add_u32 m0, s63, 34816
s_nop 0
buffer_load_dwordx4 v13, s[32:35], s62 offen lds
v_mfma_f32_32x32x16_bf16 v[64:79], v[172:175], v[156:159], v[64:79]
ds_read_b64_tr_b16 v[162:163], v25 offset:4608
ds_read_b128 v[148:151], v23 offset:4096
s_add_u32 m0, s63, 35840
s_mov_b64 exec, s[66:67]
buffer_load_dwordx4 v14, s[32:35], s62 offen lds
s_mov_b64 exec, -1
v_mfma_f32_32x32x16_bf16 v[80:95], v[176:179], v[152:155], v[80:95]
ds_read_b64_tr_b16 v[164:165], v27 offset:4096
v_mfma_f32_32x32x16_bf16 v[96:111], v[176:179], v[156:159], v[96:111]
ds_read_b64_tr_b16 v[166:167], v27 offset:4608
ds_read_b64_tr_b16 v[168:169], v29 offset:4096
s_add_u32 m0, s64, 49152
s_nop 0
buffer_load_dwordx4 v15, s[36:39], s56 offen lds
v_mfma_f32_32x32x16_bf16 v[112:127], v[180:183], v[152:155], v[112:127]
ds_read_b64_tr_b16 v[170:171], v29 offset:4608
s_add_u32 m0, s64, 50176
s_nop 0
buffer_load_dwordx4 v16, s[36:39], s56 offen lds
v_mfma_f32_32x32x16_bf16 v[128:143], v[180:183], v[156:159], v[128:143]
s_waitcnt lgkmcnt(0)
v_mfma_f32_32x32x16_bf16 v[48:63], v[160:163], v[144:147], v[48:63]
ds_read_b128 v[152:155], v24 offset:0
ds_read_b64_tr_b16 v[172:173], v25 offset:6144
s_add_u32 s56, s56, s59
v_mfma_f32_32x32x16_bf16 v[64:79], v[160:163], v[148:151], v[64:79]
ds_read_b64_tr_b16 v[174:175], v25 offset:6656
ds_read_b128 v[156:159], v24 offset:4096
v_mfma_f32_32x32x16_bf16 v[80:95], v[164:167], v[144:147], v[80:95]
ds_read_b64_tr_b16 v[176:177], v27 offset:6144
s_add_u32 m0, s64, 57344
s_nop 0
buffer_load_dwordx4 v15, s[40:43], s57 offen lds
v_mfma_f32_32x32x16_bf16 v[96:111], v[164:167], v[148:151], v[96:111]
ds_read_b64_tr_b16 v[178:179], v27 offset:6656
ds_read_b64_tr_b16 v[180:181], v29 offset:6144
v_mfma_f32_32x32x16_bf16 v[112:127], v[168:171], v[144:147], v[112:127]
ds_read_b64_tr_b16 v[182:183], v29 offset:6656
s_add_u32 m0, s64, 58368
s_nop 0
buffer_load_dwordx4 v16, s[40:43], s57 offen lds
v_mfma_f32_32x32x16_bf16 v[128:143], v[168:171], v[148:151], v[128:143]
s_mov_b32 s48, s26
s_and_b32 s49, s27, 0xffff
s_mov_b32 s50, 0x1440000
s_mov_b32 s51, 0x20000
s_mov_b32 s52, s24
s_and_b32 s53, s25, 0xffff
s_mov_b32 s54, 0x100
s_mov_b32 s55, 0x20000
s_mul_i32 s86, s68, 14
s_add_u32 s86, s86, s69
s_lshl_b32 s86, s86, 7
s_add_u32 s87, s86, 0xb58000
s_cmp_ge_u32 s69, 12
s_cbranch_scc1 L_p1_dst_g
s_lshl_b32 s82, s69, 1
s_add_u32 s82, s82, s30
s_lshr_b32 s83, s82, 3
s_lshl_b32 s83, s83, 21
s_and_b32 s84, s82, 7
s_lshl_b32 s84, s84, 12
s_add_u32 s70, s83, s84
s_cmp_lt_u32 s82, 8
s_cselect_b32 s72, 0x3d8293ee, 1.0
s_lshl_b32 s83, s69, 1
s_add_u32 s83, s83, s30
s_mul_i32 s83, s83, 128000
s_add_u32 s71, s83, 0x600000
s_sub_u32 s83, s69, 8
s_lshl_b32 s83, s83, 1
s_add_u32 s83, s83, s30
s_lshl_b32 s83, s83, 14
s_add_u32 s76, s83, 0xb10000
s_branch L_p1_dst_done
L_p1_dst_g:
s_sub_u32 s82, s69, 12
s_lshl_b32 s82, s82, 1
s_add_u32 s82, s82, s30
s_add_u32 s82, s82, 12
s_lshl_b32 s84, s82, 1
s_mul_i32 s84, s84, 128000
s_add_u32 s70, s84, 0x600000
s_mov_b32 s71, 0
s_mov_b32 s72, 1.0
s_sub_u32 s83, s69, 12
s_lshl_b32 s83, s83, 1
s_add_u32 s83, s83, s30
s_add_u32 s83, s83, 8
s_lshl_b32 s83, s83, 14
s_add_u32 s76, s83, 0xb10000
L_p1_dst_done:
s_lshl_b32 s82, s68, 2
s_lshl_b32 s83, s29, 1
s_add_u32 s82, s82, s83
s_lshl_b32 s82, s82, 15
v_lshlrev_b32 v6, 4, v1
v_add_u32 v6, s82, v6
v_lshrrev_b32 v4, 5, v1
v_lshlrev_b32 v4, 4, v4
s_lshl_b32 s82, s30, 8
v_add_u32 v7, s82, v4
s_lshl_b32 s82, s30, 7
s_add_u32 s82, s82, 512
v_add_u32 v8, s82, v4
v_and_b32 v2, 31, v1
s_lshl_b32 s82, s29, 6
v_add_u32 v2, s82, v2
s_mul_i32 s83, s68, 125
v_add_u32 v3, 0, v2
v_cmp_gt_u32 vcc, 125, v3
v_add_u32 v5, s83, v3
v_lshlrev_b32 v5, 3, v5
v_cmp_eq_u32 s[84:85], 0, v4
s_nop 3
s_and_b64 vcc, vcc, s[84:85]
v_mov_b32 v184, 0x7ff00000
v_cndmask_b32 v184, v184, v5, vcc
v_add_u32 v3, 32, v2
v_cmp_gt_u32 vcc, 125, v3
v_add_u32 v5, s83, v3
v_lshlrev_b32 v5, 3, v5
v_cmp_eq_u32 s[84:85], 0, v4
s_nop 3
s_and_b64 vcc, vcc, s[84:85]
v_mov_b32 v185, 0x7ff00000
v_cndmask_b32 v185, v185, v5, vcc
s_lshl_b32 s82, s29, 6
s_add_u32 s84, s83, s82
s_lshl_b32 s84, s84, 6
v_lshlrev_b32 v31, 4, v1
v_add_u32 v31, s84, v31
v_lshrrev_b32 v3, 2, v1
s_add_u32 s82, s82, 48
v_add_u32 v3, s82, v3
v_cmp_gt_u32 vcc, 125, v3
v_add_u32 v5, 3072, v31
v_mov_b32 v32, 0x7ff00000
v_cndmask_b32 v32, v32, v5, vcc
s_mul_i32 s82, s28, 5120
s_add_u32 s82, s82, 4096
v_and_b32 v3, 31, v1
v_mul_u32_u24 v3, 80, v3
v_add_u32 v3, v3, v4
v_add_u32 v186, s82, v3
v_lshrrev_b32 v3, 2, v1
v_mul_u32_u24 v3, 80, v3
v_and_b32 v5, 3, v1
v_lshl_add_u32 v3, v5, 4, v3
v_add_u32 v187, s82, v3
s_lshl_b32 s82, s68, 10
s_add_u32 s82, s82, 0xb00000
v_lshlrev_b32 v10, 3, v2
v_add_u32 v10, s82, v10
s_lshl_b32 s82, s68, 2
v_mov_b32 v9, s82
v_mov_b32 v42, 1.0
v_mov_b32 v43, 1.0
v_mov_b32 v44, 0xc0135761
v_mov_b32 v45, 0xc0135761
s_mov_b32 s90, 0xbdd2d3e8
s_mov_b32 s91, 0xbdd2d3e8
s_waitcnt lgkmcnt(0)
v_mfma_f32_32x32x16_bf16 v[48:63], v[172:175], v[152:155], v[48:63]
v_mfma_f32_32x32x16_bf16 v[64:79], v[172:175], v[156:159], v[64:79]
s_waitcnt vmcnt(8)
s_barrier
v_mfma_f32_32x32x16_bf16 v[80:95], v[176:179], v[152:155], v[80:95]
ds_read_b128 v[144:147], v21 offset:16384
ds_read_b64_tr_b16 v[160:161], v25 offset:24576
ds_read_b64_tr_b16 v[162:163], v25 offset:25088
v_mfma_f32_32x32x16_bf16 v[96:111], v[176:179], v[156:159], v[96:111]
ds_read_b128 v[148:151], v21 offset:20480
ds_read_b64_tr_b16 v[164:165], v27 offset:24576
ds_read_b64_tr_b16 v[166:167], v27 offset:25088
v_mfma_f32_32x32x16_bf16 v[112:127], v[180:183], v[152:155], v[112:127]
ds_read_b64_tr_b16 v[168:169], v29 offset:24576
ds_read_b64_tr_b16 v[170:171], v29 offset:25088
s_add_u32 s57, s57, s60
v_mfma_f32_32x32x16_bf16 v[128:143], v[180:183], v[156:159], v[128:143]
s_add_u32 m0, s64, 65536
s_nop 0
buffer_load_dwordx4 v19, s[44:47], s58 offen lds
s_add_u32 m0, s64, 66560
s_nop 0
buffer_load_dwordx4 v20, s[44:47], s58 offen lds
s_add_u32 s58, s58, s61
s_waitcnt lgkmcnt(0)
v_mfma_f32_32x32x16_bf16 v[48:63], v[160:163], v[144:147], v[48:63]
ds_read_b128 v[152:155], v22 offset:16384
ds_read_b64_tr_b16 v[172:173], v25 offset:26624
s_mov_b32 s62, 384
v_mfma_f32_32x32x16_bf16 v[64:79], v[160:163], v[148:151], v[64:79]
ds_read_b64_tr_b16 v[174:175], v25 offset:27136
ds_read_b128 v[156:159], v22 offset:20480
v_mfma_f32_32x32x16_bf16 v[80:95], v[164:167], v[144:147], v[80:95]
ds_read_b64_tr_b16 v[176:177], v27 offset:26624
s_add_u32 m0, s63, 49152
s_nop 0
buffer_load_dwordx4 v11, s[32:35], s62 offen lds
v_mfma_f32_32x32x16_bf16 v[96:111], v[164:167], v[148:151], v[96:111]
ds_read_b64_tr_b16 v[178:179], v27 offset:27136
ds_read_b64_tr_b16 v[180:181], v29 offset:26624
v_mfma_f32_32x32x16_bf16 v[112:127], v[168:171], v[144:147], v[112:127]
ds_read_b64_tr_b16 v[182:183], v29 offset:27136
s_add_u32 m0, s63, 50176
s_nop 0
buffer_load_dwordx4 v12, s[32:35], s62 offen lds
v_mfma_f32_32x32x16_bf16 v[128:143], v[168:171], v[148:151], v[128:143]
s_waitcnt lgkmcnt(0)
v_mfma_f32_32x32x16_bf16 v[48:63], v[172:175], v[152:155], v[48:63]
ds_read_b128 v[144:147], v23 offset:16384
ds_read_b64_tr_b16 v[160:161], v25 offset:28672
s_add_u32 m0, s63, 51200
s_nop 0
buffer_load_dwordx4 v13, s[32:35], s62 offen lds
v_mfma_f32_32x32x16_bf16 v[64:79], v[172:175], v[156:159], v[64:79]
ds_read_b64_tr_b16 v[162:163], v25 offset:29184
ds_read_b128 v[148:151], v23 offset:20480
s_add_u32 m0, s63, 52224
s_mov_b64 exec, s[66:67]
buffer_load_dwordx4 v14, s[32:35], s62 offen lds
s_mov_b64 exec, -1
v_mfma_f32_32x32x16_bf16 v[80:95], v[176:179], v[152:155], v[80:95]
ds_read_b64_tr_b16 v[164:165], v27 offset:28672
v_mfma_f32_32x32x16_bf16 v[96:111], v[176:179], v[156:159], v[96:111]
ds_read_b64_tr_b16 v[166:167], v27 offset:29184
ds_read_b64_tr_b16 v[168:169], v29 offset:28672
s_add_u32 m0, s64, 73728
s_nop 0
buffer_load_dwordx4 v15, s[36:39], s56 offen lds
v_mfma_f32_32x32x16_bf16 v[112:127], v[180:183], v[152:155], v[112:127]
ds_read_b64_tr_b16 v[170:171], v29 offset:29184
s_add_u32 m0, s64, 74752
s_nop 0
buffer_load_dwordx4 v16, s[36:39], s56 offen lds
v_mfma_f32_32x32x16_bf16 v[128:143], v[180:183], v[156:159], v[128:143]
s_waitcnt lgkmcnt(0)
v_mfma_f32_32x32x16_bf16 v[48:63], v[160:163], v[144:147], v[48:63]
ds_read_b128 v[152:155], v24 offset:16384
ds_read_b64_tr_b16 v[172:173], v25 offset:30720
s_add_u32 s56, s56, s59
v_mfma_f32_32x32x16_bf16 v[64:79], v[160:163], v[148:151], v[64:79]
ds_read_b64_tr_b16 v[174:175], v25 offset:31232
ds_read_b128 v[156:159], v24 offset:20480
v_mfma_f32_32x32x16_bf16 v[80:95], v[164:167], v[144:147], v[80:95]
ds_read_b64_tr_b16 v[176:177], v27 offset:30720
s_add_u32 m0, s64, 81920
s_nop 0
buffer_load_dwordx4 v15, s[40:43], s57 offen lds
v_mfma_f32_32x32x16_bf16 v[96:111], v[164:167], v[148:151], v[96:111]
ds_read_b64_tr_b16 v[178:179], v27 offset:31232
ds_read_b64_tr_b16 v[180:181], v29 offset:30720
v_mfma_f32_32x32x16_bf16 v[112:127], v[168:171], v[144:147], v[112:127]
ds_read_b64_tr_b16 v[182:183], v29 offset:31232
s_add_u32 m0, s64, 82944
s_nop 0
buffer_load_dwordx4 v16, s[40:43], s57 offen lds
v_mfma_f32_32x32x16_bf16 v[128:143], v[168:171], v[148:151], v[128:143]
s_waitcnt lgkmcnt(0)
v_mfma_f32_32x32x16_bf16 v[48:63], v[172:175], v[152:155], v[48:63]
v_mfma_f32_32x32x16_bf16 v[64:79], v[172:175], v[156:159], v[64:79]
s_waitcnt vmcnt(8)
s_barrier
v_mfma_f32_32x32x16_bf16 v[80:95], v[176:179], v[152:155], v[80:95]
ds_read_b128 v[144:147], v21 offset:32768
ds_read_b64_tr_b16 v[160:161], v26 offset:0
ds_read_b64_tr_b16 v[162:163], v26 offset:512
v_mfma_f32_32x32x16_bf16 v[96:111], v[176:179], v[156:159], v[96:111]
ds_read_b128 v[148:151], v21 offset:36864
ds_read_b64_tr_b16 v[164:165], v28 offset:0
ds_read_b64_tr_b16 v[166:167], v28 offset:512
v_mfma_f32_32x32x16_bf16 v[112:127], v[180:183], v[152:155], v[112:127]
ds_read_b64_tr_b16 v[168:169], v30 offset:0
ds_read_b64_tr_b16 v[170:171], v30 offset:512
s_add_u32 s57, s57, s60
v_mfma_f32_32x32x16_bf16 v[128:143], v[180:183], v[156:159], v[128:143]
s_add_u32 m0, s64, 90112
s_nop 0
buffer_load_dwordx4 v19, s[44:47], s58 offen lds
s_add_u32 m0, s64, 91136
s_nop 0
buffer_load_dwordx4 v20, s[44:47], s58 offen lds
s_add_u32 s58, s58, s61
s_waitcnt lgkmcnt(0)
v_mfma_f32_32x32x16_bf16 v[48:63], v[160:163], v[144:147], v[48:63]
ds_read_b128 v[152:155], v22 offset:32768
ds_read_b64_tr_b16 v[172:173], v26 offset:2048
s_mov_b32 s62, 512
v_mfma_f32_32x32x16_bf16 v[64:79], v[160:163], v[148:151], v[64:79]
ds_read_b64_tr_b16 v[174:175], v26 offset:2560
ds_read_b128 v[156:159], v22 offset:36864
v_mfma_f32_32x32x16_bf16 v[80:95], v[164:167], v[144:147], v[80:95]
ds_read_b64_tr_b16 v[176:177], v28 offset:2048
s_add_u32 m0, s63, 0
s_nop 0
buffer_load_dwordx4 v11, s[32:35], s62 offen lds
v_mfma_f32_32x32x16_bf16 v[96:111], v[164:167], v[148:151], v[96:111]
ds_read_b64_tr_b16 v[178:179], v28 offset:2560
ds_read_b64_tr_b16 v[180:181], v30 offset:2048
v_mfma_f32_32x32x16_bf16 v[112:127], v[168:171], v[144:147], v[112:127]
ds_read_b64_tr_b16 v[182:183], v30 offset:2560
s_add_u32 m0, s63, 1024
s_nop 0
buffer_load_dwordx4 v12, s[32:35], s62 offen lds
v_mfma_f32_32x32x16_bf16 v[128:143], v[168:171], v[148:151], v[128:143]
s_waitcnt lgkmcnt(0)
v_mfma_f32_32x32x16_bf16 v[48:63], v[172:175], v[152:155], v[48:63]
ds_read_b128 v[144:147], v23 offset:32768
ds_read_b64_tr_b16 v[160:161], v26 offset:4096
s_add_u32 m0, s63, 2048
s_nop 0
buffer_load_dwordx4 v13, s[32:35], s62 offen lds
v_mfma_f32_32x32x16_bf16 v[64:79], v[172:175], v[156:159], v[64:79]
ds_read_b64_tr_b16 v[162:163], v26 offset:4608
ds_read_b128 v[148:151], v23 offset:36864
s_add_u32 m0, s63, 3072
s_mov_b64 exec, s[66:67]
buffer_load_dwordx4 v14, s[32:35], s62 offen lds
s_mov_b64 exec, -1
v_mfma_f32_32x32x16_bf16 v[80:95], v[176:179], v[152:155], v[80:95]
ds_read_b64_tr_b16 v[164:165], v28 offset:4096
v_mfma_f32_32x32x16_bf16 v[96:111], v[176:179], v[156:159], v[96:111]
ds_read_b64_tr_b16 v[166:167], v28 offset:4608
ds_read_b64_tr_b16 v[168:169], v30 offset:4096
s_add_u32 m0, s64, 0
s_nop 0
buffer_load_dwordx4 v15, s[36:39], s56 offen lds
v_mfma_f32_32x32x16_bf16 v[112:127], v[180:183], v[152:155], v[112:127]
ds_read_b64_tr_b16 v[170:171], v30 offset:4608
s_add_u32 m0, s64, 1024
s_nop 0
buffer_load_dwordx4 v16, s[36:39], s56 offen lds
v_mfma_f32_32x32x16_bf16 v[128:143], v[180:183], v[156:159], v[128:143]
s_waitcnt lgkmcnt(0)
v_mfma_f32_32x32x16_bf16 v[48:63], v[160:163], v[144:147], v[48:63]
ds_read_b128 v[152:155], v24 offset:32768
ds_read_b64_tr_b16 v[172:173], v26 offset:6144
s_add_u32 s56, s56, s59
v_mfma_f32_32x32x16_bf16 v[64:79], v[160:163], v[148:151], v[64:79]
ds_read_b64_tr_b16 v[174:175], v26 offset:6656
ds_read_b128 v[156:159], v24 offset:36864
v_mfma_f32_32x32x16_bf16 v[80:95], v[164:167], v[144:147], v[80:95]
ds_read_b64_tr_b16 v[176:177], v28 offset:6144
s_add_u32 m0, s64, 8192
s_nop 0
buffer_load_dwordx4 v15, s[40:43], s57 offen lds
v_mfma_f32_32x32x16_bf16 v[96:111], v[164:167], v[148:151], v[96:111]
ds_read_b64_tr_b16 v[178:179], v28 offset:6656
ds_read_b64_tr_b16 v[180:181], v30 offset:6144
v_mfma_f32_32x32x16_bf16 v[112:127], v[168:171], v[144:147], v[112:127]
ds_read_b64_tr_b16 v[182:183], v30 offset:6656
s_add_u32 m0, s64, 9216
s_nop 0
buffer_load_dwordx4 v16, s[40:43], s57 offen lds
v_mfma_f32_32x32x16_bf16 v[128:143], v[168:171], v[148:151], v[128:143]
s_waitcnt lgkmcnt(0)
v_mfma_f32_32x32x16_bf16 v[48:63], v[172:175], v[152:155], v[48:63]
v_mfma_f32_32x32x16_bf16 v[64:79], v[172:175], v[156:159], v[64:79]
s_waitcnt vmcnt(8)
s_barrier
v_mfma_f32_32x32x16_bf16 v[80:95], v[176:179], v[152:155], v[80:95]
ds_read_b128 v[144:147], v21 offset:49152
ds_read_b64_tr_b16 v[160:161], v26 offset:24576
ds_read_b64_tr_b16 v[162:163], v26 offset:25088
v_mfma_f32_32x32x16_bf16 v[96:111], v[176:179], v[156:159], v[96:111]
ds_read_b128 v[148:151], v21 offset:53248
ds_read_b64_tr_b16 v[164:165], v28 offset:24576
ds_read_b64_tr_b16 v[166:167], v28 offset:25088
v_mfma_f32_32x32x16_bf16 v[112:127], v[180:183], v[152:155], v[112:127]
ds_read_b64_tr_b16 v[168:169], v30 offset:24576
ds_read_b64_tr_b16 v[170:171], v30 offset:25088
s_add_u32 s57, s57, s60
v_mfma_f32_32x32x16_bf16 v[128:143], v[180:183], v[156:159], v[128:143]
s_add_u32 m0, s64, 16384
s_nop 0
buffer_load_dwordx4 v19, s[44:47], s58 offen lds
s_add_u32 m0, s64, 17408
s_nop 0
buffer_load_dwordx4 v20, s[44:47], s58 offen lds
s_add_u32 s58, s58, s61
s_waitcnt lgkmcnt(0)
v_mfma_f32_32x32x16_bf16 v[48:63], v[160:163], v[144:147], v[48:63]
ds_read_b128 v[152:155], v22 offset:49152
ds_read_b64_tr_b16 v[172:173], v26 offset:26624
s_mov_b32 s62, 640
v_mfma_f32_32x32x16_bf16 v[64:79], v[160:163], v[148:151], v[64:79]
ds_read_b64_tr_b16 v[174:175], v26 offset:27136
ds_read_b128 v[156:159], v22 offset:53248
v_mfma_f32_32x32x16_bf16 v[80:95], v[164:167], v[144:147], v[80:95]
ds_read_b64_tr_b16 v[176:177], v28 offset:26624
s_add_u32 m0, s63, 16384
s_nop 0
buffer_load_dwordx4 v11, s[32:35], s62 offen lds
v_mfma_f32_32x32x16_bf16 v[96:111], v[164:167], v[148:151], v[96:111]
ds_read_b64_tr_b16 v[178:179], v28 offset:27136
ds_read_b64_tr_b16 v[180:181], v30 offset:26624
v_mfma_f32_32x32x16_bf16 v[112:127], v[168:171], v[144:147], v[112:127]
ds_read_b64_tr_b16 v[182:183], v30 offset:27136
s_add_u32 m0, s63, 17408
s_nop 0
buffer_load_dwordx4 v12, s[32:35], s62 offen lds
v_mfma_f32_32x32x16_bf16 v[128:143], v[168:171], v[148:151], v[128:143]
s_waitcnt lgkmcnt(0)
v_mfma_f32_32x32x16_bf16 v[48:63], v[172:175], v[152:155], v[48:63]
ds_read_b128 v[144:147], v23 offset:49152
ds_read_b64_tr_b16 v[160:161], v26 offset:28672
s_add_u32 m0, s63, 18432
s_nop 0
buffer_load_dwordx4 v13, s[32:35], s62 offen lds
v_mfma_f32_32x32x16_bf16 v[64:79], v[172:175], v[156:159], v[64:79]
ds_read_b64_tr_b16 v[162:163], v26 offset:29184
ds_read_b128 v[148:151], v23 offset:53248
s_add_u32 m0, s63, 19456
s_mov_b64 exec, s[66:67]
buffer_load_dwordx4 v14, s[32:35], s62 offen lds
s_mov_b64 exec, -1
v_mfma_f32_32x32x16_bf16 v[80:95], v[176:179], v[152:155], v[80:95]
ds_read_b64_tr_b16 v[164:165], v28 offset:28672
v_mfma_f32_32x32x16_bf16 v[96:111], v[176:179], v[156:159], v[96:111]
ds_read_b64_tr_b16 v[166:167], v28 offset:29184
ds_read_b64_tr_b16 v[168:169], v30 offset:28672
s_add_u32 m0, s64, 24576
s_nop 0
buffer_load_dwordx4 v15, s[36:39], s56 offen lds
v_mfma_f32_32x32x16_bf16 v[112:127], v[180:183], v[152:155], v[112:127]
ds_read_b64_tr_b16 v[170:171], v30 offset:29184
s_add_u32 m0, s64, 25600
s_nop 0
buffer_load_dwordx4 v16, s[36:39], s56 offen lds
v_mfma_f32_32x32x16_bf16 v[128:143], v[180:183], v[156:159], v[128:143]
s_waitcnt lgkmcnt(0)
v_mfma_f32_32x32x16_bf16 v[48:63], v[160:163], v[144:147], v[48:63]
ds_read_b128 v[152:155], v24 offset:49152
ds_read_b64_tr_b16 v[172:173], v26 offset:30720
s_add_u32 s56, s56, s59
v_mfma_f32_32x32x16_bf16 v[64:79], v[160:163], v[148:151], v[64:79]
ds_read_b64_tr_b16 v[174:175], v26 offset:31232
ds_read_b128 v[156:159], v24 offset:53248
v_mfma_f32_32x32x16_bf16 v[80:95], v[164:167], v[144:147], v[80:95]
ds_read_b64_tr_b16 v[176:177], v28 offset:30720
s_add_u32 m0, s64, 32768
s_nop 0
buffer_load_dwordx4 v15, s[40:43], s57 offen lds
v_mfma_f32_32x32x16_bf16 v[96:111], v[164:167], v[148:151], v[96:111]
ds_read_b64_tr_b16 v[178:179], v28 offset:31232
ds_read_b64_tr_b16 v[180:181], v30 offset:30720
v_mfma_f32_32x32x16_bf16 v[112:127], v[168:171], v[144:147], v[112:127]
ds_read_b64_tr_b16 v[182:183], v30 offset:31232
s_add_u32 m0, s64, 33792
s_nop 0
buffer_load_dwordx4 v16, s[40:43], s57 offen lds
v_mfma_f32_32x32x16_bf16 v[128:143], v[168:171], v[148:151], v[128:143]
s_waitcnt lgkmcnt(0)
v_mfma_f32_32x32x16_bf16 v[48:63], v[172:175], v[152:155], v[48:63]
v_mfma_f32_32x32x16_bf16 v[64:79], v[172:175], v[156:159], v[64:79]
s_waitcnt vmcnt(8)
s_barrier
v_mfma_f32_32x32x16_bf16 v[80:95], v[176:179], v[152:155], v[80:95]
ds_read_b128 v[144:147], v21 offset:0
ds_read_b64_tr_b16 v[160:161], v25 offset:0
ds_read_b64_tr_b16 v[162:163], v25 offset:512
v_mfma_f32_32x32x16_bf16 v[96:111], v[176:179], v[156:159], v[96:111]
ds_read_b128 v[148:151], v21 offset:4096
ds_read_b64_tr_b16 v[164:165], v27 offset:0
ds_read_b64_tr_b16 v[166:167], v27 offset:512
v_mfma_f32_32x32x16_bf16 v[112:127], v[180:183], v[152:155], v[112:127]
ds_read_b64_tr_b16 v[168:169], v29 offset:0
ds_read_b64_tr_b16 v[170:171], v29 offset:512
s_add_u32 s57, s57, s60
v_mfma_f32_32x32x16_bf16 v[128:143], v[180:183], v[156:159], v[128:143]
s_add_u32 m0, s64, 40960
s_nop 0
buffer_load_dwordx4 v19, s[44:47], s58 offen lds
s_add_u32 m0, s64, 41984
s_nop 0
buffer_load_dwordx4 v20, s[44:47], s58 offen lds
s_add_u32 s58, s58, s61
s_waitcnt lgkmcnt(0)
v_mfma_f32_32x32x16_bf16 v[48:63], v[160:163], v[144:147], v[48:63]
ds_read_b128 v[152:155], v22 offset:0
ds_read_b64_tr_b16 v[172:173], v25 offset:2048
s_mov_b32 s62, 768
v_mfma_f32_32x32x16_bf16 v[64:79], v[160:163], v[148:151], v[64:79]
ds_read_b64_tr_b16 v[174:175], v25 offset:2560
ds_read_b128 v[156:159], v22 offset:4096
v_mfma_f32_32x32x16_bf16 v[80:95], v[164:167], v[144:147], v[80:95]
ds_read_b64_tr_b16 v[176:177], v27 offset:2048
s_add_u32 m0, s63, 32768
s_nop 0
buffer_load_dwordx4 v11, s[32:35], s62 offen lds
v_mfma_f32_32x32x16_bf16 v[96:111], v[164:167], v[148:151], v[96:111]
ds_read_b64_tr_b16 v[178:179], v27 offset:2560
ds_read_b64_tr_b16 v[180:181], v29 offset:2048
v_mfma_f32_32x32x16_bf16 v[112:127], v[168:171], v[144:147], v[112:127]
ds_read_b64_tr_b16 v[182:183], v29 offset:2560
s_add_u32 m0, s63, 33792
s_nop 0
buffer_load_dwordx4 v12, s[32:35], s62 offen lds
v_mfma_f32_32x32x16_bf16 v[128:143], v[168:171], v[148:151], v[128:143]
s_waitcnt lgkmcnt(0)
v_mfma_f32_32x32x16_bf16 v[48:63], v[172:175], v[152:155], v[48:63]
ds_read_b128 v[144:147], v23 offset:0
ds_read_b64_tr_b16 v[160:161], v25 offset:4096
s_add_u32 m0, s63, 34816
s_nop 0
buffer_load_dwordx4 v13, s[32:35], s62 offen lds
v_mfma_f32_32x32x16_bf16 v[64:79], v[172:175], v[156:159], v[64:79]
ds_read_b64_tr_b16 v[162:163], v25 offset:4608
ds_read_b128 v[148:151], v23 offset:4096
s_add_u32 m0, s63, 35840
s_mov_b64 exec, s[66:67]
buffer_load_dwordx4 v14, s[32:35], s62 offen lds
s_mov_b64 exec, -1
v_mfma_f32_32x32x16_bf16 v[80:95], v[176:179], v[152:155], v[80:95]
ds_read_b64_tr_b16 v[164:165], v27 offset:4096
v_mfma_f32_32x32x16_bf16 v[96:111], v[176:179], v[156:159], v[96:111]
ds_read_b64_tr_b16 v[166:167], v27 offset:4608
ds_read_b64_tr_b16 v[168:169], v29 offset:4096
s_add_u32 m0, s64, 49152
s_nop 0
buffer_load_dwordx4 v15, s[36:39], s56 offen lds
v_mfma_f32_32x32x16_bf16 v[112:127], v[180:183], v[152:155], v[112:127]
ds_read_b64_tr_b16 v[170:171], v29 offset:4608
s_add_u32 m0, s64, 50176
s_nop 0
buffer_load_dwordx4 v16, s[36:39], s56 offen lds
v_mfma_f32_32x32x16_bf16 v[128:143], v[180:183], v[156:159], v[128:143]
s_waitcnt lgkmcnt(0)
v_mfma_f32_32x32x16_bf16 v[48:63], v[160:163], v[144:147], v[48:63]
ds_read_b128 v[152:155], v24 offset:0
ds_read_b64_tr_b16 v[172:173], v25 offset:6144
s_add_u32 s56, s56, s59
v_mfma_f32_32x32x16_bf16 v[64:79], v[160:163], v[148:151], v[64:79]
ds_read_b64_tr_b16 v[174:175], v25 offset:6656
ds_read_b128 v[156:159], v24 offset:4096
v_mfma_f32_32x32x16_bf16 v[80:95], v[164:167], v[144:147], v[80:95]
ds_read_b64_tr_b16 v[176:177], v27 offset:6144
s_add_u32 m0, s64, 57344
s_nop 0
buffer_load_dwordx4 v15, s[40:43], s57 offen lds
v_mfma_f32_32x32x16_bf16 v[96:111], v[164:167], v[148:151], v[96:111]
ds_read_b64_tr_b16 v[178:179], v27 offset:6656
ds_read_b64_tr_b16 v[180:181], v29 offset:6144
v_mfma_f32_32x32x16_bf16 v[112:127], v[168:171], v[144:147], v[112:127]
ds_read_b64_tr_b16 v[182:183], v29 offset:6656
s_add_u32 m0, s64, 58368
s_nop 0
buffer_load_dwordx4 v16, s[40:43], s57 offen lds
v_mfma_f32_32x32x16_bf16 v[128:143], v[168:171], v[148:151], v[128:143]
s_waitcnt lgkmcnt(0)
v_mfma_f32_32x32x16_bf16 v[48:63], v[172:175], v[152:155], v[48:63]
v_mfma_f32_32x32x16_bf16 v[64:79], v[172:175], v[156:159], v[64:79]
s_waitcnt vmcnt(8)
s_barrier
v_mfma_f32_32x32x16_bf16 v[80:95], v[176:179], v[152:155], v[80:95]
ds_read_b128 v[144:147], v21 offset:16384
ds_read_b64_tr_b16 v[160:161], v25 offset:24576
ds_read_b64_tr_b16 v[162:163], v25 offset:25088
v_mfma_f32_32x32x16_bf16 v[96:111], v[176:179], v[156:159], v[96:111]
ds_read_b128 v[148:151], v21 offset:20480
ds_read_b64_tr_b16 v[164:165], v27 offset:24576
ds_read_b64_tr_b16 v[166:167], v27 offset:25088
v_mfma_f32_32x32x16_bf16 v[112:127], v[180:183], v[152:155], v[112:127]
ds_read_b64_tr_b16 v[168:169], v29 offset:24576
ds_read_b64_tr_b16 v[170:171], v29 offset:25088
s_add_u32 s57, s57, s60
v_mfma_f32_32x32x16_bf16 v[128:143], v[180:183], v[156:159], v[128:143]
s_add_u32 m0, s64, 65536
s_nop 0
buffer_load_dwordx4 v19, s[44:47], s58 offen lds
s_add_u32 m0, s64, 66560
s_nop 0
buffer_load_dwordx4 v20, s[44:47], s58 offen lds
s_add_u32 s58, s58, s61
s_waitcnt lgkmcnt(0)
v_mfma_f32_32x32x16_bf16 v[48:63], v[160:163], v[144:147], v[48:63]
ds_read_b128 v[152:155], v22 offset:16384
ds_read_b64_tr_b16 v[172:173], v25 offset:26624
s_mov_b32 s62, 896
v_mfma_f32_32x32x16_bf16 v[64:79], v[160:163], v[148:151], v[64:79]
ds_read_b64_tr_b16 v[174:175], v25 offset:27136
ds_read_b128 v[156:159], v22 offset:20480
v_mfma_f32_32x32x16_bf16 v[80:95], v[164:167], v[144:147], v[80:95]
ds_read_b64_tr_b16 v[176:177], v27 offset:26624
s_add_u32 m0, s63, 49152
s_nop 0
buffer_load_dwordx4 v11, s[32:35], s62 offen lds
v_mfma_f32_32x32x16_bf16 v[96:111], v[164:167], v[148:151], v[96:111]
ds_read_b64_tr_b16 v[178:179], v27 offset:27136
ds_read_b64_tr_b16 v[180:181], v29 offset:26624
v_mfma_f32_32x32x16_bf16 v[112:127], v[168:171], v[144:147], v[112:127]
ds_read_b64_tr_b16 v[182:183], v29 offset:27136
s_add_u32 m0, s63, 50176
s_nop 0
buffer_load_dwordx4 v12, s[32:35], s62 offen lds
v_mfma_f32_32x32x16_bf16 v[128:143], v[168:171], v[148:151], v[128:143]
s_waitcnt lgkmcnt(0)
v_mfma_f32_32x32x16_bf16 v[48:63], v[172:175], v[152:155], v[48:63]
ds_read_b128 v[144:147], v23 offset:16384
ds_read_b64_tr_b16 v[160:161], v25 offset:28672
s_add_u32 m0, s63, 51200
s_nop 0
buffer_load_dwordx4 v13, s[32:35], s62 offen lds
v_mfma_f32_32x32x16_bf16 v[64:79], v[172:175], v[156:159], v[64:79]
ds_read_b64_tr_b16 v[162:163], v25 offset:29184
ds_read_b128 v[148:151], v23 offset:20480
s_add_u32 m0, s63, 52224
s_mov_b64 exec, s[66:67]
buffer_load_dwordx4 v14, s[32:35], s62 offen lds
s_mov_b64 exec, -1
v_mfma_f32_32x32x16_bf16 v[80:95], v[176:179], v[152:155], v[80:95]
ds_read_b64_tr_b16 v[164:165], v27 offset:28672
v_mfma_f32_32x32x16_bf16 v[96:111], v[176:179], v[156:159], v[96:111]
ds_read_b64_tr_b16 v[166:167], v27 offset:29184
ds_read_b64_tr_b16 v[168:169], v29 offset:28672
s_add_u32 m0, s64, 73728
s_nop 0
buffer_load_dwordx4 v15, s[36:39], s56 offen lds
v_mfma_f32_32x32x16_bf16 v[112:127], v[180:183], v[152:155], v[112:127]
ds_read_b64_tr_b16 v[170:171], v29 offset:29184
s_add_u32 m0, s64, 74752
s_nop 0
buffer_load_dwordx4 v16, s[36:39], s56 offen lds
v_mfma_f32_32x32x16_bf16 v[128:143], v[180:183], v[156:159], v[128:143]
s_waitcnt lgkmcnt(0)
v_mfma_f32_32x32x16_bf16 v[48:63], v[160:163], v[144:147], v[48:63]
ds_read_b128 v[152:155], v24 offset:16384
ds_read_b64_tr_b16 v[172:173], v25 offset:30720
s_add_u32 s56, s56, s59
v_mfma_f32_32x32x16_bf16 v[64:79], v[160:163], v[148:151], v[64:79]
ds_read_b64_tr_b16 v[174:175], v25 offset:31232
ds_read_b128 v[156:159], v24 offset:20480
v_mfma_f32_32x32x16_bf16 v[80:95], v[164:167], v[144:147], v[80:95]
ds_read_b64_tr_b16 v[176:177], v27 offset:30720
s_add_u32 m0, s64, 81920
s_nop 0
buffer_load_dwordx4 v15, s[40:43], s57 offen lds
v_mfma_f32_32x32x16_bf16 v[96:111], v[164:167], v[148:151], v[96:111]
ds_read_b64_tr_b16 v[178:179], v27 offset:31232
ds_read_b64_tr_b16 v[180:181], v29 offset:30720
v_mfma_f32_32x32x16_bf16 v[112:127], v[168:171], v[144:147], v[112:127]
ds_read_b64_tr_b16 v[182:183], v29 offset:31232
s_add_u32 m0, s64, 82944
s_nop 0
buffer_load_dwordx4 v16, s[40:43], s57 offen lds
v_mfma_f32_32x32x16_bf16 v[128:143], v[168:171], v[148:151], v[128:143]
s_waitcnt lgkmcnt(0)
v_mfma_f32_32x32x16_bf16 v[48:63], v[172:175], v[152:155], v[48:63]
v_mfma_f32_32x32x16_bf16 v[64:79], v[172:175], v[156:159], v[64:79]
s_waitcnt vmcnt(8)
s_barrier
v_mfma_f32_32x32x16_bf16 v[80:95], v[176:179], v[152:155], v[80:95]
ds_read_b128 v[144:147], v21 offset:32768
ds_read_b64_tr_b16 v[160:161], v26 offset:0
ds_read_b64_tr_b16 v[162:163], v26 offset:512
v_mfma_f32_32x32x16_bf16 v[96:111], v[176:179], v[156:159], v[96:111]
ds_read_b128 v[148:151], v21 offset:36864
ds_read_b64_tr_b16 v[164:165], v28 offset:0
ds_read_b64_tr_b16 v[166:167], v28 offset:512
v_mfma_f32_32x32x16_bf16 v[112:127], v[180:183], v[152:155], v[112:127]
ds_read_b64_tr_b16 v[168:169], v30 offset:0
ds_read_b64_tr_b16 v[170:171], v30 offset:512
s_add_u32 s57, s57, s60
v_mfma_f32_32x32x16_bf16 v[128:143], v[180:183], v[156:159], v[128:143]
s_add_u32 m0, s64, 90112
s_nop 0
buffer_load_dwordx4 v19, s[44:47], s58 offen lds
s_add_u32 m0, s64, 91136
s_nop 0
buffer_load_dwordx4 v20, s[44:47], s58 offen lds
s_add_u32 s58, s58, s61
s_waitcnt lgkmcnt(0)
v_mfma_f32_32x32x16_bf16 v[48:63], v[160:163], v[144:147], v[48:63]
ds_read_b128 v[152:155], v22 offset:32768
ds_read_b64_tr_b16 v[172:173], v26 offset:2048
buffer_load_dword v2, v9, s[52:55], 0 offen sc1
v_mfma_f32_32x32x16_bf16 v[64:79], v[160:163], v[148:151], v[64:79]
ds_read_b64_tr_b16 v[174:175], v26 offset:2560
ds_read_b128 v[156:159], v22 offset:36864
v_mfma_f32_32x32x16_bf16 v[80:95], v[164:167], v[144:147], v[80:95]
ds_read_b64_tr_b16 v[176:177], v28 offset:2048
v_mfma_f32_32x32x16_bf16 v[96:111], v[164:167], v[148:151], v[96:111]
ds_read_b64_tr_b16 v[178:179], v28 offset:2560
ds_read_b64_tr_b16 v[180:181], v30 offset:2048
buffer_load_dword v4, off, s[52:55], 0 offset:128 sc1
v_mfma_f32_32x32x16_bf16 v[112:127], v[168:171], v[144:147], v[112:127]
ds_read_b64_tr_b16 v[182:183], v30 offset:2560
v_mfma_f32_32x32x16_bf16 v[128:143], v[168:171], v[148:151], v[128:143]
s_waitcnt lgkmcnt(0)
v_mfma_f32_32x32x16_bf16 v[48:63], v[172:175], v[152:155], v[48:63]
ds_read_b128 v[144:147], v23 offset:32768
ds_read_b64_tr_b16 v[160:161], v26 offset:4096
v_mfma_f32_32x32x16_bf16 v[64:79], v[172:175], v[156:159], v[64:79]
ds_read_b64_tr_b16 v[162:163], v26 offset:4608
ds_read_b128 v[148:151], v23 offset:36864
v_mfma_f32_32x32x16_bf16 v[80:95], v[176:179], v[152:155], v[80:95]
ds_read_b64_tr_b16 v[164:165], v28 offset:4096
v_mfma_f32_32x32x16_bf16 v[96:111], v[176:179], v[156:159], v[96:111]
ds_read_b64_tr_b16 v[166:167], v28 offset:4608
ds_read_b64_tr_b16 v[168:169], v30 offset:4096
v_mfma_f32_32x32x16_bf16 v[112:127], v[180:183], v[152:155], v[112:127]
ds_read_b64_tr_b16 v[170:171], v30 offset:4608
v_mfma_f32_32x32x16_bf16 v[128:143], v[180:183], v[156:159], v[128:143]
s_waitcnt lgkmcnt(0)
v_mfma_f32_32x32x16_bf16 v[48:63], v[160:163], v[144:147], v[48:63]
ds_read_b128 v[152:155], v24 offset:32768
ds_read_b64_tr_b16 v[172:173], v26 offset:6144
v_mfma_f32_32x32x16_bf16 v[64:79], v[160:163], v[148:151], v[64:79]
ds_read_b64_tr_b16 v[174:175], v26 offset:6656
ds_read_b128 v[156:159], v24 offset:36864
v_mfma_f32_32x32x16_bf16 v[80:95], v[164:167], v[144:147], v[80:95]
ds_read_b64_tr_b16 v[176:177], v28 offset:6144
v_mfma_f32_32x32x16_bf16 v[96:111], v[164:167], v[148:151], v[96:111]
ds_read_b64_tr_b16 v[178:179], v28 offset:6656
ds_read_b64_tr_b16 v[180:181], v30 offset:6144
v_mfma_f32_32x32x16_bf16 v[112:127], v[168:171], v[144:147], v[112:127]
ds_read_b64_tr_b16 v[182:183], v30 offset:6656
v_mfma_f32_32x32x16_bf16 v[128:143], v[168:171], v[148:151], v[128:143]
s_waitcnt lgkmcnt(0)
v_mfma_f32_32x32x16_bf16 v[48:63], v[172:175], v[152:155], v[48:63]
v_mfma_f32_32x32x16_bf16 v[64:79], v[172:175], v[156:159], v[64:79]
s_waitcnt vmcnt(2)
s_barrier
v_mfma_f32_32x32x16_bf16 v[80:95], v[176:179], v[152:155], v[80:95]
ds_read_b128 v[144:147], v21 offset:49152
ds_read_b64_tr_b16 v[160:161], v26 offset:24576
v_mfma_f32_32x32x16_bf16 v[96:111], v[176:179], v[156:159], v[96:111]
ds_read_b64_tr_b16 v[162:163], v26 offset:25088
ds_read_b128 v[148:151], v21 offset:53248
v_mfma_f32_32x32x16_bf16 v[112:127], v[180:183], v[152:155], v[112:127]
ds_read_b64_tr_b16 v[164:165], v28 offset:24576
ds_read_b64_tr_b16 v[166:167], v28 offset:25088
v_mfma_f32_32x32x16_bf16 v[128:143], v[180:183], v[156:159], v[128:143]
ds_read_b64_tr_b16 v[168:169], v30 offset:24576
ds_read_b64_tr_b16 v[170:171], v30 offset:25088
s_waitcnt lgkmcnt(0)
v_mfma_f32_32x32x16_bf16 v[48:63], v[160:163], v[144:147], v[48:63]
ds_read_b128 v[152:155], v22 offset:49152
ds_read_b64_tr_b16 v[172:173], v26 offset:26624
v_mfma_f32_32x32x16_bf16 v[64:79], v[160:163], v[148:151], v[64:79]
ds_read_b64_tr_b16 v[174:175], v26 offset:27136
ds_read_b128 v[156:159], v22 offset:53248
v_mfma_f32_32x32x16_bf16 v[80:95], v[164:167], v[144:147], v[80:95]
ds_read_b64_tr_b16 v[176:177], v28 offset:26624
v_mfma_f32_32x32x16_bf16 v[96:111], v[164:167], v[148:151], v[96:111]
ds_read_b64_tr_b16 v[178:179], v28 offset:27136
ds_read_b64_tr_b16 v[180:181], v30 offset:26624
v_mfma_f32_32x32x16_bf16 v[112:127], v[168:171], v[144:147], v[112:127]
ds_read_b64_tr_b16 v[182:183], v30 offset:27136
v_mfma_f32_32x32x16_bf16 v[128:143], v[168:171], v[148:151], v[128:143]
s_waitcnt vmcnt(0)
v_readfirstlane_b32 s81, v2
v_readfirstlane_b32 s82, v4
s_nop 3
s_cmp_lt_u32 s81, 2
s_cbranch_scc1 L_p1_polln_3a
s_cmp_lt_u32 s82, 32
s_cbranch_scc1 L_p1_polln_3a
s_branch L_p1_pollok_2
L_p1_polln_3a:
s_mov_b32 s79, 0x100000
L_p1_poll_1:
s_sleep 4
buffer_load_dword v2, v9, s[52:55], 0 offen sc1
buffer_load_dword v4, off, s[52:55], 0 offset:128 sc1
s_waitcnt vmcnt(0)
v_readfirstlane_b32 s81, v2
v_readfirstlane_b32 s82, v4
s_nop 3
s_cmp_lt_u32 s81, 2
s_cbranch_scc1 L_p1_polln_3b
s_cmp_lt_u32 s82, 32
s_cbranch_scc1 L_p1_polln_3b
s_branch L_p1_pollok_2
L_p1_polln_3b:
s_sub_u32 s79, s79, 1
s_cmp_eq_u32 s79, 0
s_cbranch_scc0 L_p1_poll_1
L_p1_pollok_2:
buffer_load_dwordx2 v[34:35], v10, s[48:51], 0 offen sc1
buffer_load_dwordx2 v[36:37], v10, s[48:51], 0 offen offset:256 sc1
s_waitcnt lgkmcnt(0)
v_mfma_f32_32x32x16_bf16 v[48:63], v[172:175], v[152:155], v[48:63]
ds_read_b128 v[144:147], v23 offset:49152
ds_read_b64_tr_b16 v[160:161], v26 offset:28672
v_mfma_f32_32x32x16_bf16 v[64:79], v[172:175], v[156:159], v[64:79]
ds_read_b64_tr_b16 v[162:163], v26 offset:29184
ds_read_b128 v[148:151], v23 offset:53248
v_mfma_f32_32x32x16_bf16 v[80:95], v[176:179], v[152:155], v[80:95]
ds_read_b64_tr_b16 v[164:165], v28 offset:28672
v_mfma_f32_32x32x16_bf16 v[96:111], v[176:179], v[156:159], v[96:111]
ds_read_b64_tr_b16 v[166:167], v28 offset:29184
ds_read_b64_tr_b16 v[168:169], v30 offset:28672
v_mfma_f32_32x32x16_bf16 v[112:127], v[180:183], v[152:155], v[112:127]
ds_read_b64_tr_b16 v[170:171], v30 offset:29184
v_mfma_f32_32x32x16_bf16 v[128:143], v[180:183], v[156:159], v[128:143]
s_lshr_b32 s82, s2, 3
s_sub_u32 s82, s82, 4
s_lshl_b32 s82, s82, 2
s_add_u32 s82, s82, s28
v_lshlrev_b32 v3, 4, v1
s_cmp_ge_u32 s82, 28
s_cbranch_scc1 L_p1_warm_dw
s_getpc_b64 s[84:85]
L_p1_warm_pc:
s_add_u32 s84, s84, L_p2_start-L_p1_warm_pc
s_addc_u32 s85, s85, 0
s_lshl_b32 s82, s82, 10
v_add_u32 v3, s82, v3
v_min_u32 v3, L_EXIT_p2-L_p2_start-16, v3
global_load_dwordx4 v[236:239], v3, s[84:85]
s_branch L_p1_warm_done
L_p1_warm_dw:
s_sub_u32 s82, s82, 28
s_lshl_b32 s82, s82, 10
v_add_u32 v3, s82, v3
v_min_u32 v3, 31728, v3
global_load_dwordx4 v[236:239], v3, s[16:17]
L_p1_warm_done:
s_waitcnt lgkmcnt(0)
v_mfma_f32_32x32x16_bf16 v[48:63], v[160:163], v[144:147], v[48:63]
ds_read_b128 v[152:155], v24 offset:49152
ds_read_b64_tr_b16 v[172:173], v26 offset:30720
v_mfma_f32_32x32x16_bf16 v[64:79], v[160:163], v[148:151], v[64:79]
ds_read_b64_tr_b16 v[174:175], v26 offset:31232
ds_read_b128 v[156:159], v24 offset:53248
v_mfma_f32_32x32x16_bf16 v[80:95], v[164:167], v[144:147], v[80:95]
ds_read_b64_tr_b16 v[176:177], v28 offset:30720
v_mfma_f32_32x32x16_bf16 v[96:111], v[164:167], v[148:151], v[96:111]
ds_read_b64_tr_b16 v[178:179], v28 offset:31232
ds_read_b64_tr_b16 v[180:181], v30 offset:30720
v_mfma_f32_32x32x16_bf16 v[112:127], v[168:171], v[144:147], v[112:127]
ds_read_b64_tr_b16 v[182:183], v30 offset:31232
v_mfma_f32_32x32x16_bf16 v[128:143], v[168:171], v[148:151], v[128:143]
s_waitcnt lgkmcnt(0)
v_mfma_f32_32x32x16_bf16 v[48:63], v[172:175], v[152:155], v[48:63]
v_mfma_f32_32x32x16_bf16 v[64:79], v[172:175], v[156:159], v[64:79]
v_mfma_f32_32x32x16_bf16 v[80:95], v[176:179], v[152:155], v[80:95]
v_mfma_f32_32x32x16_bf16 v[96:111], v[176:179], v[156:159], v[96:111]
v_mfma_f32_32x32x16_bf16 v[112:127], v[180:183], v[152:155], v[112:127]
v_mfma_f32_32x32x16_bf16 v[128:143], v[180:183], v[156:159], v[128:143]
s_cmp_eq_u32 s29, 0
s_cbranch_scc1 L_p1_nocs
s_mov_b32 exec_lo, 0x20000000
s_mov_b32 exec_hi, 0x20000000
s_nop 7
ds_write_b128 v7, v[64:67] offset:0
ds_write_b128 v7, v[68:71] offset:32
ds_write_b128 v7, v[72:75] offset:64
ds_write_b128 v7, v[76:79] offset:96
ds_write_b128 v7, v[96:99] offset:128
ds_write_b128 v7, v[100:103] offset:160
ds_write_b128 v7, v[104:107] offset:192
ds_write_b128 v7, v[108:111] offset:224
ds_write_b128 v8, v[128:131] offset:0
ds_write_b128 v8, v[132:135] offset:32
ds_write_b128 v8, v[136:139] offset:64
ds_write_b128 v8, v[140:143] offset:96
s_mov_b64 exec, -1
L_p1_nocs:
s_waitcnt lgkmcnt(0)
s_barrier
s_waitcnt vmcnt(1)
v_pk_mul_f32 v[38:39], v[34:35], s[72:73] op_sel_hi:[1,0]
v_pk_mul_f32 v[40:41], v[36:37], s[72:73] op_sel_hi:[1,0]
s_cmp_ge_u32 s69, 12
s_cbranch_scc1 L_p1_epi_g
ds_read_b128 v[188:191], v7 offset:0
ds_read_b128 v[192:195], v7 offset:32
ds_read_b128 v[196:199], v7 offset:64
ds_read_b128 v[200:203], v7 offset:96
ds_read_b128 v[204:207], v7 offset:128
ds_read_b128 v[208:211], v7 offset:160
ds_read_b128 v[212:215], v7 offset:192
ds_read_b128 v[216:219], v7 offset:224
s_waitcnt lgkmcnt(4)
v_pk_mul_f32 v[48:49], v[48:49], v[38:39] op_sel:[0,0] op_sel_hi:[1,0]
v_pk_mul_f32 v[50:51], v[50:51], v[38:39] op_sel:[0,0] op_sel_hi:[1,0]
v_pk_mul_f32 v[52:53], v[52:53], v[38:39] op_sel:[0,0] op_sel_hi:[1,0]
v_pk_mul_f32 v[54:55], v[54:55], v[38:39] op_sel:[0,0] op_sel_hi:[1,0]
v_pk_mul_f32 v[56:57], v[56:57], v[38:39] op_sel:[0,0] op_sel_hi:[1,0]
v_pk_mul_f32 v[58:59], v[58:59], v[38:39] op_sel:[0,0] op_sel_hi:[1,0]
v_pk_mul_f32 v[60:61], v[60:61], v[38:39] op_sel:[0,0] op_sel_hi:[1,0]
v_pk_mul_f32 v[62:63], v[62:63], v[38:39] op_sel:[0,0] op_sel_hi:[1,0]
v_pk_fma_f32 v[48:49], v[188:189], v[38:39], v[48:49] op_sel:[0,1,0] op_sel_hi:[1,1,1]
v_pk_fma_f32 v[50:51], v[190:191], v[38:39], v[50:51] op_sel:[0,1,0] op_sel_hi:[1,1,1]
v_pk_fma_f32 v[52:53], v[192:193], v[38:39], v[52:53] op_sel:[0,1,0] op_sel_hi:[1,1,1]
v_pk_fma_f32 v[54:55], v[194:195], v[38:39], v[54:55] op_sel:[0,1,0] op_sel_hi:[1,1,1]
v_pk_fma_f32 v[56:57], v[196:197], v[38:39], v[56:57] op_sel:[0,1,0] op_sel_hi:[1,1,1]
v_pk_fma_f32 v[58:59], v[198:199], v[38:39], v[58:59] op_sel:[0,1,0] op_sel_hi:[1,1,1]
v_pk_fma_f32 v[60:61], v[200:201], v[38:39], v[60:61] op_sel:[0,1,0] op_sel_hi:[1,1,1]
v_pk_fma_f32 v[62:63], v[202:203], v[38:39], v[62:63] op_sel:[0,1,0] op_sel_hi:[1,1,1]
v_cvt_pk_bf16_f32 v144, v48, v49
v_cvt_pk_bf16_f32 v145, v50, v51
v_cvt_pk_bf16_f32 v146, v52, v53
v_cvt_pk_bf16_f32 v147, v54, v55
v_cvt_pk_bf16_f32 v148, v56, v57
v_cvt_pk_bf16_f32 v149, v58, v59
v_cvt_pk_bf16_f32 v150, v60, v61
v_cvt_pk_bf16_f32 v151, v62, v63
s_add_u32 s82, s70, 0
buffer_store_dwordx4 v[144:147], v6, s[48:51], s82 offen offset:0 sc1
s_add_u32 s82, s70, 0
buffer_store_dwordx4 v[148:151], v6, s[48:51], s82 offen offset:1024 sc1
v_pk_mul_f32 v[64:65], v[64:65], v[40:41] op_sel:[0,0] op_sel_hi:[1,0]
v_pk_mul_f32 v[66:67], v[66:67], v[40:41] op_sel:[0,0] op_sel_hi:[1,0]
v_pk_mul_f32 v[68:69], v[68:69], v[40:41] op_sel:[0,0] op_sel_hi:[1,0]
v_pk_mul_f32 v[70:71], v[70:71], v[40:41] op_sel:[0,0] op_sel_hi:[1,0]
v_pk_mul_f32 v[72:73], v[72:73], v[40:41] op_sel:[0,0] op_sel_hi:[1,0]
v_pk_mul_f32 v[74:75], v[74:75], v[40:41] op_sel:[0,0] op_sel_hi:[1,0]
v_pk_mul_f32 v[76:77], v[76:77], v[40:41] op_sel:[0,0] op_sel_hi:[1,0]
v_pk_mul_f32 v[78:79], v[78:79], v[40:41] op_sel:[0,0] op_sel_hi:[1,0]
v_pk_fma_f32 v[64:65], v[188:189], v[40:41], v[64:65] op_sel:[0,1,0] op_sel_hi:[1,1,1]
v_pk_fma_f32 v[66:67], v[190:191], v[40:41], v[66:67] op_sel:[0,1,0] op_sel_hi:[1,1,1]
v_pk_fma_f32 v[68:69], v[192:193], v[40:41], v[68:69] op_sel:[0,1,0] op_sel_hi:[1,1,1]
v_pk_fma_f32 v[70:71], v[194:195], v[40:41], v[70:71] op_sel:[0,1,0] op_sel_hi:[1,1,1]
v_pk_fma_f32 v[72:73], v[196:197], v[40:41], v[72:73] op_sel:[0,1,0] op_sel_hi:[1,1,1]
v_pk_fma_f32 v[74:75], v[198:199], v[40:41], v[74:75] op_sel:[0,1,0] op_sel_hi:[1,1,1]
v_pk_fma_f32 v[76:77], v[200:201], v[40:41], v[76:77] op_sel:[0,1,0] op_sel_hi:[1,1,1]
v_pk_fma_f32 v[78:79], v[202:203], v[40:41], v[78:79] op_sel:[0,1,0] op_sel_hi:[1,1,1]
v_cvt_pk_bf16_f32 v152, v64, v65
v_cvt_pk_bf16_f32 v153, v66, v67
v_cvt_pk_bf16_f32 v154, v68, v69
v_cvt_pk_bf16_f32 v155, v70, v71
v_cvt_pk_bf16_f32 v156, v72, v73
v_cvt_pk_bf16_f32 v157, v74, v75
v_cvt_pk_bf16_f32 v158, v76, v77
v_cvt_pk_bf16_f32 v159, v78, v79
s_add_u32 s82, s70, 32768
buffer_store_dwordx4 v[152:155], v6, s[48:51], s82 offen offset:0 sc1
s_add_u32 s82, s70, 32768
buffer_store_dwordx4 v[156:159], v6, s[48:51], s82 offen offset:1024 sc1
ds_read_b128 v[188:191], v8 offset:0
ds_read_b128 v[192:195], v8 offset:32
ds_read_b128 v[196:199], v8 offset:64
ds_read_b128 v[200:203], v8 offset:96
s_waitcnt lgkmcnt(4)
v_pk_mul_f32 v[80:81], v[80:81], v[38:39] op_sel:[0,0] op_sel_hi:[1,0]
v_pk_mul_f32 v[82:83], v[82:83], v[38:39] op_sel:[0,0] op_sel_hi:[1,0]
v_pk_mul_f32 v[84:85], v[84:85], v[38:39] op_sel:[0,0] op_sel_hi:[1,0]
v_pk_mul_f32 v[86:87], v[86:87], v[38:39] op_sel:[0,0] op_sel_hi:[1,0]
v_pk_mul_f32 v[88:89], v[88:89], v[38:39] op_sel:[0,0] op_sel_hi:[1,0]
v_pk_mul_f32 v[90:91], v[90:91], v[38:39] op_sel:[0,0] op_sel_hi:[1,0]
v_pk_mul_f32 v[92:93], v[92:93], v[38:39] op_sel:[0,0] op_sel_hi:[1,0]
v_pk_mul_f32 v[94:95], v[94:95], v[38:39] op_sel:[0,0] op_sel_hi:[1,0]
v_pk_fma_f32 v[80:81], v[204:205], v[38:39], v[80:81] op_sel:[0,1,0] op_sel_hi:[1,1,1]
v_pk_fma_f32 v[82:83], v[206:207], v[38:39], v[82:83] op_sel:[0,1,0] op_sel_hi:[1,1,1]
v_pk_fma_f32 v[84:85], v[208:209], v[38:39], v[84:85] op_sel:[0,1,0] op_sel_hi:[1,1,1]
v_pk_fma_f32 v[86:87], v[210:211], v[38:39], v[86:87] op_sel:[0,1,0] op_sel_hi:[1,1,1]
v_pk_fma_f32 v[88:89], v[212:213], v[38:39], v[88:89] op_sel:[0,1,0] op_sel_hi:[1,1,1]
v_pk_fma_f32 v[90:91], v[214:215], v[38:39], v[90:91] op_sel:[0,1,0] op_sel_hi:[1,1,1]
v_pk_fma_f32 v[92:93], v[216:217], v[38:39], v[92:93] op_sel:[0,1,0] op_sel_hi:[1,1,1]
v_pk_fma_f32 v[94:95], v[218:219], v[38:39], v[94:95] op_sel:[0,1,0] op_sel_hi:[1,1,1]
v_cvt_pk_bf16_f32 v160, v80, v81
v_cvt_pk_bf16_f32 v161, v82, v83
v_cvt_pk_bf16_f32 v162, v84, v85
v_cvt_pk_bf16_f32 v163, v86, v87
v_cvt_pk_bf16_f32 v164, v88, v89
v_cvt_pk_bf16_f32 v165, v90, v91
v_cvt_pk_bf16_f32 v166, v92, v93
v_cvt_pk_bf16_f32 v167, v94, v95
s_add_u32 s82, s70, 2048
buffer_store_dwordx4 v[160:163], v6, s[48:51], s82 offen offset:0 sc1
s_add_u32 s82, s70, 2048
buffer_store_dwordx4 v[164:167], v6, s[48:51], s82 offen offset:1024 sc1
v_pk_mul_f32 v[96:97], v[96:97], v[40:41] op_sel:[0,0] op_sel_hi:[1,0]
v_pk_mul_f32 v[98:99], v[98:99], v[40:41] op_sel:[0,0] op_sel_hi:[1,0]
v_pk_mul_f32 v[100:101], v[100:101], v[40:41] op_sel:[0,0] op_sel_hi:[1,0]
v_pk_mul_f32 v[102:103], v[102:103], v[40:41] op_sel:[0,0] op_sel_hi:[1,0]
v_pk_mul_f32 v[104:105], v[104:105], v[40:41] op_sel:[0,0] op_sel_hi:[1,0]
v_pk_mul_f32 v[106:107], v[106:107], v[40:41] op_sel:[0,0] op_sel_hi:[1,0]
v_pk_mul_f32 v[108:109], v[108:109], v[40:41] op_sel:[0,0] op_sel_hi:[1,0]
v_pk_mul_f32 v[110:111], v[110:111], v[40:41] op_sel:[0,0] op_sel_hi:[1,0]
v_pk_fma_f32 v[96:97], v[204:205], v[40:41], v[96:97] op_sel:[0,1,0] op_sel_hi:[1,1,1]
v_pk_fma_f32 v[98:99], v[206:207], v[40:41], v[98:99] op_sel:[0,1,0] op_sel_hi:[1,1,1]
v_pk_fma_f32 v[100:101], v[208:209], v[40:41], v[100:101] op_sel:[0,1,0] op_sel_hi:[1,1,1]
v_pk_fma_f32 v[102:103], v[210:211], v[40:41], v[102:103] op_sel:[0,1,0] op_sel_hi:[1,1,1]
v_pk_fma_f32 v[104:105], v[212:213], v[40:41], v[104:105] op_sel:[0,1,0] op_sel_hi:[1,1,1]
v_pk_fma_f32 v[106:107], v[214:215], v[40:41], v[106:107] op_sel:[0,1,0] op_sel_hi:[1,1,1]
v_pk_fma_f32 v[108:109], v[216:217], v[40:41], v[108:109] op_sel:[0,1,0] op_sel_hi:[1,1,1]
v_pk_fma_f32 v[110:111], v[218:219], v[40:41], v[110:111] op_sel:[0,1,0] op_sel_hi:[1,1,1]
v_cvt_pk_bf16_f32 v168, v96, v97
v_cvt_pk_bf16_f32 v169, v98, v99
v_cvt_pk_bf16_f32 v170, v100, v101
v_cvt_pk_bf16_f32 v171, v102, v103
v_cvt_pk_bf16_f32 v172, v104, v105
v_cvt_pk_bf16_f32 v173, v106, v107
v_cvt_pk_bf16_f32 v174, v108, v109
v_cvt_pk_bf16_f32 v175, v110, v111
s_add_u32 s82, s70, 34816
buffer_store_dwordx4 v[168:171], v6, s[48:51], s82 offen offset:0 sc1
s_add_u32 s82, s70, 34816
buffer_store_dwordx4 v[172:175], v6, s[48:51], s82 offen offset:1024 sc1
s_waitcnt lgkmcnt(0)
v_pk_mul_f32 v[112:113], v[112:113], v[34:35] op_sel:[0,0] op_sel_hi:[1,0]
v_pk_mul_f32 v[114:115], v[114:115], v[34:35] op_sel:[0,0] op_sel_hi:[1,0]
v_pk_mul_f32 v[116:117], v[116:117], v[34:35] op_sel:[0,0] op_sel_hi:[1,0]
v_pk_mul_f32 v[118:119], v[118:119], v[34:35] op_sel:[0,0] op_sel_hi:[1,0]
v_pk_mul_f32 v[120:121], v[120:121], v[34:35] op_sel:[0,0] op_sel_hi:[1,0]
v_pk_mul_f32 v[122:123], v[122:123], v[34:35] op_sel:[0,0] op_sel_hi:[1,0]
v_pk_mul_f32 v[124:125], v[124:125], v[34:35] op_sel:[0,0] op_sel_hi:[1,0]
v_pk_mul_f32 v[126:127], v[126:127], v[34:35] op_sel:[0,0] op_sel_hi:[1,0]
v_pk_fma_f32 v[112:113], v[188:189], v[34:35], v[112:113] op_sel:[0,1,0] op_sel_hi:[1,1,1]
v_pk_fma_f32 v[114:115], v[190:191], v[34:35], v[114:115] op_sel:[0,1,0] op_sel_hi:[1,1,1]
v_pk_fma_f32 v[116:117], v[192:193], v[34:35], v[116:117] op_sel:[0,1,0] op_sel_hi:[1,1,1]
v_pk_fma_f32 v[118:119], v[194:195], v[34:35], v[118:119] op_sel:[0,1,0] op_sel_hi:[1,1,1]
v_pk_fma_f32 v[120:121], v[196:197], v[34:35], v[120:121] op_sel:[0,1,0] op_sel_hi:[1,1,1]
v_pk_fma_f32 v[122:123], v[198:199], v[34:35], v[122:123] op_sel:[0,1,0] op_sel_hi:[1,1,1]
v_pk_fma_f32 v[124:125], v[200:201], v[34:35], v[124:125] op_sel:[0,1,0] op_sel_hi:[1,1,1]
v_pk_fma_f32 v[126:127], v[202:203], v[34:35], v[126:127] op_sel:[0,1,0] op_sel_hi:[1,1,1]
v_pk_mul_f32 v[204:205], v[112:113], v[112:113]
v_pk_mul_f32 v[206:207], v[114:115], v[114:115]
v_pk_mul_f32 v[208:209], v[116:117], v[116:117]
v_pk_mul_f32 v[210:211], v[118:119], v[118:119]
v_pk_mul_f32 v[212:213], v[120:121], v[120:121]
v_pk_mul_f32 v[214:215], v[122:123], v[122:123]
v_pk_mul_f32 v[216:217], v[124:125], v[124:125]
v_pk_mul_f32 v[218:219], v[126:127], v[126:127]
v_pk_fma_f32 v[204:205], v[204:205], s[90:91], v[44:45]
v_pk_fma_f32 v[206:207], v[206:207], s[90:91], v[44:45]
v_pk_fma_f32 v[208:209], v[208:209], s[90:91], v[44:45]
v_pk_fma_f32 v[210:211], v[210:211], s[90:91], v[44:45]
v_pk_fma_f32 v[212:213], v[212:213], s[90:91], v[44:45]
v_pk_fma_f32 v[214:215], v[214:215], s[90:91], v[44:45]
v_pk_fma_f32 v[216:217], v[216:217], s[90:91], v[44:45]
v_pk_fma_f32 v[218:219], v[218:219], s[90:91], v[44:45]
v_pk_mul_f32 v[204:205], v[204:205], v[112:113]
v_pk_mul_f32 v[206:207], v[206:207], v[114:115]
v_pk_mul_f32 v[208:209], v[208:209], v[116:117]
v_pk_mul_f32 v[210:211], v[210:211], v[118:119]
v_pk_mul_f32 v[212:213], v[212:213], v[120:121]
v_pk_mul_f32 v[214:215], v[214:215], v[122:123]
v_pk_mul_f32 v[216:217], v[216:217], v[124:125]
v_pk_mul_f32 v[218:219], v[218:219], v[126:127]
v_exp_f32 v204, v204
v_exp_f32 v205, v205
v_exp_f32 v206, v206
v_exp_f32 v207, v207
v_exp_f32 v208, v208
v_exp_f32 v209, v209
v_exp_f32 v210, v210
v_exp_f32 v211, v211
v_exp_f32 v212, v212
v_exp_f32 v213, v213
v_exp_f32 v214, v214
v_exp_f32 v215, v215
v_exp_f32 v216, v216
v_exp_f32 v217, v217
v_exp_f32 v218, v218
v_exp_f32 v219, v219
v_pk_add_f32 v[204:205], v[204:205], v[42:43]
v_pk_add_f32 v[206:207], v[206:207], v[42:43]
v_pk_add_f32 v[208:209], v[208:209], v[42:43]
v_pk_add_f32 v[210:211], v[210:211], v[42:43]
v_pk_add_f32 v[212:213], v[212:213], v[42:43]
v_pk_add_f32 v[214:215], v[214:215], v[42:43]
v_pk_add_f32 v[216:217], v[216:217], v[42:43]
v_pk_add_f32 v[218:219], v[218:219], v[42:43]
v_rcp_f32 v204, v204
v_rcp_f32 v205, v205
v_rcp_f32 v206, v206
v_rcp_f32 v207, v207
v_rcp_f32 v208, v208
v_rcp_f32 v209, v209
v_rcp_f32 v210, v210
v_rcp_f32 v211, v211
v_rcp_f32 v212, v212
v_rcp_f32 v213, v213
v_rcp_f32 v214, v214
v_rcp_f32 v215, v215
v_rcp_f32 v216, v216
v_rcp_f32 v217, v217
v_rcp_f32 v218, v218
v_rcp_f32 v219, v219
v_pk_mul_f32 v[112:113], v[112:113], v[204:205]
v_pk_mul_f32 v[114:115], v[114:115], v[206:207]
v_pk_mul_f32 v[116:117], v[116:117], v[208:209]
v_pk_mul_f32 v[118:119], v[118:119], v[210:211]
v_pk_mul_f32 v[120:121], v[120:121], v[212:213]
v_pk_mul_f32 v[122:123], v[122:123], v[214:215]
v_pk_mul_f32 v[124:125], v[124:125], v[216:217]
v_pk_mul_f32 v[126:127], v[126:127], v[218:219]
v_cvt_pk_bf16_f32 v220, v112, v113
v_cvt_pk_bf16_f32 v221, v114, v115
v_cvt_pk_bf16_f32 v222, v116, v117
v_cvt_pk_bf16_f32 v223, v118, v119
v_cvt_pk_bf16_f32 v224, v120, v121
v_cvt_pk_bf16_f32 v225, v122, v123
v_cvt_pk_bf16_f32 v226, v124, v125
v_cvt_pk_bf16_f32 v227, v126, v127
v_permlane32_swap_b32 v220, v222
v_permlane32_swap_b32 v221, v223
v_permlane32_swap_b32 v224, v226
v_permlane32_swap_b32 v225, v227
ds_write_b128 v186, v[220:223] offset:0
ds_write_b128 v186, v[224:227] offset:32
ds_read_b128 v[220:223], v187 offset:0
ds_read_b128 v[224:227], v187 offset:1280
v_pk_mul_f32 v[128:129], v[128:129], v[36:37] op_sel:[0,0] op_sel_hi:[1,0]
s_waitcnt lgkmcnt(0)
s_add_u32 s80, s71, 0
buffer_store_dwordx4 v[220:223], v31, s[48:51], s80 offen offset:0 sc1
buffer_store_dwordx4 v[224:227], v31, s[48:51], s80 offen offset:1024 sc1
v_pk_mul_f32 v[130:131], v[130:131], v[36:37] op_sel:[0,0] op_sel_hi:[1,0]
v_pk_mul_f32 v[132:133], v[132:133], v[36:37] op_sel:[0,0] op_sel_hi:[1,0]
v_pk_mul_f32 v[134:135], v[134:135], v[36:37] op_sel:[0,0] op_sel_hi:[1,0]
v_pk_mul_f32 v[136:137], v[136:137], v[36:37] op_sel:[0,0] op_sel_hi:[1,0]
v_pk_mul_f32 v[138:139], v[138:139], v[36:37] op_sel:[0,0] op_sel_hi:[1,0]
v_pk_mul_f32 v[140:141], v[140:141], v[36:37] op_sel:[0,0] op_sel_hi:[1,0]
v_pk_mul_f32 v[142:143], v[142:143], v[36:37] op_sel:[0,0] op_sel_hi:[1,0]
v_pk_fma_f32 v[128:129], v[188:189], v[36:37], v[128:129] op_sel:[0,1,0] op_sel_hi:[1,1,1]
v_pk_fma_f32 v[130:131], v[190:191], v[36:37], v[130:131] op_sel:[0,1,0] op_sel_hi:[1,1,1]
v_pk_fma_f32 v[132:133], v[192:193], v[36:37], v[132:133] op_sel:[0,1,0] op_sel_hi:[1,1,1]
v_pk_fma_f32 v[134:135], v[194:195], v[36:37], v[134:135] op_sel:[0,1,0] op_sel_hi:[1,1,1]
v_pk_fma_f32 v[136:137], v[196:197], v[36:37], v[136:137] op_sel:[0,1,0] op_sel_hi:[1,1,1]
v_pk_fma_f32 v[138:139], v[198:199], v[36:37], v[138:139] op_sel:[0,1,0] op_sel_hi:[1,1,1]
v_pk_fma_f32 v[140:141], v[200:201], v[36:37], v[140:141] op_sel:[0,1,0] op_sel_hi:[1,1,1]
v_pk_fma_f32 v[142:143], v[202:203], v[36:37], v[142:143] op_sel:[0,1,0] op_sel_hi:[1,1,1]
v_pk_mul_f32 v[204:205], v[128:129], v[128:129]
v_pk_mul_f32 v[206:207], v[130:131], v[130:131]
v_pk_mul_f32 v[208:209], v[132:133], v[132:133]
v_pk_mul_f32 v[210:211], v[134:135], v[134:135]
v_pk_mul_f32 v[212:213], v[136:137], v[136:137]
v_pk_mul_f32 v[214:215], v[138:139], v[138:139]
v_pk_mul_f32 v[216:217], v[140:141], v[140:141]
v_pk_mul_f32 v[218:219], v[142:143], v[142:143]
v_pk_fma_f32 v[204:205], v[204:205], s[90:91], v[44:45]
v_pk_fma_f32 v[206:207], v[206:207], s[90:91], v[44:45]
v_pk_fma_f32 v[208:209], v[208:209], s[90:91], v[44:45]
v_pk_fma_f32 v[210:211], v[210:211], s[90:91], v[44:45]
v_pk_fma_f32 v[212:213], v[212:213], s[90:91], v[44:45]
v_pk_fma_f32 v[214:215], v[214:215], s[90:91], v[44:45]
v_pk_fma_f32 v[216:217], v[216:217], s[90:91], v[44:45]
v_pk_fma_f32 v[218:219], v[218:219], s[90:91], v[44:45]
v_pk_mul_f32 v[204:205], v[204:205], v[128:129]
v_pk_mul_f32 v[206:207], v[206:207], v[130:131]
v_pk_mul_f32 v[208:209], v[208:209], v[132:133]
v_pk_mul_f32 v[210:211], v[210:211], v[134:135]
v_pk_mul_f32 v[212:213], v[212:213], v[136:137]
v_pk_mul_f32 v[214:215], v[214:215], v[138:139]
v_pk_mul_f32 v[216:217], v[216:217], v[140:141]
v_pk_mul_f32 v[218:219], v[218:219], v[142:143]
v_exp_f32 v204, v204
v_exp_f32 v205, v205
v_exp_f32 v206, v206
v_exp_f32 v207, v207
v_exp_f32 v208, v208
v_exp_f32 v209, v209
v_exp_f32 v210, v210
v_exp_f32 v211, v211
v_exp_f32 v212, v212
v_exp_f32 v213, v213
v_exp_f32 v214, v214
v_exp_f32 v215, v215
v_exp_f32 v216, v216
v_exp_f32 v217, v217
v_exp_f32 v218, v218
v_exp_f32 v219, v219
v_pk_add_f32 v[204:205], v[204:205], v[42:43]
v_pk_add_f32 v[206:207], v[206:207], v[42:43]
v_pk_add_f32 v[208:209], v[208:209], v[42:43]
v_pk_add_f32 v[210:211], v[210:211], v[42:43]
v_pk_add_f32 v[212:213], v[212:213], v[42:43]
v_pk_add_f32 v[214:215], v[214:215], v[42:43]
v_pk_add_f32 v[216:217], v[216:217], v[42:43]
v_pk_add_f32 v[218:219], v[218:219], v[42:43]
v_rcp_f32 v204, v204
v_rcp_f32 v205, v205
v_rcp_f32 v206, v206
v_rcp_f32 v207, v207
v_rcp_f32 v208, v208
v_rcp_f32 v209, v209
v_rcp_f32 v210, v210
v_rcp_f32 v211, v211
v_rcp_f32 v212, v212
v_rcp_f32 v213, v213
v_rcp_f32 v214, v214
v_rcp_f32 v215, v215
v_rcp_f32 v216, v216
v_rcp_f32 v217, v217
v_rcp_f32 v218, v218
v_rcp_f32 v219, v219
v_pk_mul_f32 v[128:129], v[128:129], v[204:205]
v_pk_mul_f32 v[130:131], v[130:131], v[206:207]
v_pk_mul_f32 v[132:133], v[132:133], v[208:209]
v_pk_mul_f32 v[134:135], v[134:135], v[210:211]
v_pk_mul_f32 v[136:137], v[136:137], v[212:213]
v_pk_mul_f32 v[138:139], v[138:139], v[214:215]
v_pk_mul_f32 v[140:141], v[140:141], v[216:217]
v_pk_mul_f32 v[142:143], v[142:143], v[218:219]
v_cvt_pk_bf16_f32 v228, v128, v129
v_cvt_pk_bf16_f32 v229, v130, v131
v_cvt_pk_bf16_f32 v230, v132, v133
v_cvt_pk_bf16_f32 v231, v134, v135
v_cvt_pk_bf16_f32 v232, v136, v137
v_cvt_pk_bf16_f32 v233, v138, v139
v_cvt_pk_bf16_f32 v234, v140, v141
v_cvt_pk_bf16_f32 v235, v142, v143
v_permlane32_swap_b32 v228, v230
v_permlane32_swap_b32 v229, v231
v_permlane32_swap_b32 v232, v234
v_permlane32_swap_b32 v233, v235
ds_write_b128 v186, v[228:231] offset:2560
ds_write_b128 v186, v[232:235] offset:2592
ds_read_b128 v[228:231], v187 offset:2560
ds_read_b128 v[232:235], v187 offset:3840
s_waitcnt lgkmcnt(0)
s_add_u32 s80, s71, 0
buffer_store_dwordx4 v[228:231], v31, s[48:51], s80 offen offset:2048 sc1
buffer_store_dwordx4 v[232:235], v32, s[48:51], s80 offen sc1
s_cmp_lt_u32 s69, 8
s_cbranch_scc1 L_p1_nog_4
v_pk_mul_f32 v[178:179], v[112:113], v[112:113]
v_pk_add_f32 v[176:177], v[112:113], v[114:115]
v_pk_fma_f32 v[178:179], v[114:115], v[114:115], v[178:179]
v_pk_add_f32 v[176:177], v[176:177], v[116:117]
v_pk_fma_f32 v[178:179], v[116:117], v[116:117], v[178:179]
v_pk_add_f32 v[176:177], v[176:177], v[118:119]
v_pk_fma_f32 v[178:179], v[118:119], v[118:119], v[178:179]
v_pk_add_f32 v[176:177], v[176:177], v[120:121]
v_pk_fma_f32 v[178:179], v[120:121], v[120:121], v[178:179]
v_pk_add_f32 v[176:177], v[176:177], v[122:123]
v_pk_fma_f32 v[178:179], v[122:123], v[122:123], v[178:179]
v_pk_add_f32 v[176:177], v[176:177], v[124:125]
v_pk_fma_f32 v[178:179], v[124:125], v[124:125], v[178:179]
v_pk_add_f32 v[176:177], v[176:177], v[126:127]
v_pk_fma_f32 v[178:179], v[126:127], v[126:127], v[178:179]
v_add_f32 v176, v176, v177
v_add_f32 v177, v178, v179
v_mov_b32 v178, v176
v_mov_b32 v179, v177
s_nop 0
v_permlane32_swap_b32 v176, v178
v_permlane32_swap_b32 v177, v179
v_pk_add_f32 v[176:177], v[176:177], v[178:179]
buffer_store_dwordx2 v[176:177], v184, s[48:51], s76 offen sc1
v_pk_mul_f32 v[182:183], v[128:129], v[128:129]
v_pk_add_f32 v[180:181], v[128:129], v[130:131]
v_pk_fma_f32 v[182:183], v[130:131], v[130:131], v[182:183]
v_pk_add_f32 v[180:181], v[180:181], v[132:133]
v_pk_fma_f32 v[182:183], v[132:133], v[132:133], v[182:183]
v_pk_add_f32 v[180:181], v[180:181], v[134:135]
v_pk_fma_f32 v[182:183], v[134:135], v[134:135], v[182:183]
v_pk_add_f32 v[180:181], v[180:181], v[136:137]
v_pk_fma_f32 v[182:183], v[136:137], v[136:137], v[182:183]
v_pk_add_f32 v[180:181], v[180:181], v[138:139]
v_pk_fma_f32 v[182:183], v[138:139], v[138:139], v[182:183]
v_pk_add_f32 v[180:181], v[180:181], v[140:141]
v_pk_fma_f32 v[182:183], v[140:141], v[140:141], v[182:183]
v_pk_add_f32 v[180:181], v[180:181], v[142:143]
v_pk_fma_f32 v[182:183], v[142:143], v[142:143], v[182:183]
v_add_f32 v180, v180, v181
v_add_f32 v181, v182, v183
v_mov_b32 v182, v180
v_mov_b32 v183, v181
s_nop 0
v_permlane32_swap_b32 v180, v182
v_permlane32_swap_b32 v181, v183
v_pk_add_f32 v[180:181], v[180:181], v[182:183]
buffer_store_dwordx2 v[180:181], v185, s[48:51], s76 offen sc1
L_p1_nog_4:
s_mov_b64 exec, -1
v_mov_b32 v3, 1
s_waitcnt vmcnt(0) lgkmcnt(0)
s_barrier
s_cmp_lg_u32 s28, 0
s_cbranch_scc1 L_p1_nopub_5
s_mov_b64 exec, 1
buffer_store_dword v3, off, s[48:51], s87 sc1
s_mov_b64 exec, -1
L_p1_nopub_5:
s_branch L_p2_start
L_p1_epi_g:
ds_read_b128 v[188:191], v7 offset:0
ds_read_b128 v[192:195], v7 offset:32
ds_read_b128 v[196:199], v7 offset:64
ds_read_b128 v[200:203], v7 offset:96
ds_read_b128 v[144:147], v7 offset:128
ds_read_b128 v[148:151], v7 offset:160
ds_read_b128 v[152:155], v7 offset:192
ds_read_b128 v[156:159], v7 offset:224
s_waitcnt lgkmcnt(4)
v_pk_mul_f32 v[48:49], v[48:49], v[34:35] op_sel:[0,0] op_sel_hi:[1,0]
v_pk_mul_f32 v[50:51], v[50:51], v[34:35] op_sel:[0,0] op_sel_hi:[1,0]
v_pk_mul_f32 v[52:53], v[52:53], v[34:35] op_sel:[0,0] op_sel_hi:[1,0]
v_pk_mul_f32 v[54:55], v[54:55], v[34:35] op_sel:[0,0] op_sel_hi:[1,0]
v_pk_mul_f32 v[56:57], v[56:57], v[34:35] op_sel:[0,0] op_sel_hi:[1,0]
v_pk_mul_f32 v[58:59], v[58:59], v[34:35] op_sel:[0,0] op_sel_hi:[1,0]
v_pk_mul_f32 v[60:61], v[60:61], v[34:35] op_sel:[0,0] op_sel_hi:[1,0]
v_pk_mul_f32 v[62:63], v[62:63], v[34:35] op_sel:[0,0] op_sel_hi:[1,0]
v_pk_fma_f32 v[48:49], v[188:189], v[34:35], v[48:49] op_sel:[0,1,0] op_sel_hi:[1,1,1]
v_pk_fma_f32 v[50:51], v[190:191], v[34:35], v[50:51] op_sel:[0,1,0] op_sel_hi:[1,1,1]
v_pk_fma_f32 v[52:53], v[192:193], v[34:35], v[52:53] op_sel:[0,1,0] op_sel_hi:[1,1,1]
v_pk_fma_f32 v[54:55], v[194:195], v[34:35], v[54:55] op_sel:[0,1,0] op_sel_hi:[1,1,1]
v_pk_fma_f32 v[56:57], v[196:197], v[34:35], v[56:57] op_sel:[0,1,0] op_sel_hi:[1,1,1]
v_pk_fma_f32 v[58:59], v[198:199], v[34:35], v[58:59] op_sel:[0,1,0] op_sel_hi:[1,1,1]
v_pk_fma_f32 v[60:61], v[200:201], v[34:35], v[60:61] op_sel:[0,1,0] op_sel_hi:[1,1,1]
v_pk_fma_f32 v[62:63], v[202:203], v[34:35], v[62:63] op_sel:[0,1,0] op_sel_hi:[1,1,1]
v_pk_mul_f32 v[204:205], v[48:49], v[48:49]
v_pk_mul_f32 v[206:207], v[50:51], v[50:51]
v_pk_mul_f32 v[208:209], v[52:53], v[52:53]
v_pk_mul_f32 v[210:211], v[54:55], v[54:55]
v_pk_mul_f32 v[212:213], v[56:57], v[56:57]
v_pk_mul_f32 v[214:215], v[58:59], v[58:59]
v_pk_mul_f32 v[216:217], v[60:61], v[60:61]
v_pk_mul_f32 v[218:219], v[62:63], v[62:63]
v_pk_fma_f32 v[204:205], v[204:205], s[90:91], v[44:45]
v_pk_fma_f32 v[206:207], v[206:207], s[90:91], v[44:45]
v_pk_fma_f32 v[208:209], v[208:209], s[90:91], v[44:45]
v_pk_fma_f32 v[210:211], v[210:211], s[90:91], v[44:45]
v_pk_fma_f32 v[212:213], v[212:213], s[90:91], v[44:45]
v_pk_fma_f32 v[214:215], v[214:215], s[90:91], v[44:45]
v_pk_fma_f32 v[216:217], v[216:217], s[90:91], v[44:45]
v_pk_fma_f32 v[218:219], v[218:219], s[90:91], v[44:45]
v_pk_mul_f32 v[204:205], v[204:205], v[48:49]
v_pk_mul_f32 v[206:207], v[206:207], v[50:51]
v_pk_mul_f32 v[208:209], v[208:209], v[52:53]
v_pk_mul_f32 v[210:211], v[210:211], v[54:55]
v_pk_mul_f32 v[212:213], v[212:213], v[56:57]
v_pk_mul_f32 v[214:215], v[214:215], v[58:59]
v_pk_mul_f32 v[216:217], v[216:217], v[60:61]
v_pk_mul_f32 v[218:219], v[218:219], v[62:63]
v_exp_f32 v204, v204
v_exp_f32 v205, v205
v_exp_f32 v206, v206
v_exp_f32 v207, v207
v_exp_f32 v208, v208
v_exp_f32 v209, v209
v_exp_f32 v210, v210
v_exp_f32 v211, v211
v_exp_f32 v212, v212
v_exp_f32 v213, v213
v_exp_f32 v214, v214
v_exp_f32 v215, v215
v_exp_f32 v216, v216
v_exp_f32 v217, v217
v_exp_f32 v218, v218
v_exp_f32 v219, v219
v_pk_add_f32 v[204:205], v[204:205], v[42:43]
v_pk_add_f32 v[206:207], v[206:207], v[42:43]
v_pk_add_f32 v[208:209], v[208:209], v[42:43]
v_pk_add_f32 v[210:211], v[210:211], v[42:43]
v_pk_add_f32 v[212:213], v[212:213], v[42:43]
v_pk_add_f32 v[214:215], v[214:215], v[42:43]
v_pk_add_f32 v[216:217], v[216:217], v[42:43]
v_pk_add_f32 v[218:219], v[218:219], v[42:43]
v_rcp_f32 v204, v204
v_rcp_f32 v205, v205
v_rcp_f32 v206, v206
v_rcp_f32 v207, v207
v_rcp_f32 v208, v208
v_rcp_f32 v209, v209
v_rcp_f32 v210, v210
v_rcp_f32 v211, v211
v_rcp_f32 v212, v212
v_rcp_f32 v213, v213
v_rcp_f32 v214, v214
v_rcp_f32 v215, v215
v_rcp_f32 v216, v216
v_rcp_f32 v217, v217
v_rcp_f32 v218, v218
v_rcp_f32 v219, v219
v_pk_mul_f32 v[48:49], v[48:49], v[204:205]
v_pk_mul_f32 v[50:51], v[50:51], v[206:207]
v_pk_mul_f32 v[52:53], v[52:53], v[208:209]
v_pk_mul_f32 v[54:55], v[54:55], v[210:211]
v_pk_mul_f32 v[56:57], v[56:57], v[212:213]
v_pk_mul_f32 v[58:59], v[58:59], v[214:215]
v_pk_mul_f32 v[60:61], v[60:61], v[216:217]
v_pk_mul_f32 v[62:63], v[62:63], v[218:219]
v_cvt_pk_bf16_f32 v220, v48, v49
v_cvt_pk_bf16_f32 v221, v50, v51
v_cvt_pk_bf16_f32 v222, v52, v53
v_cvt_pk_bf16_f32 v223, v54, v55
v_cvt_pk_bf16_f32 v224, v56, v57
v_cvt_pk_bf16_f32 v225, v58, v59
v_cvt_pk_bf16_f32 v226, v60, v61
v_cvt_pk_bf16_f32 v227, v62, v63
v_permlane32_swap_b32 v220, v222
v_permlane32_swap_b32 v221, v223
v_permlane32_swap_b32 v224, v226
v_permlane32_swap_b32 v225, v227
ds_write_b128 v186, v[220:223] offset:0
ds_write_b128 v186, v[224:227] offset:32
ds_read_b128 v[220:223], v187 offset:0
ds_read_b128 v[224:227], v187 offset:1280
v_pk_mul_f32 v[178:179], v[48:49], v[48:49]
v_pk_add_f32 v[176:177], v[48:49], v[50:51]
v_pk_fma_f32 v[178:179], v[50:51], v[50:51], v[178:179]
v_pk_add_f32 v[176:177], v[176:177], v[52:53]
v_pk_fma_f32 v[178:179], v[52:53], v[52:53], v[178:179]
v_pk_add_f32 v[176:177], v[176:177], v[54:55]
v_pk_fma_f32 v[178:179], v[54:55], v[54:55], v[178:179]
v_pk_add_f32 v[176:177], v[176:177], v[56:57]
v_pk_fma_f32 v[178:179], v[56:57], v[56:57], v[178:179]
v_pk_add_f32 v[176:177], v[176:177], v[58:59]
v_pk_fma_f32 v[178:179], v[58:59], v[58:59], v[178:179]
v_pk_add_f32 v[176:177], v[176:177], v[60:61]
v_pk_fma_f32 v[178:179], v[60:61], v[60:61], v[178:179]
v_pk_add_f32 v[176:177], v[176:177], v[62:63]
v_pk_fma_f32 v[178:179], v[62:63], v[62:63], v[178:179]
v_pk_mul_f32 v[64:65], v[64:65], v[36:37] op_sel:[0,0] op_sel_hi:[1,0]
v_pk_mul_f32 v[66:67], v[66:67], v[36:37] op_sel:[0,0] op_sel_hi:[1,0]
v_pk_mul_f32 v[68:69], v[68:69], v[36:37] op_sel:[0,0] op_sel_hi:[1,0]
v_pk_mul_f32 v[70:71], v[70:71], v[36:37] op_sel:[0,0] op_sel_hi:[1,0]
v_pk_mul_f32 v[72:73], v[72:73], v[36:37] op_sel:[0,0] op_sel_hi:[1,0]
v_pk_mul_f32 v[74:75], v[74:75], v[36:37] op_sel:[0,0] op_sel_hi:[1,0]
v_pk_mul_f32 v[76:77], v[76:77], v[36:37] op_sel:[0,0] op_sel_hi:[1,0]
v_pk_mul_f32 v[78:79], v[78:79], v[36:37] op_sel:[0,0] op_sel_hi:[1,0]
v_pk_fma_f32 v[64:65], v[188:189], v[36:37], v[64:65] op_sel:[0,1,0] op_sel_hi:[1,1,1]
s_waitcnt lgkmcnt(0)
s_add_u32 s80, s70, 0
buffer_store_dwordx4 v[220:223], v31, s[48:51], s80 offen offset:0 sc1
buffer_store_dwordx4 v[224:227], v31, s[48:51], s80 offen offset:1024 sc1
v_pk_fma_f32 v[66:67], v[190:191], v[36:37], v[66:67] op_sel:[0,1,0] op_sel_hi:[1,1,1]
v_pk_fma_f32 v[68:69], v[192:193], v[36:37], v[68:69] op_sel:[0,1,0] op_sel_hi:[1,1,1]
v_pk_fma_f32 v[70:71], v[194:195], v[36:37], v[70:71] op_sel:[0,1,0] op_sel_hi:[1,1,1]
v_pk_fma_f32 v[72:73], v[196:197], v[36:37], v[72:73] op_sel:[0,1,0] op_sel_hi:[1,1,1]
v_pk_fma_f32 v[74:75], v[198:199], v[36:37], v[74:75] op_sel:[0,1,0] op_sel_hi:[1,1,1]
v_pk_fma_f32 v[76:77], v[200:201], v[36:37], v[76:77] op_sel:[0,1,0] op_sel_hi:[1,1,1]
v_pk_fma_f32 v[78:79], v[202:203], v[36:37], v[78:79] op_sel:[0,1,0] op_sel_hi:[1,1,1]
v_pk_mul_f32 v[204:205], v[64:65], v[64:65]
v_pk_mul_f32 v[206:207], v[66:67], v[66:67]
v_pk_mul_f32 v[208:209], v[68:69], v[68:69]
v_pk_mul_f32 v[210:211], v[70:71], v[70:71]
v_pk_mul_f32 v[212:213], v[72:73], v[72:73]
v_pk_mul_f32 v[214:215], v[74:75], v[74:75]
v_pk_mul_f32 v[216:217], v[76:77], v[76:77]
v_pk_mul_f32 v[218:219], v[78:79], v[78:79]
v_pk_fma_f32 v[204:205], v[204:205], s[90:91], v[44:45]
v_pk_fma_f32 v[206:207], v[206:207], s[90:91], v[44:45]
v_pk_fma_f32 v[208:209], v[208:209], s[90:91], v[44:45]
v_pk_fma_f32 v[210:211], v[210:211], s[90:91], v[44:45]
v_pk_fma_f32 v[212:213], v[212:213], s[90:91], v[44:45]
v_pk_fma_f32 v[214:215], v[214:215], s[90:91], v[44:45]
v_pk_fma_f32 v[216:217], v[216:217], s[90:91], v[44:45]
v_pk_fma_f32 v[218:219], v[218:219], s[90:91], v[44:45]
v_pk_mul_f32 v[204:205], v[204:205], v[64:65]
v_pk_mul_f32 v[206:207], v[206:207], v[66:67]
v_pk_mul_f32 v[208:209], v[208:209], v[68:69]
v_pk_mul_f32 v[210:211], v[210:211], v[70:71]
v_pk_mul_f32 v[212:213], v[212:213], v[72:73]
v_pk_mul_f32 v[214:215], v[214:215], v[74:75]
v_pk_mul_f32 v[216:217], v[216:217], v[76:77]
v_pk_mul_f32 v[218:219], v[218:219], v[78:79]
v_exp_f32 v204, v204
v_exp_f32 v205, v205
v_exp_f32 v206, v206
v_exp_f32 v207, v207
v_exp_f32 v208, v208
v_exp_f32 v209, v209
v_exp_f32 v210, v210
v_exp_f32 v211, v211
v_exp_f32 v212, v212
v_exp_f32 v213, v213
v_exp_f32 v214, v214
v_exp_f32 v215, v215
v_exp_f32 v216, v216
v_exp_f32 v217, v217
v_exp_f32 v218, v218
v_exp_f32 v219, v219
v_pk_add_f32 v[204:205], v[204:205], v[42:43]
v_pk_add_f32 v[206:207], v[206:207], v[42:43]
v_pk_add_f32 v[208:209], v[208:209], v[42:43]
v_pk_add_f32 v[210:211], v[210:211], v[42:43]
v_pk_add_f32 v[212:213], v[212:213], v[42:43]
v_pk_add_f32 v[214:215], v[214:215], v[42:43]
v_pk_add_f32 v[216:217], v[216:217], v[42:43]
v_pk_add_f32 v[218:219], v[218:219], v[42:43]
v_rcp_f32 v204, v204
v_rcp_f32 v205, v205
v_rcp_f32 v206, v206
v_rcp_f32 v207, v207
v_rcp_f32 v208, v208
v_rcp_f32 v209, v209
v_rcp_f32 v210, v210
v_rcp_f32 v211, v211
v_rcp_f32 v212, v212
v_rcp_f32 v213, v213
v_rcp_f32 v214, v214
v_rcp_f32 v215, v215
v_rcp_f32 v216, v216
v_rcp_f32 v217, v217
v_rcp_f32 v218, v218
v_rcp_f32 v219, v219
v_pk_mul_f32 v[64:65], v[64:65], v[204:205]
v_pk_mul_f32 v[66:67], v[66:67], v[206:207]
v_pk_mul_f32 v[68:69], v[68:69], v[208:209]
v_pk_mul_f32 v[70:71], v[70:71], v[210:211]
v_pk_mul_f32 v[72:73], v[72:73], v[212:213]
v_pk_mul_f32 v[74:75], v[74:75], v[214:215]
v_pk_mul_f32 v[76:77], v[76:77], v[216:217]
v_pk_mul_f32 v[78:79], v[78:79], v[218:219]
v_cvt_pk_bf16_f32 v228, v64, v65
v_cvt_pk_bf16_f32 v229, v66, v67
v_cvt_pk_bf16_f32 v230, v68, v69
v_cvt_pk_bf16_f32 v231, v70, v71
v_cvt_pk_bf16_f32 v232, v72, v73
v_cvt_pk_bf16_f32 v233, v74, v75
v_cvt_pk_bf16_f32 v234, v76, v77
v_cvt_pk_bf16_f32 v235, v78, v79
v_permlane32_swap_b32 v228, v230
v_permlane32_swap_b32 v229, v231
v_permlane32_swap_b32 v232, v234
v_permlane32_swap_b32 v233, v235
ds_write_b128 v186, v[228:231] offset:2560
ds_write_b128 v186, v[232:235] offset:2592
ds_read_b128 v[228:231], v187 offset:2560
ds_read_b128 v[232:235], v187 offset:3840
v_pk_mul_f32 v[182:183], v[64:65], v[64:65]
v_pk_add_f32 v[180:181], v[64:65], v[66:67]
v_pk_fma_f32 v[182:183], v[66:67], v[66:67], v[182:183]
v_pk_add_f32 v[180:181], v[180:181], v[68:69]
v_pk_fma_f32 v[182:183], v[68:69], v[68:69], v[182:183]
v_pk_add_f32 v[180:181], v[180:181], v[70:71]
v_pk_fma_f32 v[182:183], v[70:71], v[70:71], v[182:183]
v_pk_add_f32 v[180:181], v[180:181], v[72:73]
v_pk_fma_f32 v[182:183], v[72:73], v[72:73], v[182:183]
v_pk_add_f32 v[180:181], v[180:181], v[74:75]
v_pk_fma_f32 v[182:183], v[74:75], v[74:75], v[182:183]
v_pk_add_f32 v[180:181], v[180:181], v[76:77]
v_pk_fma_f32 v[182:183], v[76:77], v[76:77], v[182:183]
v_pk_add_f32 v[180:181], v[180:181], v[78:79]
v_pk_fma_f32 v[182:183], v[78:79], v[78:79], v[182:183]
s_waitcnt lgkmcnt(0)
v_pk_mul_f32 v[80:81], v[80:81], v[34:35] op_sel:[0,0] op_sel_hi:[1,0]
v_pk_mul_f32 v[82:83], v[82:83], v[34:35] op_sel:[0,0] op_sel_hi:[1,0]
v_pk_mul_f32 v[84:85], v[84:85], v[34:35] op_sel:[0,0] op_sel_hi:[1,0]
v_pk_mul_f32 v[86:87], v[86:87], v[34:35] op_sel:[0,0] op_sel_hi:[1,0]
v_pk_mul_f32 v[88:89], v[88:89], v[34:35] op_sel:[0,0] op_sel_hi:[1,0]
v_pk_mul_f32 v[90:91], v[90:91], v[34:35] op_sel:[0,0] op_sel_hi:[1,0]
v_pk_mul_f32 v[92:93], v[92:93], v[34:35] op_sel:[0,0] op_sel_hi:[1,0]
v_pk_mul_f32 v[94:95], v[94:95], v[34:35] op_sel:[0,0] op_sel_hi:[1,0]
v_pk_fma_f32 v[80:81], v[144:145], v[34:35], v[80:81] op_sel:[0,1,0] op_sel_hi:[1,1,1]
s_waitcnt lgkmcnt(0)
s_add_u32 s80, s70, 0
buffer_store_dwordx4 v[228:231], v31, s[48:51], s80 offen offset:2048 sc1
buffer_store_dwordx4 v[232:235], v32, s[48:51], s80 offen sc1
v_pk_fma_f32 v[82:83], v[146:147], v[34:35], v[82:83] op_sel:[0,1,0] op_sel_hi:[1,1,1]
v_pk_fma_f32 v[84:85], v[148:149], v[34:35], v[84:85] op_sel:[0,1,0] op_sel_hi:[1,1,1]
v_pk_fma_f32 v[86:87], v[150:151], v[34:35], v[86:87] op_sel:[0,1,0] op_sel_hi:[1,1,1]
v_pk_fma_f32 v[88:89], v[152:153], v[34:35], v[88:89] op_sel:[0,1,0] op_sel_hi:[1,1,1]
v_pk_fma_f32 v[90:91], v[154:155], v[34:35], v[90:91] op_sel:[0,1,0] op_sel_hi:[1,1,1]
v_pk_fma_f32 v[92:93], v[156:157], v[34:35], v[92:93] op_sel:[0,1,0] op_sel_hi:[1,1,1]
v_pk_fma_f32 v[94:95], v[158:159], v[34:35], v[94:95] op_sel:[0,1,0] op_sel_hi:[1,1,1]
v_pk_mul_f32 v[204:205], v[80:81], v[80:81]
v_pk_mul_f32 v[206:207], v[82:83], v[82:83]
v_pk_mul_f32 v[208:209], v[84:85], v[84:85]
v_pk_mul_f32 v[210:211], v[86:87], v[86:87]
v_pk_mul_f32 v[212:213], v[88:89], v[88:89]
v_pk_mul_f32 v[214:215], v[90:91], v[90:91]
v_pk_mul_f32 v[216:217], v[92:93], v[92:93]
v_pk_mul_f32 v[218:219], v[94:95], v[94:95]
v_pk_fma_f32 v[204:205], v[204:205], s[90:91], v[44:45]
v_pk_fma_f32 v[206:207], v[206:207], s[90:91], v[44:45]
v_pk_fma_f32 v[208:209], v[208:209], s[90:91], v[44:45]
v_pk_fma_f32 v[210:211], v[210:211], s[90:91], v[44:45]
v_pk_fma_f32 v[212:213], v[212:213], s[90:91], v[44:45]
v_pk_fma_f32 v[214:215], v[214:215], s[90:91], v[44:45]
v_pk_fma_f32 v[216:217], v[216:217], s[90:91], v[44:45]
v_pk_fma_f32 v[218:219], v[218:219], s[90:91], v[44:45]
v_pk_mul_f32 v[204:205], v[204:205], v[80:81]
v_pk_mul_f32 v[206:207], v[206:207], v[82:83]
v_pk_mul_f32 v[208:209], v[208:209], v[84:85]
v_pk_mul_f32 v[210:211], v[210:211], v[86:87]
v_pk_mul_f32 v[212:213], v[212:213], v[88:89]
v_pk_mul_f32 v[214:215], v[214:215], v[90:91]
v_pk_mul_f32 v[216:217], v[216:217], v[92:93]
v_pk_mul_f32 v[218:219], v[218:219], v[94:95]
v_exp_f32 v204, v204
v_exp_f32 v205, v205
v_exp_f32 v206, v206
v_exp_f32 v207, v207
v_exp_f32 v208, v208
v_exp_f32 v209, v209
v_exp_f32 v210, v210
v_exp_f32 v211, v211
v_exp_f32 v212, v212
v_exp_f32 v213, v213
v_exp_f32 v214, v214
v_exp_f32 v215, v215
v_exp_f32 v216, v216
v_exp_f32 v217, v217
v_exp_f32 v218, v218
v_exp_f32 v219, v219
v_pk_add_f32 v[204:205], v[204:205], v[42:43]
v_pk_add_f32 v[206:207], v[206:207], v[42:43]
v_pk_add_f32 v[208:209], v[208:209], v[42:43]
v_pk_add_f32 v[210:211], v[210:211], v[42:43]
v_pk_add_f32 v[212:213], v[212:213], v[42:43]
v_pk_add_f32 v[214:215], v[214:215], v[42:43]
v_pk_add_f32 v[216:217], v[216:217], v[42:43]
v_pk_add_f32 v[218:219], v[218:219], v[42:43]
v_rcp_f32 v204, v204
v_rcp_f32 v205, v205
v_rcp_f32 v206, v206
v_rcp_f32 v207, v207
v_rcp_f32 v208, v208
v_rcp_f32 v209, v209
v_rcp_f32 v210, v210
v_rcp_f32 v211, v211
v_rcp_f32 v212, v212
v_rcp_f32 v213, v213
v_rcp_f32 v214, v214
v_rcp_f32 v215, v215
v_rcp_f32 v216, v216
v_rcp_f32 v217, v217
v_rcp_f32 v218, v218
v_rcp_f32 v219, v219
v_pk_mul_f32 v[80:81], v[80:81], v[204:205]
v_pk_mul_f32 v[82:83], v[82:83], v[206:207]
v_pk_mul_f32 v[84:85], v[84:85], v[208:209]
v_pk_mul_f32 v[86:87], v[86:87], v[210:211]
v_pk_mul_f32 v[88:89], v[88:89], v[212:213]
v_pk_mul_f32 v[90:91], v[90:91], v[214:215]
v_pk_mul_f32 v[92:93], v[92:93], v[216:217]
v_pk_mul_f32 v[94:95], v[94:95], v[218:219]
v_cvt_pk_bf16_f32 v220, v80, v81
v_cvt_pk_bf16_f32 v221, v82, v83
v_cvt_pk_bf16_f32 v222, v84, v85
v_cvt_pk_bf16_f32 v223, v86, v87
v_cvt_pk_bf16_f32 v224, v88, v89
v_cvt_pk_bf16_f32 v225, v90, v91
v_cvt_pk_bf16_f32 v226, v92, v93
v_cvt_pk_bf16_f32 v227, v94, v95
v_permlane32_swap_b32 v220, v222
v_permlane32_swap_b32 v221, v223
v_permlane32_swap_b32 v224, v226
v_permlane32_swap_b32 v225, v227
ds_write_b128 v186, v[220:223] offset:0
ds_write_b128 v186, v[224:227] offset:32
ds_read_b128 v[220:223], v187 offset:0
ds_read_b128 v[224:227], v187 offset:1280
v_pk_add_f32 v[176:177], v[176:177], v[80:81]
v_pk_fma_f32 v[178:179], v[80:81], v[80:81], v[178:179]
v_pk_add_f32 v[176:177], v[176:177], v[82:83]
v_pk_fma_f32 v[178:179], v[82:83], v[82:83], v[178:179]
v_pk_add_f32 v[176:177], v[176:177], v[84:85]
v_pk_fma_f32 v[178:179], v[84:85], v[84:85], v[178:179]
v_pk_add_f32 v[176:177], v[176:177], v[86:87]
v_pk_fma_f32 v[178:179], v[86:87], v[86:87], v[178:179]
v_pk_add_f32 v[176:177], v[176:177], v[88:89]
v_pk_fma_f32 v[178:179], v[88:89], v[88:89], v[178:179]
v_pk_add_f32 v[176:177], v[176:177], v[90:91]
v_pk_fma_f32 v[178:179], v[90:91], v[90:91], v[178:179]
v_pk_add_f32 v[176:177], v[176:177], v[92:93]
v_pk_fma_f32 v[178:179], v[92:93], v[92:93], v[178:179]
v_pk_add_f32 v[176:177], v[176:177], v[94:95]
v_pk_fma_f32 v[178:179], v[94:95], v[94:95], v[178:179]
v_pk_mul_f32 v[96:97], v[96:97], v[36:37] op_sel:[0,0] op_sel_hi:[1,0]
v_pk_mul_f32 v[98:99], v[98:99], v[36:37] op_sel:[0,0] op_sel_hi:[1,0]
v_pk_mul_f32 v[100:101], v[100:101], v[36:37] op_sel:[0,0] op_sel_hi:[1,0]
v_pk_mul_f32 v[102:103], v[102:103], v[36:37] op_sel:[0,0] op_sel_hi:[1,0]
v_pk_mul_f32 v[104:105], v[104:105], v[36:37] op_sel:[0,0] op_sel_hi:[1,0]
v_pk_mul_f32 v[106:107], v[106:107], v[36:37] op_sel:[0,0] op_sel_hi:[1,0]
v_pk_mul_f32 v[108:109], v[108:109], v[36:37] op_sel:[0,0] op_sel_hi:[1,0]
v_pk_mul_f32 v[110:111], v[110:111], v[36:37] op_sel:[0,0] op_sel_hi:[1,0]
v_pk_fma_f32 v[96:97], v[144:145], v[36:37], v[96:97] op_sel:[0,1,0] op_sel_hi:[1,1,1]
s_waitcnt lgkmcnt(0)
s_add_u32 s80, s70, 128000
buffer_store_dwordx4 v[220:223], v31, s[48:51], s80 offen offset:0 sc1
buffer_store_dwordx4 v[224:227], v31, s[48:51], s80 offen offset:1024 sc1
v_pk_fma_f32 v[98:99], v[146:147], v[36:37], v[98:99] op_sel:[0,1,0] op_sel_hi:[1,1,1]
v_pk_fma_f32 v[100:101], v[148:149], v[36:37], v[100:101] op_sel:[0,1,0] op_sel_hi:[1,1,1]
v_pk_fma_f32 v[102:103], v[150:151], v[36:37], v[102:103] op_sel:[0,1,0] op_sel_hi:[1,1,1]
v_pk_fma_f32 v[104:105], v[152:153], v[36:37], v[104:105] op_sel:[0,1,0] op_sel_hi:[1,1,1]
v_pk_fma_f32 v[106:107], v[154:155], v[36:37], v[106:107] op_sel:[0,1,0] op_sel_hi:[1,1,1]
v_pk_fma_f32 v[108:109], v[156:157], v[36:37], v[108:109] op_sel:[0,1,0] op_sel_hi:[1,1,1]
v_pk_fma_f32 v[110:111], v[158:159], v[36:37], v[110:111] op_sel:[0,1,0] op_sel_hi:[1,1,1]
v_pk_mul_f32 v[204:205], v[96:97], v[96:97]
v_pk_mul_f32 v[206:207], v[98:99], v[98:99]
v_pk_mul_f32 v[208:209], v[100:101], v[100:101]
v_pk_mul_f32 v[210:211], v[102:103], v[102:103]
v_pk_mul_f32 v[212:213], v[104:105], v[104:105]
v_pk_mul_f32 v[214:215], v[106:107], v[106:107]
v_pk_mul_f32 v[216:217], v[108:109], v[108:109]
v_pk_mul_f32 v[218:219], v[110:111], v[110:111]
v_pk_fma_f32 v[204:205], v[204:205], s[90:91], v[44:45]
v_pk_fma_f32 v[206:207], v[206:207], s[90:91], v[44:45]
v_pk_fma_f32 v[208:209], v[208:209], s[90:91], v[44:45]
v_pk_fma_f32 v[210:211], v[210:211], s[90:91], v[44:45]
v_pk_fma_f32 v[212:213], v[212:213], s[90:91], v[44:45]
v_pk_fma_f32 v[214:215], v[214:215], s[90:91], v[44:45]
v_pk_fma_f32 v[216:217], v[216:217], s[90:91], v[44:45]
v_pk_fma_f32 v[218:219], v[218:219], s[90:91], v[44:45]
v_pk_mul_f32 v[204:205], v[204:205], v[96:97]
v_pk_mul_f32 v[206:207], v[206:207], v[98:99]
v_pk_mul_f32 v[208:209], v[208:209], v[100:101]
v_pk_mul_f32 v[210:211], v[210:211], v[102:103]
v_pk_mul_f32 v[212:213], v[212:213], v[104:105]
v_pk_mul_f32 v[214:215], v[214:215], v[106:107]
v_pk_mul_f32 v[216:217], v[216:217], v[108:109]
v_pk_mul_f32 v[218:219], v[218:219], v[110:111]
v_exp_f32 v204, v204
v_exp_f32 v205, v205
v_exp_f32 v206, v206
v_exp_f32 v207, v207
v_exp_f32 v208, v208
v_exp_f32 v209, v209
v_exp_f32 v210, v210
v_exp_f32 v211, v211
v_exp_f32 v212, v212
v_exp_f32 v213, v213
v_exp_f32 v214, v214
v_exp_f32 v215, v215
v_exp_f32 v216, v216
v_exp_f32 v217, v217
v_exp_f32 v218, v218
v_exp_f32 v219, v219
v_pk_add_f32 v[204:205], v[204:205], v[42:43]
v_pk_add_f32 v[206:207], v[206:207], v[42:43]
v_pk_add_f32 v[208:209], v[208:209], v[42:43]
v_pk_add_f32 v[210:211], v[210:211], v[42:43]
v_pk_add_f32 v[212:213], v[212:213], v[42:43]
v_pk_add_f32 v[214:215], v[214:215], v[42:43]
v_pk_add_f32 v[216:217], v[216:217], v[42:43]
v_pk_add_f32 v[218:219], v[218:219], v[42:43]
v_rcp_f32 v204, v204
v_rcp_f32 v205, v205
v_rcp_f32 v206, v206
v_rcp_f32 v207, v207
v_rcp_f32 v208, v208
v_rcp_f32 v209, v209
v_rcp_f32 v210, v210
v_rcp_f32 v211, v211
v_rcp_f32 v212, v212
v_rcp_f32 v213, v213
v_rcp_f32 v214, v214
v_rcp_f32 v215, v215
v_rcp_f32 v216, v216
v_rcp_f32 v217, v217
v_rcp_f32 v218, v218
v_rcp_f32 v219, v219
v_pk_mul_f32 v[96:97], v[96:97], v[204:205]
v_pk_mul_f32 v[98:99], v[98:99], v[206:207]
v_pk_mul_f32 v[100:101], v[100:101], v[208:209]
v_pk_mul_f32 v[102:103], v[102:103], v[210:211]
v_pk_mul_f32 v[104:105], v[104:105], v[212:213]
v_pk_mul_f32 v[106:107], v[106:107], v[214:215]
v_pk_mul_f32 v[108:109], v[108:109], v[216:217]
v_pk_mul_f32 v[110:111], v[110:111], v[218:219]
v_cvt_pk_bf16_f32 v228, v96, v97
v_cvt_pk_bf16_f32 v229, v98, v99
v_cvt_pk_bf16_f32 v230, v100, v101
v_cvt_pk_bf16_f32 v231, v102, v103
v_cvt_pk_bf16_f32 v232, v104, v105
v_cvt_pk_bf16_f32 v233, v106, v107
v_cvt_pk_bf16_f32 v234, v108, v109
v_cvt_pk_bf16_f32 v235, v110, v111
v_permlane32_swap_b32 v228, v230
v_permlane32_swap_b32 v229, v231
v_permlane32_swap_b32 v232, v234
v_permlane32_swap_b32 v233, v235
ds_write_b128 v186, v[228:231] offset:2560
ds_write_b128 v186, v[232:235] offset:2592
ds_read_b128 v[228:231], v187 offset:2560
ds_read_b128 v[232:235], v187 offset:3840
v_pk_add_f32 v[180:181], v[180:181], v[96:97]
v_pk_fma_f32 v[182:183], v[96:97], v[96:97], v[182:183]
v_pk_add_f32 v[180:181], v[180:181], v[98:99]
v_pk_fma_f32 v[182:183], v[98:99], v[98:99], v[182:183]
v_pk_add_f32 v[180:181], v[180:181], v[100:101]
v_pk_fma_f32 v[182:183], v[100:101], v[100:101], v[182:183]
v_pk_add_f32 v[180:181], v[180:181], v[102:103]
v_pk_fma_f32 v[182:183], v[102:103], v[102:103], v[182:183]
v_pk_add_f32 v[180:181], v[180:181], v[104:105]
v_pk_fma_f32 v[182:183], v[104:105], v[104:105], v[182:183]
v_pk_add_f32 v[180:181], v[180:181], v[106:107]
v_pk_fma_f32 v[182:183], v[106:107], v[106:107], v[182:183]
v_pk_add_f32 v[180:181], v[180:181], v[108:109]
v_pk_fma_f32 v[182:183], v[108:109], v[108:109], v[182:183]
v_pk_add_f32 v[180:181], v[180:181], v[110:111]
v_pk_fma_f32 v[182:183], v[110:111], v[110:111], v[182:183]
s_waitcnt lgkmcnt(0)
s_add_u32 s80, s70, 128000
buffer_store_dwordx4 v[228:231], v31, s[48:51], s80 offen offset:2048 sc1
buffer_store_dwordx4 v[232:235], v32, s[48:51], s80 offen sc1
v_add_f32 v176, v176, v177
v_add_f32 v177, v178, v179
v_mov_b32 v178, v176
v_mov_b32 v179, v177
s_nop 0
v_permlane32_swap_b32 v176, v178
v_permlane32_swap_b32 v177, v179
v_pk_add_f32 v[176:177], v[176:177], v[178:179]
buffer_store_dwordx2 v[176:177], v184, s[48:51], s76 offen sc1
v_add_f32 v180, v180, v181
v_add_f32 v181, v182, v183
v_mov_b32 v182, v180
v_mov_b32 v183, v181
s_nop 0
v_permlane32_swap_b32 v180, v182
v_permlane32_swap_b32 v181, v183
v_pk_add_f32 v[180:181], v[180:181], v[182:183]
buffer_store_dwordx2 v[180:181], v185, s[48:51], s76 offen sc1
s_mov_b64 exec, -1
v_mov_b32 v3, 1
s_waitcnt vmcnt(0) lgkmcnt(0)
s_barrier
s_cmp_lg_u32 s28, 0
s_cbranch_scc1 L_p1_nopub_6
s_mov_b64 exec, 1
buffer_store_dword v3, off, s[48:51], s87 sc1
s_mov_b64 exec, -1
L_p1_nopub_6:
s_branch L_p2_start
L_p1_weights:
s_waitcnt lgkmcnt(0)
s_mov_b32 s48, s26
s_and_b32 s49, s27, 0xffff
s_mov_b32 s50, 0x1440000
s_mov_b32 s51, 0x20000
s_mov_b32 s52, s24
s_and_b32 s53, s25, 0xffff
s_mov_b32 s54, 0x100
s_mov_b32 s55, 0x20000
s_lshl_b32 s81, s81, 3
s_add_u32 s81, s81, s80
s_add_u32 s86, s81, 224
s_lshl_b32 s86, s86, 7
s_add_u32 s87, s86, 0xb58000
s_mov_b32 s78, s81
s_lshl_b32 s86, s78, 10
s_add_u32 s86, s86, 0xb50000
v_and_b32 v3, 7, v1
v_lshlrev_b32 v3, 7, v3
v_lshrrev_b32 v5, 3, v1
v_lshl_add_u32 v3, v5, 15, v3
v_mov_b32 v5, 0
s_mov_b64 exec, 0xffffff
buffer_store_dword v5, v3, s[48:51], s86 offen sc1
s_mov_b64 exec, -1
s_lshr_b32 s82, s78, 1
s_mov_b32 s68, s82
s_mul_i32 s82, s82, 128000
s_add_u32 s44, s4, s82
s_addc_u32 s45, s5, 0
s_and_b32 s45, s45, 0xffff
s_mov_b32 s46, 0x1f400
s_mov_b32 s47, 0x20000
s_and_b32 s83, s78, 1
s_lshl_b32 s83, s83, 6
s_lshl_b32 s84, s28, 4
s_add_u32 s83, s83, s84
v_lshrrev_b32 v31, 3, v1
v_add_u32 v31, s83, v31
v_lshrrev_b32 v32, 3, v1
v_add_u32 v32, s83, v32
v_add_u32 v32, 8, v32
v_lshlrev_b32 v2, 10, v31
v_and_b32 v3, 7, v1
v_lshl_add_u32 v2, v3, 4, v2
buffer_load_dwordx4 v[188:191], v2, s[44:47], 0 offen offset:0
buffer_load_dwordx4 v[192:195], v2, s[44:47], 0 offen offset:128
buffer_load_dwordx4 v[196:199], v2, s[44:47], 0 offen offset:256
buffer_load_dwordx4 v[200:203], v2, s[44:47], 0 offen offset:384
buffer_load_dwordx4 v[204:207], v2, s[44:47], 0 offen offset:512
buffer_load_dwordx4 v[208:211], v2, s[44:47], 0 offen offset:640
buffer_load_dwordx4 v[212:215], v2, s[44:47], 0 offen offset:768
buffer_load_dwordx4 v[216:219], v2, s[44:47], 0 offen offset:896
s_nop 0
v_lshlrev_b32 v2, 10, v32
v_and_b32 v3, 7, v1
v_lshl_add_u32 v2, v3, 4, v2
buffer_load_dwordx4 v[220:223], v2, s[44:47], 0 offen offset:0
buffer_load_dwordx4 v[224:227], v2, s[44:47], 0 offen offset:128
buffer_load_dwordx4 v[228:231], v2, s[44:47], 0 offen offset:256
buffer_load_dwordx4 v[232:235], v2, s[44:47], 0 offen offset:384
buffer_load_dwordx4 v[236:239], v2, s[44:47], 0 offen offset:512
buffer_load_dwordx4 v[240:243], v2, s[44:47], 0 offen offset:640
buffer_load_dwordx4 v[244:247], v2, s[44:47], 0 offen offset:768
buffer_load_dwordx4 v[248:251], v2, s[44:47], 0 offen offset:896
s_nop 0
s_lshr_b32 s82, s78, 4
s_cmp_eq_u32 s82, 0
s_cselect_b64 s[84:85], s[12:13], s[18:19]
s_lshr_b32 s83, s78, 2
s_and_b32 s83, s83, 3
s_lshl_b32 s83, s83, 17
s_add_u32 s32, s84, s83
s_addc_u32 s33, s85, 0
s_and_b32 s33, s33, 0xffff
s_mov_b32 s34, 0x20000
s_mov_b32 s35, 0x20000
s_lshr_b32 s82, s78, 4
s_lshl_b32 s82, s82, 19
s_and_b32 s83, s78, 3
s_lshl_b32 s83, s83, 8
s_add_u32 s83, s83, 0
s_sub_u32 s86, 0x80000, s83
s_add_u32 s83, s83, s82
s_add_u32 s36, s20, s83
s_addc_u32 s37, s21, 0
s_and_b32 s37, s37, 0xffff
s_mov_b32 s38, s86
s_mov_b32 s39, 0x20000
s_mov_b32 s73, 10
s_lshr_b32 s82, s78, 4
s_lshl_b32 s82, s82, 19
s_and_b32 s83, s78, 3
s_lshl_b32 s83, s83, 8
s_add_u32 s83, s83, 128
s_sub_u32 s86, 0x80000, s83
s_add_u32 s83, s83, s82
s_add_u32 s40, s20, s83
s_addc_u32 s41, s21, 0
s_and_b32 s41, s41, 0xffff
s_mov_b32 s42, s86
s_mov_b32 s43, 0x20000
s_mov_b32 s74, 10
v_lshrrev_b32 v2, 3, v1
v_lshrrev_b32 v3, 4, v1
v_and_b32 v4, 7, v1
v_xor_b32 v5, v4, v3
v_lshlrev_b32 v11, 10, v2
v_lshl_add_u32 v11, v5, 4, v11
s_lshl_b32 s80, s28, 15
v_add_u32 v11, s80, v11
v_xor_b32 v12, 64, v11
v_add_u32 v12, 0x2000, v12
v_add_u32 v13, 0x4000, v11
v_add_u32 v14, 0x4000, v12
v_and_b32 v3, 16, v1
v_lshlrev_b32 v3, 2, v3
v_lshlrev_b32 v4, 4, v4
v_xor_b32 v3, v3, v4
s_lshl_b32 s80, s28, 4
v_add_u32 v2, s80, v2
v_lshl_add_u32 v15, v2, s73, v3
s_lshl_b32 s80, 8, s73
v_add_u32 v16, s80, v15
s_lshl_b32 s63, s28, 12
s_lshl_b32 s64, s28, 11
s_add_u32 s64, s64, 65536
s_mov_b32 s56, 0
s_lshl_b32 s59, 64, s73
s_mov_b32 s57, 0
s_lshl_b32 s60, 64, s74
v_and_b32 v2, 31, v1
v_lshrrev_b32 v3, 1, v2
v_and_b32 v3, 7, v3
v_lshrrev_b32 v4, 5, v1
s_lshl_b32 s80, s29, 6
v_add_u32 v2, s80, v2
v_lshlrev_b32 v2, 7, v2
v_or_b32 v5, 0, v4
v_xor_b32 v5, v5, v3
v_lshl_add_u32 v21, v5, 4, v2
v_or_b32 v5, 2, v4
v_xor_b32 v5, v5, v3
v_lshl_add_u32 v22, v5, 4, v2
v_or_b32 v5, 4, v4
v_xor_b32 v5, v5, v3
v_lshl_add_u32 v23, v5, 4, v2
v_or_b32 v5, 6, v4
v_xor_b32 v5, v5, v3
v_lshl_add_u32 v24, v5, 4, v2
v_and_b32 v2, 15, v1
v_lshrrev_b32 v3, 2, v2
v_lshl_add_u32 v3, v4, 3, v3
v_lshlrev_b32 v3, 7, v3
v_and_b32 v5, 1, v2
v_lshl_add_u32 v3, v5, 3, v3
v_bfe_u32 v5, v1, 4, 1
v_lshlrev_b32 v5, 1, v5
v_bfe_u32 v4, v2, 1, 1
v_or_b32 v5, v5, v4
v_bfe_u32 v4, v2, 3, 1
v_lshlrev_b32 v4, 2, v4
v_xor_b32 v5, v5, v4
v_xor_b32 v25, 0, v5
v_lshl_add_u32 v25, v25, 4, v3
s_lshl_b32 s80, s30, 13
s_add_u32 s80, s80, 65536
v_add_u32 v25, s80, v25
v_xor_b32 v26, 0, v5
v_lshl_add_u32 v26, v26, 4, v3
s_lshl_b32 s80, s30, 13
s_add_u32 s80, s80, 114688
v_add_u32 v26, s80, v26
v_xor_b32 v27, 4, v5
v_lshl_add_u32 v27, v27, 4, v3
s_lshl_b32 s80, s30, 13
s_add_u32 s80, s80, 65536
v_add_u32 v27, s80, v27
v_xor_b32 v28, 4, v5
v_lshl_add_u32 v28, v28, 4, v3
s_lshl_b32 s80, s30, 13
s_add_u32 s80, s80, 114688
v_add_u32 v28, s80, v28
s_mov_b32 s62, 0
s_add_u32 m0, s63, 0
s_nop 0
buffer_load_dwordx4 v11, s[32:35], s62 offen lds
s_add_u32 m0, s63, 1024
s_nop 0
buffer_load_dwordx4 v12, s[32:35], s62 offen lds
s_add_u32 m0, s63, 2048
s_nop 0
buffer_load_dwordx4 v13, s[32:35], s62 offen lds
s_add_u32 m0, s63, 3072
s_nop 0
buffer_load_dwordx4 v14, s[32:35], s62 offen lds
s_add_u32 m0, s64, 0
s_nop 0
buffer_load_dwordx4 v15, s[36:39], s56 offen lds
s_add_u32 m0, s64, 1024
s_nop 0
buffer_load_dwordx4 v16, s[36:39], s56 offen lds
s_add_u32 s56, s56, s59
s_add_u32 m0, s64, 8192
s_nop 0
buffer_load_dwordx4 v15, s[40:43], s57 offen lds
s_add_u32 m0, s64, 9216
s_nop 0
buffer_load_dwordx4 v16, s[40:43], s57 offen lds
s_add_u32 s57, s57, s60
v_mov_b32 v42, 0x3f803f80
s_waitcnt vmcnt(8)
v_dot2_f32_bf16 v34, v188, v42, 0
v_dot2_f32_bf16 v35, v188, v188, 0
v_dot2_f32_bf16 v34, v189, v42, v34
v_dot2_f32_bf16 v35, v189, v189, v35
v_dot2_f32_bf16 v34, v190, v42, v34
v_dot2_f32_bf16 v35, v190, v190, v35
v_dot2_f32_bf16 v34, v191, v42, v34
v_dot2_f32_bf16 v35, v191, v191, v35
v_dot2_f32_bf16 v34, v192, v42, v34
v_dot2_f32_bf16 v35, v192, v192, v35
v_dot2_f32_bf16 v34, v193, v42, v34
v_dot2_f32_bf16 v35, v193, v193, v35
v_dot2_f32_bf16 v34, v194, v42, v34
v_dot2_f32_bf16 v35, v194, v194, v35
v_dot2_f32_bf16 v34, v195, v42, v34
v_dot2_f32_bf16 v35, v195, v195, v35
v_dot2_f32_bf16 v34, v196, v42, v34
v_dot2_f32_bf16 v35, v196, v196, v35
v_dot2_f32_bf16 v34, v197, v42, v34
v_dot2_f32_bf16 v35, v197, v197, v35
v_dot2_f32_bf16 v34, v198, v42, v34
v_dot2_f32_bf16 v35, v198, v198, v35
v_dot2_f32_bf16 v34, v199, v42, v34
v_dot2_f32_bf16 v35, v199, v199, v35
v_dot2_f32_bf16 v34, v200, v42, v34
v_dot2_f32_bf16 v35, v200, v200, v35
v_dot2_f32_bf16 v34, v201, v42, v34
v_dot2_f32_bf16 v35, v201, v201, v35
v_dot2_f32_bf16 v34, v202, v42, v34
v_dot2_f32_bf16 v35, v202, v202, v35
v_dot2_f32_bf16 v34, v203, v42, v34
v_dot2_f32_bf16 v35, v203, v203, v35
v_dot2_f32_bf16 v34, v204, v42, v34
v_dot2_f32_bf16 v35, v204, v204, v35
v_dot2_f32_bf16 v34, v205, v42, v34
v_dot2_f32_bf16 v35, v205, v205, v35
v_dot2_f32_bf16 v34, v206, v42, v34
v_dot2_f32_bf16 v35, v206, v206, v35
v_dot2_f32_bf16 v34, v207, v42, v34
v_dot2_f32_bf16 v35, v207, v207, v35
v_dot2_f32_bf16 v34, v208, v42, v34
v_dot2_f32_bf16 v35, v208, v208, v35
v_dot2_f32_bf16 v34, v209, v42, v34
v_dot2_f32_bf16 v35, v209, v209, v35
v_dot2_f32_bf16 v34, v210, v42, v34
v_dot2_f32_bf16 v35, v210, v210, v35
v_dot2_f32_bf16 v34, v211, v42, v34
v_dot2_f32_bf16 v35, v211, v211, v35
v_dot2_f32_bf16 v34, v212, v42, v34
v_dot2_f32_bf16 v35, v212, v212, v35
v_dot2_f32_bf16 v34, v213, v42, v34
v_dot2_f32_bf16 v35, v213, v213, v35
v_dot2_f32_bf16 v34, v214, v42, v34
v_dot2_f32_bf16 v35, v214, v214, v35
v_dot2_f32_bf16 v34, v215, v42, v34
v_dot2_f32_bf16 v35, v215, v215, v35
v_dot2_f32_bf16 v34, v216, v42, v34
v_dot2_f32_bf16 v35, v216, v216, v35
v_dot2_f32_bf16 v34, v217, v42, v34
v_dot2_f32_bf16 v35, v217, v217, v35
v_dot2_f32_bf16 v34, v218, v42, v34
v_dot2_f32_bf16 v35, v218, v218, v35
v_dot2_f32_bf16 v34, v219, v42, v34
v_dot2_f32_bf16 v35, v219, v219, v35
v_dot2_f32_bf16 v36, v220, v42, 0
v_dot2_f32_bf16 v37, v220, v220, 0
v_dot2_f32_bf16 v36, v221, v42, v36
v_dot2_f32_bf16 v37, v221, v221, v37
v_dot2_f32_bf16 v36, v222, v42, v36
v_dot2_f32_bf16 v37, v222, v222, v37
v_dot2_f32_bf16 v36, v223, v42, v36
v_dot2_f32_bf16 v37, v223, v223, v37
v_dot2_f32_bf16 v36, v224, v42, v36
v_dot2_f32_bf16 v37, v224, v224, v37
v_dot2_f32_bf16 v36, v225, v42, v36
v_dot2_f32_bf16 v37, v225, v225, v37
v_dot2_f32_bf16 v36, v226, v42, v36
v_dot2_f32_bf16 v37, v226, v226, v37
v_dot2_f32_bf16 v36, v227, v42, v36
v_dot2_f32_bf16 v37, v227, v227, v37
v_dot2_f32_bf16 v36, v228, v42, v36
v_dot2_f32_bf16 v37, v228, v228, v37
v_dot2_f32_bf16 v36, v229, v42, v36
v_dot2_f32_bf16 v37, v229, v229, v37
v_dot2_f32_bf16 v36, v230, v42, v36
v_dot2_f32_bf16 v37, v230, v230, v37
v_dot2_f32_bf16 v36, v231, v42, v36
v_dot2_f32_bf16 v37, v231, v231, v37
v_dot2_f32_bf16 v36, v232, v42, v36
v_dot2_f32_bf16 v37, v232, v232, v37
v_dot2_f32_bf16 v36, v233, v42, v36
v_dot2_f32_bf16 v37, v233, v233, v37
v_dot2_f32_bf16 v36, v234, v42, v36
v_dot2_f32_bf16 v37, v234, v234, v37
v_dot2_f32_bf16 v36, v235, v42, v36
v_dot2_f32_bf16 v37, v235, v235, v37
v_dot2_f32_bf16 v36, v236, v42, v36
v_dot2_f32_bf16 v37, v236, v236, v37
v_dot2_f32_bf16 v36, v237, v42, v36
v_dot2_f32_bf16 v37, v237, v237, v37
v_dot2_f32_bf16 v36, v238, v42, v36
v_dot2_f32_bf16 v37, v238, v238, v37
v_dot2_f32_bf16 v36, v239, v42, v36
v_dot2_f32_bf16 v37, v239, v239, v37
v_dot2_f32_bf16 v36, v240, v42, v36
v_dot2_f32_bf16 v37, v240, v240, v37
v_dot2_f32_bf16 v36, v241, v42, v36
v_dot2_f32_bf16 v37, v241, v241, v37
v_dot2_f32_bf16 v36, v242, v42, v36
v_dot2_f32_bf16 v37, v242, v242, v37
v_dot2_f32_bf16 v36, v243, v42, v36
v_dot2_f32_bf16 v37, v243, v243, v37
v_dot2_f32_bf16 v36, v244, v42, v36
v_dot2_f32_bf16 v37, v244, v244, v37
v_dot2_f32_bf16 v36, v245, v42, v36
v_dot2_f32_bf16 v37, v245, v245, v37
v_dot2_f32_bf16 v36, v246, v42, v36
v_dot2_f32_bf16 v37, v246, v246, v37
v_dot2_f32_bf16 v36, v247, v42, v36
v_dot2_f32_bf16 v37, v247, v247, v37
v_dot2_f32_bf16 v36, v248, v42, v36
v_dot2_f32_bf16 v37, v248, v248, v37
v_dot2_f32_bf16 v36, v249, v42, v36
v_dot2_f32_bf16 v37, v249, v249, v37
v_dot2_f32_bf16 v36, v250, v42, v36
v_dot2_f32_bf16 v37, v250, v250, v37
v_dot2_f32_bf16 v36, v251, v42, v36
v_dot2_f32_bf16 v37, v251, v251, v37
v_add_f32_dpp v34, v34, v34 quad_perm:[1,0,3,2] row_mask:0xf bank_mask:0xf
v_add_f32_dpp v35, v35, v35 quad_perm:[1,0,3,2] row_mask:0xf bank_mask:0xf
v_add_f32_dpp v36, v36, v36 quad_perm:[1,0,3,2] row_mask:0xf bank_mask:0xf
v_add_f32_dpp v37, v37, v37 quad_perm:[1,0,3,2] row_mask:0xf bank_mask:0xf
v_add_f32_dpp v34, v34, v34 quad_perm:[2,3,0,1] row_mask:0xf bank_mask:0xf
v_add_f32_dpp v35, v35, v35 quad_perm:[2,3,0,1] row_mask:0xf bank_mask:0xf
v_add_f32_dpp v36, v36, v36 quad_perm:[2,3,0,1] row_mask:0xf bank_mask:0xf
v_add_f32_dpp v37, v37, v37 quad_perm:[2,3,0,1] row_mask:0xf bank_mask:0xf
v_add_f32_dpp v34, v34, v34 row_half_mirror row_mask:0xf bank_mask:0xf
v_add_f32_dpp v35, v35, v35 row_half_mirror row_mask:0xf bank_mask:0xf
v_add_f32_dpp v36, v36, v36 row_half_mirror row_mask:0xf bank_mask:0xf
v_add_f32_dpp v37, v37, v37 row_half_mirror row_mask:0xf bank_mask:0xf
v_mul_f32 v34, 0x3b000000, v34
v_mul_f32 v35, 0x3b000000, v35
v_fma_f32 v35, -v34, v34, v35
v_max_f32 v35, 0, v35
v_add_f32 v35, 0x3727c5ac, v35
v_rsq_f32 v35, v35
s_nop 0
v_mul_f32 v3, v34, v35
v_sub_f32 v3, 0, v3
v_cmp_gt_u32 vcc, 125, v31
s_nop 1
v_cndmask_b32 v34, 0, v35, vcc
v_cndmask_b32 v35, 0, v3, vcc
s_lshl_b32 s82, s68, 10
s_add_u32 s82, s82, 0xb00000
v_lshlrev_b32 v2, 3, v31
v_add_u32 v2, s82, v2
v_and_b32 v3, 7, v1
v_cmp_eq_u32 vcc, 0, v3
v_mov_b32 v3, 0x7ff00000
s_nop 0
v_cndmask_b32 v2, v3, v2, vcc
buffer_store_dwordx2 v[34:35], v2, s[48:51], 0 offen sc1
s_nop 1
v_mul_f32 v36, 0x3b000000, v36
v_mul_f32 v37, 0x3b000000, v37
v_fma_f32 v37, -v36, v36, v37
v_max_f32 v37, 0, v37
v_add_f32 v37, 0x3727c5ac, v37
v_rsq_f32 v37, v37
s_nop 0
v_mul_f32 v3, v36, v37
v_sub_f32 v3, 0, v3
v_cmp_gt_u32 vcc, 125, v32
s_nop 1
v_cndmask_b32 v36, 0, v37, vcc
v_cndmask_b32 v37, 0, v3, vcc
s_lshl_b32 s82, s68, 10
s_add_u32 s82, s82, 0xb00000
v_lshlrev_b32 v2, 3, v32
v_add_u32 v2, s82, v2
v_and_b32 v3, 7, v1
v_cmp_eq_u32 vcc, 0, v3
v_mov_b32 v3, 0x7ff00000
s_nop 0
v_cndmask_b32 v2, v3, v2, vcc
buffer_store_dwordx2 v[36:37], v2, s[48:51], 0 offen sc1
s_nop 1
s_mov_b32 s62, 128
s_add_u32 m0, s63, 16384
s_nop 0
buffer_load_dwordx4 v11, s[32:35], s62 offen lds
s_add_u32 m0, s63, 17408
s_nop 0
buffer_load_dwordx4 v12, s[32:35], s62 offen lds
s_add_u32 m0, s63, 18432
s_nop 0
buffer_load_dwordx4 v13, s[32:35], s62 offen lds
s_add_u32 m0, s63, 19456
s_nop 0
buffer_load_dwordx4 v14, s[32:35], s62 offen lds
s_add_u32 m0, s64, 24576
s_nop 0
buffer_load_dwordx4 v15, s[36:39], s56 offen lds
s_add_u32 m0, s64, 25600
s_nop 0
buffer_load_dwordx4 v16, s[36:39], s56 offen lds
s_add_u32 s56, s56, s59
s_add_u32 m0, s64, 32768
s_nop 0
buffer_load_dwordx4 v15, s[40:43], s57 offen lds
s_add_u32 m0, s64, 33792
s_nop 0
buffer_load_dwordx4 v16, s[40:43], s57 offen lds
s_add_u32 s57, s57, s60
s_waitcnt vmcnt(8)
s_barrier
s_lshl_b32 s82, s68, 2
v_mov_b32 v2, s82
v_mov_b32 v3, 1
s_cmp_lg_u32 s28, 0
s_cbranch_scc1 L_p1_nopub
s_mov_b64 exec, 1
buffer_atomic_add v3, v2, s[52:55], 0 offen
buffer_atomic_add v3, off, s[52:55], 0 offset:128
s_mov_b64 exec, -1
L_p1_nopub:
s_waitcnt vmcnt(10) lgkmcnt(0)
s_barrier
ds_read_b128 v[144:147], v21 offset:0
ds_read_b64_tr_b16 v[160:161], v25 offset:0
ds_read_b64_tr_b16 v[162:163], v25 offset:512
ds_read_b128 v[148:151], v21 offset:4096
ds_read_b64_tr_b16 v[164:165], v27 offset:0
ds_read_b64_tr_b16 v[166:167], v27 offset:512
s_waitcnt lgkmcnt(0)
v_mfma_f32_32x32x16_bf16 v[48:63], v[144:147], v[160:163], 0
ds_read_b128 v[152:155], v22 offset:0
ds_read_b64_tr_b16 v[172:173], v25 offset:2048
s_mov_b32 s62, 256
v_mfma_f32_32x32x16_bf16 v[64:79], v[148:151], v[160:163], 0
ds_read_b64_tr_b16 v[174:175], v25 offset:2560
ds_read_b128 v[156:159], v22 offset:4096
v_mfma_f32_32x32x16_bf16 v[80:95], v[144:147], v[164:167], 0
ds_read_b64_tr_b16 v[176:177], v27 offset:2048
ds_read_b64_tr_b16 v[178:179], v27 offset:2560
s_add_u32 m0, s63, 32768
s_nop 0
buffer_load_dwordx4 v11, s[32:35], s62 offen lds
v_mfma_f32_32x32x16_bf16 v[96:111], v[148:151], v[164:167], 0
s_waitcnt lgkmcnt(0)
v_mfma_f32_32x32x16_bf16 v[48:63], v[152:155], v[172:175], v[48:63]
ds_read_b128 v[144:147], v23 offset:0
ds_read_b64_tr_b16 v[160:161], v25 offset:4096
s_add_u32 m0, s63, 33792
s_nop 0
buffer_load_dwordx4 v12, s[32:35], s62 offen lds
v_mfma_f32_32x32x16_bf16 v[64:79], v[156:159], v[172:175], v[64:79]
ds_read_b64_tr_b16 v[162:163], v25 offset:4608
ds_read_b128 v[148:151], v23 offset:4096
s_add_u32 m0, s63, 34816
s_nop 0
buffer_load_dwordx4 v13, s[32:35], s62 offen lds
v_mfma_f32_32x32x16_bf16 v[80:95], v[152:155], v[176:179], v[80:95]
ds_read_b64_tr_b16 v[164:165], v27 offset:4096
ds_read_b64_tr_b16 v[166:167], v27 offset:4608
s_add_u32 m0, s63, 35840
s_nop 0
buffer_load_dwordx4 v14, s[32:35], s62 offen lds
v_mfma_f32_32x32x16_bf16 v[96:111], v[156:159], v[176:179], v[96:111]
s_waitcnt lgkmcnt(0)
v_mfma_f32_32x32x16_bf16 v[48:63], v[144:147], v[160:163], v[48:63]
ds_read_b128 v[152:155], v24 offset:0
ds_read_b64_tr_b16 v[172:173], v25 offset:6144
s_add_u32 m0, s64, 49152
s_nop 0
buffer_load_dwordx4 v15, s[36:39], s56 offen lds
v_mfma_f32_32x32x16_bf16 v[64:79], v[148:151], v[160:163], v[64:79]
ds_read_b64_tr_b16 v[174:175], v25 offset:6656
ds_read_b128 v[156:159], v24 offset:4096
s_add_u32 m0, s64, 50176
s_nop 0
buffer_load_dwordx4 v16, s[36:39], s56 offen lds
v_mfma_f32_32x32x16_bf16 v[80:95], v[144:147], v[164:167], v[80:95]
ds_read_b64_tr_b16 v[176:177], v27 offset:6144
ds_read_b64_tr_b16 v[178:179], v27 offset:6656
s_add_u32 s56, s56, s59
v_mfma_f32_32x32x16_bf16 v[96:111], v[148:151], v[164:167], v[96:111]
s_waitcnt lgkmcnt(0)
v_mfma_f32_32x32x16_bf16 v[48:63], v[152:155], v[172:175], v[48:63]
v_mfma_f32_32x32x16_bf16 v[64:79], v[156:159], v[172:175], v[64:79]
s_waitcnt vmcnt(6)
s_barrier
v_mfma_f32_32x32x16_bf16 v[80:95], v[152:155], v[176:179], v[80:95]
ds_read_b128 v[144:147], v21 offset:16384
ds_read_b64_tr_b16 v[160:161], v25 offset:24576
ds_read_b64_tr_b16 v[162:163], v25 offset:25088
ds_read_b128 v[148:151], v21 offset:20480
ds_read_b64_tr_b16 v[164:165], v27 offset:24576
v_mfma_f32_32x32x16_bf16 v[96:111], v[156:159], v[176:179], v[96:111]
ds_read_b64_tr_b16 v[166:167], v27 offset:25088
s_add_u32 m0, s64, 57344
s_nop 0
buffer_load_dwordx4 v15, s[40:43], s57 offen lds
s_add_u32 m0, s64, 58368
s_nop 0
buffer_load_dwordx4 v16, s[40:43], s57 offen lds
s_add_u32 s57, s57, s60
s_waitcnt lgkmcnt(0)
v_mfma_f32_32x32x16_bf16 v[48:63], v[144:147], v[160:163], v[48:63]
ds_read_b128 v[152:155], v22 offset:16384
ds_read_b64_tr_b16 v[172:173], v25 offset:26624
s_mov_b32 s62, 384
v_mfma_f32_32x32x16_bf16 v[64:79], v[148:151], v[160:163], v[64:79]
ds_read_b64_tr_b16 v[174:175], v25 offset:27136
ds_read_b128 v[156:159], v22 offset:20480
v_mfma_f32_32x32x16_bf16 v[80:95], v[144:147], v[164:167], v[80:95]
ds_read_b64_tr_b16 v[176:177], v27 offset:26624
ds_read_b64_tr_b16 v[178:179], v27 offset:27136
s_add_u32 m0, s63, 49152
s_nop 0
buffer_load_dwordx4 v11, s[32:35], s62 offen lds
v_mfma_f32_32x32x16_bf16 v[96:111], v[148:151], v[164:167], v[96:111]
s_waitcnt lgkmcnt(0)
v_mfma_f32_32x32x16_bf16 v[48:63], v[152:155], v[172:175], v[48:63]
ds_read_b128 v[144:147], v23 offset:16384
ds_read_b64_tr_b16 v[160:161], v25 offset:28672
s_add_u32 m0, s63, 50176
s_nop 0
buffer_load_dwordx4 v12, s[32:35], s62 offen lds
v_mfma_f32_32x32x16_bf16 v[64:79], v[156:159], v[172:175], v[64:79]
ds_read_b64_tr_b16 v[162:163], v25 offset:29184
ds_read_b128 v[148:151], v23 offset:20480
s_add_u32 m0, s63, 51200
s_nop 0
buffer_load_dwordx4 v13, s[32:35], s62 offen lds
v_mfma_f32_32x32x16_bf16 v[80:95], v[152:155], v[176:179], v[80:95]
ds_read_b64_tr_b16 v[164:165], v27 offset:28672
ds_read_b64_tr_b16 v[166:167], v27 offset:29184
s_add_u32 m0, s63, 52224
s_nop 0
buffer_load_dwordx4 v14, s[32:35], s62 offen lds
v_mfma_f32_32x32x16_bf16 v[96:111], v[156:159], v[176:179], v[96:111]
s_waitcnt lgkmcnt(0)
v_mfma_f32_32x32x16_bf16 v[48:63], v[144:147], v[160:163], v[48:63]
ds_read_b128 v[152:155], v24 offset:16384
ds_read_b64_tr_b16 v[172:173], v25 offset:30720
s_add_u32 m0, s64, 73728
s_nop 0
buffer_load_dwordx4 v15, s[36:39], s56 offen lds
v_mfma_f32_32x32x16_bf16 v[64:79], v[148:151], v[160:163], v[64:79]
ds_read_b64_tr_b16 v[174:175], v25 offset:31232
ds_read_b128 v[156:159], v24 offset:20480
s_add_u32 m0, s64, 74752
s_nop 0
buffer_load_dwordx4 v16, s[36:39], s56 offen lds
v_mfma_f32_32x32x16_bf16 v[80:95], v[144:147], v[164:167], v[80:95]
ds_read_b64_tr_b16 v[176:177], v27 offset:30720
ds_read_b64_tr_b16 v[178:179], v27 offset:31232
s_add_u32 s56, s56, s59
v_mfma_f32_32x32x16_bf16 v[96:111], v[148:151], v[164:167], v[96:111]
s_waitcnt lgkmcnt(0)
v_mfma_f32_32x32x16_bf16 v[48:63], v[152:155], v[172:175], v[48:63]
v_mfma_f32_32x32x16_bf16 v[64:79], v[156:159], v[172:175], v[64:79]
s_waitcnt vmcnt(6)
s_barrier
v_mfma_f32_32x32x16_bf16 v[80:95], v[152:155], v[176:179], v[80:95]
ds_read_b128 v[144:147], v21 offset:32768
ds_read_b64_tr_b16 v[160:161], v26 offset:0
ds_read_b64_tr_b16 v[162:163], v26 offset:512
ds_read_b128 v[148:151], v21 offset:36864
ds_read_b64_tr_b16 v[164:165], v28 offset:0
v_mfma_f32_32x32x16_bf16 v[96:111], v[156:159], v[176:179], v[96:111]
ds_read_b64_tr_b16 v[166:167], v28 offset:512
s_add_u32 m0, s64, 81920
s_nop 0
buffer_load_dwordx4 v15, s[40:43], s57 offen lds
s_add_u32 m0, s64, 82944
s_nop 0
buffer_load_dwordx4 v16, s[40:43], s57 offen lds
s_add_u32 s57, s57, s60
s_waitcnt lgkmcnt(0)
v_mfma_f32_32x32x16_bf16 v[48:63], v[144:147], v[160:163], v[48:63]
ds_read_b128 v[152:155], v22 offset:32768
ds_read_b64_tr_b16 v[172:173], v26 offset:2048
s_mov_b32 s62, 512
v_mfma_f32_32x32x16_bf16 v[64:79], v[148:151], v[160:163], v[64:79]
ds_read_b64_tr_b16 v[174:175], v26 offset:2560
ds_read_b128 v[156:159], v22 offset:36864
v_mfma_f32_32x32x16_bf16 v[80:95], v[144:147], v[164:167], v[80:95]
ds_read_b64_tr_b16 v[176:177], v28 offset:2048
ds_read_b64_tr_b16 v[178:179], v28 offset:2560
s_add_u32 m0, s63, 0
s_nop 0
buffer_load_dwordx4 v11, s[32:35], s62 offen lds
v_mfma_f32_32x32x16_bf16 v[96:111], v[148:151], v[164:167], v[96:111]
s_waitcnt lgkmcnt(0)
v_mfma_f32_32x32x16_bf16 v[48:63], v[152:155], v[172:175], v[48:63]
ds_read_b128 v[144:147], v23 offset:32768
ds_read_b64_tr_b16 v[160:161], v26 offset:4096
s_add_u32 m0, s63, 1024
s_nop 0
buffer_load_dwordx4 v12, s[32:35], s62 offen lds
v_mfma_f32_32x32x16_bf16 v[64:79], v[156:159], v[172:175], v[64:79]
ds_read_b64_tr_b16 v[162:163], v26 offset:4608
ds_read_b128 v[148:151], v23 offset:36864
s_add_u32 m0, s63, 2048
s_nop 0
buffer_load_dwordx4 v13, s[32:35], s62 offen lds
v_mfma_f32_32x32x16_bf16 v[80:95], v[152:155], v[176:179], v[80:95]
ds_read_b64_tr_b16 v[164:165], v28 offset:4096
ds_read_b64_tr_b16 v[166:167], v28 offset:4608
s_add_u32 m0, s63, 3072
s_nop 0
buffer_load_dwordx4 v14, s[32:35], s62 offen lds
v_mfma_f32_32x32x16_bf16 v[96:111], v[156:159], v[176:179], v[96:111]
s_waitcnt lgkmcnt(0)
v_mfma_f32_32x32x16_bf16 v[48:63], v[144:147], v[160:163], v[48:63]
ds_read_b128 v[152:155], v24 offset:32768
ds_read_b64_tr_b16 v[172:173], v26 offset:6144
s_add_u32 m0, s64, 0
s_nop 0
buffer_load_dwordx4 v15, s[36:39], s56 offen lds
v_mfma_f32_32x32x16_bf16 v[64:79], v[148:151], v[160:163], v[64:79]
ds_read_b64_tr_b16 v[174:175], v26 offset:6656
ds_read_b128 v[156:159], v24 offset:36864
s_add_u32 m0, s64, 1024
s_nop 0
buffer_load_dwordx4 v16, s[36:39], s56 offen lds
v_mfma_f32_32x32x16_bf16 v[80:95], v[144:147], v[164:167], v[80:95]
ds_read_b64_tr_b16 v[176:177], v28 offset:6144
ds_read_b64_tr_b16 v[178:179], v28 offset:6656
s_add_u32 s56, s56, s59
v_mfma_f32_32x32x16_bf16 v[96:111], v[148:151], v[164:167], v[96:111]
s_waitcnt lgkmcnt(0)
v_mfma_f32_32x32x16_bf16 v[48:63], v[152:155], v[172:175], v[48:63]
v_mfma_f32_32x32x16_bf16 v[64:79], v[156:159], v[172:175], v[64:79]
s_waitcnt vmcnt(6)
s_barrier
v_mfma_f32_32x32x16_bf16 v[80:95], v[152:155], v[176:179], v[80:95]
ds_read_b128 v[144:147], v21 offset:49152
ds_read_b64_tr_b16 v[160:161], v26 offset:24576
ds_read_b64_tr_b16 v[162:163], v26 offset:25088
ds_read_b128 v[148:151], v21 offset:53248
ds_read_b64_tr_b16 v[164:165], v28 offset:24576
v_mfma_f32_32x32x16_bf16 v[96:111], v[156:159], v[176:179], v[96:111]
ds_read_b64_tr_b16 v[166:167], v28 offset:25088
s_add_u32 m0, s64, 8192
s_nop 0
buffer_load_dwordx4 v15, s[40:43], s57 offen lds
s_add_u32 m0, s64, 9216
s_nop 0
buffer_load_dwordx4 v16, s[40:43], s57 offen lds
s_add_u32 s57, s57, s60
s_waitcnt lgkmcnt(0)
v_mfma_f32_32x32x16_bf16 v[48:63], v[144:147], v[160:163], v[48:63]
ds_read_b128 v[152:155], v22 offset:49152
ds_read_b64_tr_b16 v[172:173], v26 offset:26624
s_mov_b32 s62, 640
v_mfma_f32_32x32x16_bf16 v[64:79], v[148:151], v[160:163], v[64:79]
ds_read_b64_tr_b16 v[174:175], v26 offset:27136
ds_read_b128 v[156:159], v22 offset:53248
v_mfma_f32_32x32x16_bf16 v[80:95], v[144:147], v[164:167], v[80:95]
ds_read_b64_tr_b16 v[176:177], v28 offset:26624
ds_read_b64_tr_b16 v[178:179], v28 offset:27136
s_add_u32 m0, s63, 16384
s_nop 0
buffer_load_dwordx4 v11, s[32:35], s62 offen lds
v_mfma_f32_32x32x16_bf16 v[96:111], v[148:151], v[164:167], v[96:111]
s_waitcnt lgkmcnt(0)
v_mfma_f32_32x32x16_bf16 v[48:63], v[152:155], v[172:175], v[48:63]
ds_read_b128 v[144:147], v23 offset:49152
ds_read_b64_tr_b16 v[160:161], v26 offset:28672
s_add_u32 m0, s63, 17408
s_nop 0
buffer_load_dwordx4 v12, s[32:35], s62 offen lds
v_mfma_f32_32x32x16_bf16 v[64:79], v[156:159], v[172:175], v[64:79]
ds_read_b64_tr_b16 v[162:163], v26 offset:29184
ds_read_b128 v[148:151], v23 offset:53248
s_add_u32 m0, s63, 18432
s_nop 0
buffer_load_dwordx4 v13, s[32:35], s62 offen lds
v_mfma_f32_32x32x16_bf16 v[80:95], v[152:155], v[176:179], v[80:95]
ds_read_b64_tr_b16 v[164:165], v28 offset:28672
ds_read_b64_tr_b16 v[166:167], v28 offset:29184
s_add_u32 m0, s63, 19456
s_nop 0
buffer_load_dwordx4 v14, s[32:35], s62 offen lds
v_mfma_f32_32x32x16_bf16 v[96:111], v[156:159], v[176:179], v[96:111]
s_waitcnt lgkmcnt(0)
v_mfma_f32_32x32x16_bf16 v[48:63], v[144:147], v[160:163], v[48:63]
ds_read_b128 v[152:155], v24 offset:49152
ds_read_b64_tr_b16 v[172:173], v26 offset:30720
s_add_u32 m0, s64, 24576
s_nop 0
buffer_load_dwordx4 v15, s[36:39], s56 offen lds
v_mfma_f32_32x32x16_bf16 v[64:79], v[148:151], v[160:163], v[64:79]
ds_read_b64_tr_b16 v[174:175], v26 offset:31232
ds_read_b128 v[156:159], v24 offset:53248
s_add_u32 m0, s64, 25600
s_nop 0
buffer_load_dwordx4 v16, s[36:39], s56 offen lds
v_mfma_f32_32x32x16_bf16 v[80:95], v[144:147], v[164:167], v[80:95]
ds_read_b64_tr_b16 v[176:177], v28 offset:30720
ds_read_b64_tr_b16 v[178:179], v28 offset:31232
s_add_u32 s56, s56, s59
v_mfma_f32_32x32x16_bf16 v[96:111], v[148:151], v[164:167], v[96:111]
s_waitcnt lgkmcnt(0)
v_mfma_f32_32x32x16_bf16 v[48:63], v[152:155], v[172:175], v[48:63]
v_mfma_f32_32x32x16_bf16 v[64:79], v[156:159], v[172:175], v[64:79]
s_waitcnt vmcnt(6)
s_barrier
v_mfma_f32_32x32x16_bf16 v[80:95], v[152:155], v[176:179], v[80:95]
ds_read_b128 v[144:147], v21 offset:0
ds_read_b64_tr_b16 v[160:161], v25 offset:0
ds_read_b64_tr_b16 v[162:163], v25 offset:512
ds_read_b128 v[148:151], v21 offset:4096
ds_read_b64_tr_b16 v[164:165], v27 offset:0
v_mfma_f32_32x32x16_bf16 v[96:111], v[156:159], v[176:179], v[96:111]
ds_read_b64_tr_b16 v[166:167], v27 offset:512
s_add_u32 m0, s64, 32768
s_nop 0
buffer_load_dwordx4 v15, s[40:43], s57 offen lds
s_add_u32 m0, s64, 33792
s_nop 0
buffer_load_dwordx4 v16, s[40:43], s57 offen lds
s_add_u32 s57, s57, s60
s_waitcnt lgkmcnt(0)
v_mfma_f32_32x32x16_bf16 v[48:63], v[144:147], v[160:163], v[48:63]
ds_read_b128 v[152:155], v22 offset:0
ds_read_b64_tr_b16 v[172:173], v25 offset:2048
s_mov_b32 s62, 768
v_mfma_f32_32x32x16_bf16 v[64:79], v[148:151], v[160:163], v[64:79]
ds_read_b64_tr_b16 v[174:175], v25 offset:2560
ds_read_b128 v[156:159], v22 offset:4096
v_mfma_f32_32x32x16_bf16 v[80:95], v[144:147], v[164:167], v[80:95]
ds_read_b64_tr_b16 v[176:177], v27 offset:2048
ds_read_b64_tr_b16 v[178:179], v27 offset:2560
s_add_u32 m0, s63, 32768
s_nop 0
buffer_load_dwordx4 v11, s[32:35], s62 offen lds
v_mfma_f32_32x32x16_bf16 v[96:111], v[148:151], v[164:167], v[96:111]
s_waitcnt lgkmcnt(0)
v_mfma_f32_32x32x16_bf16 v[48:63], v[152:155], v[172:175], v[48:63]
ds_read_b128 v[144:147], v23 offset:0
ds_read_b64_tr_b16 v[160:161], v25 offset:4096
s_add_u32 m0, s63, 33792
s_nop 0
buffer_load_dwordx4 v12, s[32:35], s62 offen lds
v_mfma_f32_32x32x16_bf16 v[64:79], v[156:159], v[172:175], v[64:79]
ds_read_b64_tr_b16 v[162:163], v25 offset:4608
ds_read_b128 v[148:151], v23 offset:4096
s_add_u32 m0, s63, 34816
s_nop 0
buffer_load_dwordx4 v13, s[32:35], s62 offen lds
v_mfma_f32_32x32x16_bf16 v[80:95], v[152:155], v[176:179], v[80:95]
ds_read_b64_tr_b16 v[164:165], v27 offset:4096
ds_read_b64_tr_b16 v[166:167], v27 offset:4608
s_add_u32 m0, s63, 35840
s_nop 0
buffer_load_dwordx4 v14, s[32:35], s62 offen lds
v_mfma_f32_32x32x16_bf16 v[96:111], v[156:159], v[176:179], v[96:111]
s_waitcnt lgkmcnt(0)
v_mfma_f32_32x32x16_bf16 v[48:63], v[144:147], v[160:163], v[48:63]
ds_read_b128 v[152:155], v24 offset:0
ds_read_b64_tr_b16 v[172:173], v25 offset:6144
s_add_u32 m0, s64, 49152
s_nop 0
buffer_load_dwordx4 v15, s[36:39], s56 offen lds
v_mfma_f32_32x32x16_bf16 v[64:79], v[148:151], v[160:163], v[64:79]
ds_read_b64_tr_b16 v[174:175], v25 offset:6656
ds_read_b128 v[156:159], v24 offset:4096
s_add_u32 m0, s64, 50176
s_nop 0
buffer_load_dwordx4 v16, s[36:39], s56 offen lds
v_mfma_f32_32x32x16_bf16 v[80:95], v[144:147], v[164:167], v[80:95]
ds_read_b64_tr_b16 v[176:177], v27 offset:6144
ds_read_b64_tr_b16 v[178:179], v27 offset:6656
s_add_u32 s56, s56, s59
v_mfma_f32_32x32x16_bf16 v[96:111], v[148:151], v[164:167], v[96:111]
s_waitcnt lgkmcnt(0)
v_mfma_f32_32x32x16_bf16 v[48:63], v[152:155], v[172:175], v[48:63]
v_mfma_f32_32x32x16_bf16 v[64:79], v[156:159], v[172:175], v[64:79]
s_waitcnt vmcnt(6)
s_barrier
v_mfma_f32_32x32x16_bf16 v[80:95], v[152:155], v[176:179], v[80:95]
ds_read_b128 v[144:147], v21 offset:16384
ds_read_b64_tr_b16 v[160:161], v25 offset:24576
ds_read_b64_tr_b16 v[162:163], v25 offset:25088
ds_read_b128 v[148:151], v21 offset:20480
ds_read_b64_tr_b16 v[164:165], v27 offset:24576
v_mfma_f32_32x32x16_bf16 v[96:111], v[156:159], v[176:179], v[96:111]
ds_read_b64_tr_b16 v[166:167], v27 offset:25088
s_add_u32 m0, s64, 57344
s_nop 0
buffer_load_dwordx4 v15, s[40:43], s57 offen lds
s_add_u32 m0, s64, 58368
s_nop 0
buffer_load_dwordx4 v16, s[40:43], s57 offen lds
s_add_u32 s57, s57, s60
s_waitcnt lgkmcnt(0)
v_mfma_f32_32x32x16_bf16 v[48:63], v[144:147], v[160:163], v[48:63]
ds_read_b128 v[152:155], v22 offset:16384
ds_read_b64_tr_b16 v[172:173], v25 offset:26624
s_mov_b32 s62, 896
v_mfma_f32_32x32x16_bf16 v[64:79], v[148:151], v[160:163], v[64:79]
ds_read_b64_tr_b16 v[174:175], v25 offset:27136
ds_read_b128 v[156:159], v22 offset:20480
v_mfma_f32_32x32x16_bf16 v[80:95], v[144:147], v[164:167], v[80:95]
ds_read_b64_tr_b16 v[176:177], v27 offset:26624
ds_read_b64_tr_b16 v[178:179], v27 offset:27136
s_add_u32 m0, s63, 49152
s_nop 0
buffer_load_dwordx4 v11, s[32:35], s62 offen lds
v_mfma_f32_32x32x16_bf16 v[96:111], v[148:151], v[164:167], v[96:111]
s_waitcnt lgkmcnt(0)
v_mfma_f32_32x32x16_bf16 v[48:63], v[152:155], v[172:175], v[48:63]
ds_read_b128 v[144:147], v23 offset:16384
ds_read_b64_tr_b16 v[160:161], v25 offset:28672
s_add_u32 m0, s63, 50176
s_nop 0
buffer_load_dwordx4 v12, s[32:35], s62 offen lds
v_mfma_f32_32x32x16_bf16 v[64:79], v[156:159], v[172:175], v[64:79]
ds_read_b64_tr_b16 v[162:163], v25 offset:29184
ds_read_b128 v[148:151], v23 offset:20480
s_add_u32 m0, s63, 51200
s_nop 0
buffer_load_dwordx4 v13, s[32:35], s62 offen lds
v_mfma_f32_32x32x16_bf16 v[80:95], v[152:155], v[176:179], v[80:95]
ds_read_b64_tr_b16 v[164:165], v27 offset:28672
ds_read_b64_tr_b16 v[166:167], v27 offset:29184
s_add_u32 m0, s63, 52224
s_nop 0
buffer_load_dwordx4 v14, s[32:35], s62 offen lds
v_mfma_f32_32x32x16_bf16 v[96:111], v[156:159], v[176:179], v[96:111]
s_waitcnt lgkmcnt(0)
v_mfma_f32_32x32x16_bf16 v[48:63], v[144:147], v[160:163], v[48:63]
ds_read_b128 v[152:155], v24 offset:16384
ds_read_b64_tr_b16 v[172:173], v25 offset:30720
s_add_u32 m0, s64, 73728
s_nop 0
buffer_load_dwordx4 v15, s[36:39], s56 offen lds
v_mfma_f32_32x32x16_bf16 v[64:79], v[148:151], v[160:163], v[64:79]
ds_read_b64_tr_b16 v[174:175], v25 offset:31232
ds_read_b128 v[156:159], v24 offset:20480
s_add_u32 m0, s64, 74752
s_nop 0
buffer_load_dwordx4 v16, s[36:39], s56 offen lds
v_mfma_f32_32x32x16_bf16 v[80:95], v[144:147], v[164:167], v[80:95]
ds_read_b64_tr_b16 v[176:177], v27 offset:30720
ds_read_b64_tr_b16 v[178:179], v27 offset:31232
s_add_u32 s56, s56, s59
v_mfma_f32_32x32x16_bf16 v[96:111], v[148:151], v[164:167], v[96:111]
s_waitcnt lgkmcnt(0)
v_mfma_f32_32x32x16_bf16 v[48:63], v[152:155], v[172:175], v[48:63]
v_mfma_f32_32x32x16_bf16 v[64:79], v[156:159], v[172:175], v[64:79]
s_waitcnt vmcnt(6)
s_barrier
v_mfma_f32_32x32x16_bf16 v[80:95], v[152:155], v[176:179], v[80:95]
ds_read_b128 v[144:147], v21 offset:32768
ds_read_b64_tr_b16 v[160:161], v26 offset:0
ds_read_b64_tr_b16 v[162:163], v26 offset:512
ds_read_b128 v[148:151], v21 offset:36864
ds_read_b64_tr_b16 v[164:165], v28 offset:0
v_mfma_f32_32x32x16_bf16 v[96:111], v[156:159], v[176:179], v[96:111]
ds_read_b64_tr_b16 v[166:167], v28 offset:512
s_add_u32 m0, s64, 81920
s_nop 0
buffer_load_dwordx4 v15, s[40:43], s57 offen lds
s_add_u32 m0, s64, 82944
s_nop 0
buffer_load_dwordx4 v16, s[40:43], s57 offen lds
s_add_u32 s57, s57, s60
s_waitcnt lgkmcnt(0)
v_mfma_f32_32x32x16_bf16 v[48:63], v[144:147], v[160:163], v[48:63]
ds_read_b128 v[152:155], v22 offset:32768
ds_read_b64_tr_b16 v[172:173], v26 offset:2048
buffer_load_dword v4, off, s[52:55], 0 offset:128 sc1
v_mfma_f32_32x32x16_bf16 v[64:79], v[148:151], v[160:163], v[64:79]
ds_read_b64_tr_b16 v[174:175], v26 offset:2560
ds_read_b128 v[156:159], v22 offset:36864
v_mfma_f32_32x32x16_bf16 v[80:95], v[144:147], v[164:167], v[80:95]
ds_read_b64_tr_b16 v[176:177], v28 offset:2048
ds_read_b64_tr_b16 v[178:179], v28 offset:2560
v_mfma_f32_32x32x16_bf16 v[96:111], v[148:151], v[164:167], v[96:111]
s_waitcnt lgkmcnt(0)
v_mfma_f32_32x32x16_bf16 v[48:63], v[152:155], v[172:175], v[48:63]
ds_read_b128 v[144:147], v23 offset:32768
ds_read_b64_tr_b16 v[160:161], v26 offset:4096
v_mfma_f32_32x32x16_bf16 v[64:79], v[156:159], v[172:175], v[64:79]
ds_read_b64_tr_b16 v[162:163], v26 offset:4608
ds_read_b128 v[148:151], v23 offset:36864
v_mfma_f32_32x32x16_bf16 v[80:95], v[152:155], v[176:179], v[80:95]
ds_read_b64_tr_b16 v[164:165], v28 offset:4096
ds_read_b64_tr_b16 v[166:167], v28 offset:4608
v_mfma_f32_32x32x16_bf16 v[96:111], v[156:159], v[176:179], v[96:111]
s_waitcnt lgkmcnt(0)
v_mfma_f32_32x32x16_bf16 v[48:63], v[144:147], v[160:163], v[48:63]
ds_read_b128 v[152:155], v24 offset:32768
ds_read_b64_tr_b16 v[172:173], v26 offset:6144
v_mfma_f32_32x32x16_bf16 v[64:79], v[148:151], v[160:163], v[64:79]
ds_read_b64_tr_b16 v[174:175], v26 offset:6656
ds_read_b128 v[156:159], v24 offset:36864
v_mfma_f32_32x32x16_bf16 v[80:95], v[144:147], v[164:167], v[80:95]
ds_read_b64_tr_b16 v[176:177], v28 offset:6144
ds_read_b64_tr_b16 v[178:179], v28 offset:6656
v_mfma_f32_32x32x16_bf16 v[96:111], v[148:151], v[164:167], v[96:111]
s_waitcnt lgkmcnt(0)
v_mfma_f32_32x32x16_bf16 v[48:63], v[152:155], v[172:175], v[48:63]
v_mfma_f32_32x32x16_bf16 v[64:79], v[156:159], v[172:175], v[64:79]
s_waitcnt vmcnt(1)
s_barrier
v_mfma_f32_32x32x16_bf16 v[80:95], v[152:155], v[176:179], v[80:95]
ds_read_b128 v[144:147], v21 offset:49152
ds_read_b64_tr_b16 v[160:161], v26 offset:24576
ds_read_b64_tr_b16 v[162:163], v26 offset:25088
v_mfma_f32_32x32x16_bf16 v[96:111], v[156:159], v[176:179], v[96:111]
ds_read_b128 v[148:151], v21 offset:53248
ds_read_b64_tr_b16 v[164:165], v28 offset:24576
ds_read_b64_tr_b16 v[166:167], v28 offset:25088
s_waitcnt lgkmcnt(0)
v_mfma_f32_32x32x16_bf16 v[48:63], v[144:147], v[160:163], v[48:63]
ds_read_b128 v[152:155], v22 offset:49152
ds_read_b64_tr_b16 v[172:173], v26 offset:26624
v_mfma_f32_32x32x16_bf16 v[64:79], v[148:151], v[160:163], v[64:79]
ds_read_b64_tr_b16 v[174:175], v26 offset:27136
ds_read_b128 v[156:159], v22 offset:53248
v_mfma_f32_32x32x16_bf16 v[80:95], v[144:147], v[164:167], v[80:95]
ds_read_b64_tr_b16 v[176:177], v28 offset:26624
ds_read_b64_tr_b16 v[178:179], v28 offset:27136
v_mfma_f32_32x32x16_bf16 v[96:111], v[148:151], v[164:167], v[96:111]
s_waitcnt vmcnt(0)
v_readfirstlane_b32 s82, v4
s_nop 3
s_cmp_ge_u32 s82, 32
s_cbranch_scc1 L_p1_wz_ok
s_mov_b32 s79, 0x100000
L_p1_wz:
s_sleep 4
buffer_load_dword v4, off, s[52:55], 0 offset:128 sc1
s_waitcnt vmcnt(0)
v_readfirstlane_b32 s82, v4
s_nop 3
s_cmp_ge_u32 s82, 32
s_cbranch_scc1 L_p1_wz_ok
s_sub_u32 s79, s79, 1
s_cmp_eq_u32 s79, 0
s_cbranch_scc0 L_p1_wz
L_p1_wz_ok:
s_waitcnt lgkmcnt(0)
v_mfma_f32_32x32x16_bf16 v[48:63], v[152:155], v[172:175], v[48:63]
ds_read_b128 v[144:147], v23 offset:49152
ds_read_b64_tr_b16 v[160:161], v26 offset:28672
v_mfma_f32_32x32x16_bf16 v[64:79], v[156:159], v[172:175], v[64:79]
ds_read_b64_tr_b16 v[162:163], v26 offset:29184
ds_read_b128 v[148:151], v23 offset:53248
v_mfma_f32_32x32x16_bf16 v[80:95], v[152:155], v[176:179], v[80:95]
ds_read_b64_tr_b16 v[164:165], v28 offset:28672
ds_read_b64_tr_b16 v[166:167], v28 offset:29184
v_mfma_f32_32x32x16_bf16 v[96:111], v[156:159], v[176:179], v[96:111]
s_waitcnt lgkmcnt(0)
v_mfma_f32_32x32x16_bf16 v[48:63], v[144:147], v[160:163], v[48:63]
ds_read_b128 v[152:155], v24 offset:49152
ds_read_b64_tr_b16 v[172:173], v26 offset:30720
v_mfma_f32_32x32x16_bf16 v[64:79], v[148:151], v[160:163], v[64:79]
ds_read_b64_tr_b16 v[174:175], v26 offset:31232
ds_read_b128 v[156:159], v24 offset:53248
v_mfma_f32_32x32x16_bf16 v[80:95], v[144:147], v[164:167], v[80:95]
ds_read_b64_tr_b16 v[176:177], v28 offset:30720
ds_read_b64_tr_b16 v[178:179], v28 offset:31232
v_mfma_f32_32x32x16_bf16 v[96:111], v[148:151], v[164:167], v[96:111]
s_waitcnt lgkmcnt(0)
v_mfma_f32_32x32x16_bf16 v[48:63], v[152:155], v[172:175], v[48:63]
v_mfma_f32_32x32x16_bf16 v[64:79], v[156:159], v[172:175], v[64:79]
v_mfma_f32_32x32x16_bf16 v[80:95], v[152:155], v[176:179], v[80:95]
v_mfma_f32_32x32x16_bf16 v[96:111], v[156:159], v[176:179], v[96:111]
s_lshr_b32 s82, s78, 4
s_lshl_b32 s82, s82, 19
s_add_u32 s82, s82, 0x9e8000
s_and_b32 s83, s78, 3
s_lshl_b32 s83, s83, 2
s_lshl_b32 s84, s30, 1
s_add_u32 s83, s83, s84
s_lshl_b32 s83, s83, 15
s_add_u32 s82, s82, s83
s_lshr_b32 s83, s78, 2
s_and_b32 s83, s83, 3
s_lshl_b32 s83, s83, 2
s_lshl_b32 s84, s29, 1
s_add_u32 s83, s83, s84
s_lshl_b32 s83, s83, 11
s_add_u32 s82, s82, s83
v_lshlrev_b32 v6, 4, v1
v_cvt_pk_bf16_f32 v220, v48, v49
v_cvt_pk_bf16_f32 v221, v50, v51
v_cvt_pk_bf16_f32 v222, v52, v53
v_cvt_pk_bf16_f32 v223, v54, v55
v_cvt_pk_bf16_f32 v224, v56, v57
v_cvt_pk_bf16_f32 v225, v58, v59
v_cvt_pk_bf16_f32 v226, v60, v61
v_cvt_pk_bf16_f32 v227, v62, v63
s_add_u32 s80, s82, 0
buffer_store_dwordx4 v[220:223], v6, s[48:51], s80 offen offset:0 sc1
buffer_store_dwordx4 v[224:227], v6, s[48:51], s80 offen offset:1024 sc1
v_cvt_pk_bf16_f32 v228, v64, v65
v_cvt_pk_bf16_f32 v229, v66, v67
v_cvt_pk_bf16_f32 v230, v68, v69
v_cvt_pk_bf16_f32 v231, v70, v71
v_cvt_pk_bf16_f32 v232, v72, v73
v_cvt_pk_bf16_f32 v233, v74, v75
v_cvt_pk_bf16_f32 v234, v76, v77
v_cvt_pk_bf16_f32 v235, v78, v79
s_add_u32 s80, s82, 2048
buffer_store_dwordx4 v[228:231], v6, s[48:51], s80 offen offset:0 sc1
buffer_store_dwordx4 v[232:235], v6, s[48:51], s80 offen offset:1024 sc1
v_cvt_pk_bf16_f32 v220, v80, v81
v_cvt_pk_bf16_f32 v221, v82, v83
v_cvt_pk_bf16_f32 v222, v84, v85
v_cvt_pk_bf16_f32 v223, v86, v87
v_cvt_pk_bf16_f32 v224, v88, v89
v_cvt_pk_bf16_f32 v225, v90, v91
v_cvt_pk_bf16_f32 v226, v92, v93
v_cvt_pk_bf16_f32 v227, v94, v95
s_add_u32 s80, s82, 32768
buffer_store_dwordx4 v[220:223], v6, s[48:51], s80 offen offset:0 sc1
buffer_store_dwordx4 v[224:227], v6, s[48:51], s80 offen offset:1024 sc1
v_cvt_pk_bf16_f32 v228, v96, v97
v_cvt_pk_bf16_f32 v229, v98, v99
v_cvt_pk_bf16_f32 v230, v100, v101
v_cvt_pk_bf16_f32 v231, v102, v103
v_cvt_pk_bf16_f32 v232, v104, v105
v_cvt_pk_bf16_f32 v233, v106, v107
v_cvt_pk_bf16_f32 v234, v108, v109
v_cvt_pk_bf16_f32 v235, v110, v111
s_add_u32 s80, s82, 34816
buffer_store_dwordx4 v[228:231], v6, s[48:51], s80 offen offset:0 sc1
buffer_store_dwordx4 v[232:235], v6, s[48:51], s80 offen offset:1024 sc1
s_mov_b64 exec, -1
v_mov_b32 v3, 1
s_waitcnt vmcnt(0) lgkmcnt(0)
s_barrier
s_cmp_lg_u32 s28, 0
s_cbranch_scc1 L_p1_nopub_7
s_mov_b64 exec, 1
buffer_store_dword v3, off, s[48:51], s87 sc1
s_mov_b64 exec, -1
L_p1_nopub_7:
s_branch L_p2_start
L_EXIT_p1:
s_waitcnt vmcnt(0)
s_endpgm
L_p2_start:
v_and_b32 v1, 63, v0
v_lshrrev_b32 v3, 6, v0
v_lshlrev_b32 v2, 4, v1
v_readfirstlane_b32 s28, v3
s_and_b32 s48, s2, 7
s_lshr_b32 s49, s2, 3
s_lshr_b32 s40, s48, 2
s_cmp_lt_u32 s49, 8
s_cbranch_scc1 L_p2_conv
s_sub_u32 s49, s49, 8
v_add_u32 v9, 0x10000, v2
v_mov_b32 v8, v2
s_lshl_b32 s60, s28, 15
s_cmp_ge_u32 s49, 16
s_cbranch_scc1 L_p2_vsetup
s_and_b32 s50, s48, 1
s_lshl_b32 s50, s50, 2
s_and_b32 s51, s49, 3
s_add_u32 s50, s50, s51
s_lshr_b32 s51, s48, 1
s_and_b32 s51, s51, 1
s_lshl_b32 s51, s51, 2
s_lshr_b32 s52, s49, 2
s_add_u32 s51, s51, s52
s_lshl_b32 s53, s40, 3
s_add_u32 s53, s53, s50
s_lshl_b32 s53, s53, 3
s_add_u32 s65, s53, s51
s_lshl_b32 s65, s65, 7
s_add_u32 s65, s65, 0xb50000
s_add_u32 s53, s50, s51
s_mov_b32 s63, 0
s_lshl_b32 s52, s40, 3
s_add_u32 s53, s52, s51
s_lshl_b32 s53, s53, 2
s_add_u32 s53, s53, s28
s_lshl_b32 s53, s53, 15
s_add_u32 s41, s53, 0x200000
s_add_u32 s53, s52, s50
s_lshl_b32 s53, s53, 2
s_add_u32 s53, s53, s28
s_lshl_b32 s54, s53, 15
s_add_u32 s42, s54, 0x0
s_lshl_b32 s54, s53, 16
s_lshl_b32 s55, s51, 13
s_add_u32 s54, s54, s55
s_add_u32 s43, s54, 0xc00000
s_add_u32 s54, s52, s51
s_lshl_b32 s54, s54, 10
s_lshl_b32 s55, s50, 7
s_add_u32 s54, s54, s55
s_lshl_b32 s55, s28, 5
s_add_u32 s54, s54, s55
s_lshl_b32 s54, s54, 3
s_add_u32 s44, s54, 0x1400000
s_waitcnt lgkmcnt(0)
s_mov_b32 s32, s26
s_and_b32 s33, s27, 0xffff
s_mov_b32 s34, 0x1440000
s_mov_b32 s35, 0x20000
s_lshl_b32 s52, s40, 3
s_add_u32 s53, s52, s50
s_mul_i32 s53, s53, 14
s_add_u32 s54, s52, s51
s_mul_i32 s54, s54, 14
v_mov_b32 v5, s54
v_mov_b32 v6, s53
v_cmp_gt_u32 vcc, 4, v1
s_nop 1
v_cndmask_b32 v5, v5, v6, vcc
v_add_u32 v5, v5, v1
v_lshlrev_b32 v5, 7, v5
v_add_u32 v5, 0xb58000, v5
v_mov_b32 v6, 0x7ff00000
v_cmp_gt_u32 vcc, 8, v1
s_nop 1
v_cndmask_b32 v5, v6, v5, vcc
s_mov_b32 s66, 0x100000
L_p2_pps_8:
buffer_load_dword v6, v5, s[32:35], 0 offen sc1
s_waitcnt vmcnt(0)
v_cmp_eq_u32 vcc, 1, v6
s_nop 4
s_and_b32 vcc_lo, vcc_lo, 0xff
s_cmp_lg_u32 vcc_lo, 0xff
s_cbranch_scc1 L_p2_ppns_10
s_branch L_p2_ppoks_9
L_p2_ppns_10:
s_sub_u32 s66, s66, 1
s_cmp_eq_u32 s66, 0
s_cbranch_scc1 L_p2_ppoks_9
s_sleep 2
s_branch L_p2_pps_8
L_p2_ppoks_9:
s_add_u32 s61, s41, s63
s_add_u32 s62, s42, s63
s_add_u32 m0, s60, 0
s_add_u32 s63, s63, 4096
s_and_b32 s63, s63, 0x7fff
buffer_load_dwordx4 v2, s[32:35], s61 offen offset:0 sc1 lds
buffer_load_dwordx4 a[0:3], v2, s[32:35], s62 offen offset:0 sc1
buffer_load_dwordx4 v2, s[32:35], s61 offen offset:1024 sc1 lds
buffer_load_dwordx4 a[4:7], v2, s[32:35], s62 offen offset:1024 sc1
buffer_load_dwordx4 v2, s[32:35], s61 offen offset:2048 sc1 lds
buffer_load_dwordx4 a[8:11], v2, s[32:35], s62 offen offset:2048 sc1
buffer_load_dwordx4 v2, s[32:35], s61 offen offset:3072 sc1 lds
buffer_load_dwordx4 a[12:15], v2, s[32:35], s62 offen offset:3072 sc1
s_add_u32 s61, s41, s63
s_add_u32 s62, s42, s63
s_add_u32 m0, s60, 4096
s_add_u32 s63, s63, 4096
s_and_b32 s63, s63, 0x7fff
buffer_load_dwordx4 v2, s[32:35], s61 offen offset:0 sc1 lds
buffer_load_dwordx4 a[16:19], v2, s[32:35], s62 offen offset:0 sc1
buffer_load_dwordx4 v2, s[32:35], s61 offen offset:1024 sc1 lds
buffer_load_dwordx4 a[20:23], v2, s[32:35], s62 offen offset:1024 sc1
buffer_load_dwordx4 v2, s[32:35], s61 offen offset:2048 sc1 lds
buffer_load_dwordx4 a[24:27], v2, s[32:35], s62 offen offset:2048 sc1
buffer_load_dwordx4 v2, s[32:35], s61 offen offset:3072 sc1 lds
buffer_load_dwordx4 a[28:31], v2, s[32:35], s62 offen offset:3072 sc1
s_waitcnt vmcnt(8)
s_barrier
ds_read_b128 v[76:79], v8 offset:0
ds_read_b128 v[80:83], v8 offset:32768
ds_read_b128 v[84:87], v9 offset:0
ds_read_b128 v[88:91], v9 offset:32768
s_waitcnt lgkmcnt(0)
v_mfma_f32_32x32x16_bf16 v[12:27], v[76:79], a[0:3], 0
ds_read_b128 v[92:95], v8 offset:1024
ds_read_b128 v[96:99], v8 offset:33792
v_mfma_f32_32x32x16_bf16 v[28:43], v[80:83], a[0:3], 0
s_add_u32 s61, s41, s63
s_add_u32 s62, s42, s63
s_add_u32 m0, s60, 8192
s_add_u32 s63, s63, 4096
s_and_b32 s63, s63, 0x7fff
ds_read_b128 v[100:103], v9 offset:1024
v_mfma_f32_32x32x16_bf16 v[44:59], v[84:87], a[0:3], 0
ds_read_b128 v[104:107], v9 offset:33792
buffer_load_dwordx4 v2, s[32:35], s61 offen offset:0 sc1 lds
v_mfma_f32_32x32x16_bf16 v[60:75], v[88:91], a[0:3], 0
buffer_load_dwordx4 a[32:35], v2, s[32:35], s62 offen offset:0 sc1
s_waitcnt lgkmcnt(0)
v_mfma_f32_32x32x16_bf16 v[12:27], v[92:95], a[4:7], v[12:27]
ds_read_b128 v[76:79], v8 offset:2048
ds_read_b128 v[80:83], v8 offset:34816
v_mfma_f32_32x32x16_bf16 v[28:43], v[96:99], a[4:7], v[28:43]
buffer_load_dwordx4 v2, s[32:35], s61 offen offset:1024 sc1 lds
v_mfma_f32_32x32x16_bf16 v[44:59], v[100:103], a[4:7], v[44:59]
ds_read_b128 v[84:87], v9 offset:2048
ds_read_b128 v[88:91], v9 offset:34816
v_mfma_f32_32x32x16_bf16 v[60:75], v[104:107], a[4:7], v[60:75]
buffer_load_dwordx4 a[36:39], v2, s[32:35], s62 offen offset:1024 sc1
s_waitcnt lgkmcnt(0)
v_mfma_f32_32x32x16_bf16 v[12:27], v[76:79], a[8:11], v[12:27]
ds_read_b128 v[92:95], v8 offset:3072
ds_read_b128 v[96:99], v8 offset:35840
v_mfma_f32_32x32x16_bf16 v[28:43], v[80:83], a[8:11], v[28:43]
buffer_load_dwordx4 v2, s[32:35], s61 offen offset:2048 sc1 lds
v_mfma_f32_32x32x16_bf16 v[44:59], v[84:87], a[8:11], v[44:59]
ds_read_b128 v[100:103], v9 offset:3072
ds_read_b128 v[104:107], v9 offset:35840
v_mfma_f32_32x32x16_bf16 v[60:75], v[88:91], a[8:11], v[60:75]
buffer_load_dwordx4 a[40:43], v2, s[32:35], s62 offen offset:2048 sc1
s_waitcnt lgkmcnt(0)
v_mfma_f32_32x32x16_bf16 v[12:27], v[92:95], a[12:15], v[12:27]
s_waitcnt vmcnt(6)
s_barrier
v_mfma_f32_32x32x16_bf16 v[28:43], v[96:99], a[12:15], v[28:43]
ds_read_b128 v[76:79], v8 offset:4096
ds_read_b128 v[80:83], v8 offset:36864
v_mfma_f32_32x32x16_bf16 v[44:59], v[100:103], a[12:15], v[44:59]
ds_read_b128 v[84:87], v9 offset:4096
ds_read_b128 v[88:91], v9 offset:36864
v_mfma_f32_32x32x16_bf16 v[60:75], v[104:107], a[12:15], v[60:75]
buffer_load_dwordx4 v2, s[32:35], s61 offen offset:3072 sc1 lds
buffer_load_dwordx4 a[44:47], v2, s[32:35], s62 offen offset:3072 sc1
s_waitcnt lgkmcnt(0)
v_mfma_f32_32x32x16_bf16 v[12:27], v[76:79], a[16:19], v[12:27]
ds_read_b128 v[92:95], v8 offset:5120
ds_read_b128 v[96:99], v8 offset:37888
v_mfma_f32_32x32x16_bf16 v[28:43], v[80:83], a[16:19], v[28:43]
s_add_u32 s61, s41, s63
s_add_u32 s62, s42, s63
s_add_u32 m0, s60, 12288
s_add_u32 s63, s63, 4096
s_and_b32 s63, s63, 0x7fff
ds_read_b128 v[100:103], v9 offset:5120
v_mfma_f32_32x32x16_bf16 v[44:59], v[84:87], a[16:19], v[44:59]
ds_read_b128 v[104:107], v9 offset:37888
buffer_load_dwordx4 v2, s[32:35], s61 offen offset:0 sc1 lds
v_mfma_f32_32x32x16_bf16 v[60:75], v[88:91], a[16:19], v[60:75]
buffer_load_dwordx4 a[48:51], v2, s[32:35], s62 offen offset:0 sc1
s_waitcnt lgkmcnt(0)
v_mfma_f32_32x32x16_bf16 v[12:27], v[92:95], a[20:23], v[12:27]
ds_read_b128 v[76:79], v8 offset:6144
ds_read_b128 v[80:83], v8 offset:38912
v_mfma_f32_32x32x16_bf16 v[28:43], v[96:99], a[20:23], v[28:43]
buffer_load_dwordx4 v2, s[32:35], s61 offen offset:1024 sc1 lds
v_mfma_f32_32x32x16_bf16 v[44:59], v[100:103], a[20:23], v[44:59]
ds_read_b128 v[84:87], v9 offset:6144
ds_read_b128 v[88:91], v9 offset:38912
v_mfma_f32_32x32x16_bf16 v[60:75], v[104:107], a[20:23], v[60:75]
buffer_load_dwordx4 a[52:55], v2, s[32:35], s62 offen offset:1024 sc1
s_waitcnt lgkmcnt(0)
v_mfma_f32_32x32x16_bf16 v[12:27], v[76:79], a[24:27], v[12:27]
ds_read_b128 v[92:95], v8 offset:7168
ds_read_b128 v[96:99], v8 offset:39936
v_mfma_f32_32x32x16_bf16 v[28:43], v[80:83], a[24:27], v[28:43]
buffer_load_dwordx4 v2, s[32:35], s61 offen offset:2048 sc1 lds
v_mfma_f32_32x32x16_bf16 v[44:59], v[84:87], a[24:27], v[44:59]
ds_read_b128 v[100:103], v9 offset:7168
ds_read_b128 v[104:107], v9 offset:39936
v_mfma_f32_32x32x16_bf16 v[60:75], v[88:91], a[24:27], v[60:75]
buffer_load_dwordx4 a[56:59], v2, s[32:35], s62 offen offset:2048 sc1
s_waitcnt lgkmcnt(0)
v_mfma_f32_32x32x16_bf16 v[12:27], v[92:95], a[28:31], v[12:27]
s_waitcnt vmcnt(6)
s_barrier
v_mfma_f32_32x32x16_bf16 v[28:43], v[96:99], a[28:31], v[28:43]
ds_read_b128 v[76:79], v8 offset:8192
ds_read_b128 v[80:83], v8 offset:40960
v_mfma_f32_32x32x16_bf16 v[44:59], v[100:103], a[28:31], v[44:59]
ds_read_b128 v[84:87], v9 offset:8192
ds_read_b128 v[88:91], v9 offset:40960
v_mfma_f32_32x32x16_bf16 v[60:75], v[104:107], a[28:31], v[60:75]
buffer_load_dwordx4 v2, s[32:35], s61 offen offset:3072 sc1 lds
buffer_load_dwordx4 a[60:63], v2, s[32:35], s62 offen offset:3072 sc1
s_waitcnt lgkmcnt(0)
v_mfma_f32_32x32x16_bf16 v[12:27], v[76:79], a[32:35], v[12:27]
ds_read_b128 v[92:95], v8 offset:9216
ds_read_b128 v[96:99], v8 offset:41984
v_mfma_f32_32x32x16_bf16 v[28:43], v[80:83], a[32:35], v[28:43]
s_add_u32 s61, s41, s63
s_add_u32 s62, s42, s63
s_add_u32 m0, s60, 16384
s_add_u32 s63, s63, 4096
s_and_b32 s63, s63, 0x7fff
ds_read_b128 v[100:103], v9 offset:9216
v_mfma_f32_32x32x16_bf16 v[44:59], v[84:87], a[32:35], v[44:59]
ds_read_b128 v[104:107], v9 offset:41984
buffer_load_dwordx4 v2, s[32:35], s61 offen offset:0 sc1 lds
v_mfma_f32_32x32x16_bf16 v[60:75], v[88:91], a[32:35], v[60:75]
buffer_load_dwordx4 a[64:67], v2, s[32:35], s62 offen offset:0 sc1
s_waitcnt lgkmcnt(0)
v_mfma_f32_32x32x16_bf16 v[12:27], v[92:95], a[36:39], v[12:27]
ds_read_b128 v[76:79], v8 offset:10240
ds_read_b128 v[80:83], v8 offset:43008
v_mfma_f32_32x32x16_bf16 v[28:43], v[96:99], a[36:39], v[28:43]
buffer_load_dwordx4 v2, s[32:35], s61 offen offset:1024 sc1 lds
v_mfma_f32_32x32x16_bf16 v[44:59], v[100:103], a[36:39], v[44:59]
ds_read_b128 v[84:87], v9 offset:10240
ds_read_b128 v[88:91], v9 offset:43008
v_mfma_f32_32x32x16_bf16 v[60:75], v[104:107], a[36:39], v[60:75]
buffer_load_dwordx4 a[68:71], v2, s[32:35], s62 offen offset:1024 sc1
s_waitcnt lgkmcnt(0)
v_mfma_f32_32x32x16_bf16 v[12:27], v[76:79], a[40:43], v[12:27]
ds_read_b128 v[92:95], v8 offset:11264
ds_read_b128 v[96:99], v8 offset:44032
v_mfma_f32_32x32x16_bf16 v[28:43], v[80:83], a[40:43], v[28:43]
buffer_load_dwordx4 v2, s[32:35], s61 offen offset:2048 sc1 lds
v_mfma_f32_32x32x16_bf16 v[44:59], v[84:87], a[40:43], v[44:59]
ds_read_b128 v[100:103], v9 offset:11264
ds_read_b128 v[104:107], v9 offset:44032
v_mfma_f32_32x32x16_bf16 v[60:75], v[88:91], a[40:43], v[60:75]
buffer_load_dwordx4 a[72:75], v2, s[32:35], s62 offen offset:2048 sc1
s_waitcnt lgkmcnt(0)
v_mfma_f32_32x32x16_bf16 v[12:27], v[92:95], a[44:47], v[12:27]
s_waitcnt vmcnt(6)
s_barrier
v_mfma_f32_32x32x16_bf16 v[28:43], v[96:99], a[44:47], v[28:43]
ds_read_b128 v[76:79], v8 offset:12288
ds_read_b128 v[80:83], v8 offset:45056
v_mfma_f32_32x32x16_bf16 v[44:59], v[100:103], a[44:47], v[44:59]
ds_read_b128 v[84:87], v9 offset:12288
ds_read_b128 v[88:91], v9 offset:45056
v_mfma_f32_32x32x16_bf16 v[60:75], v[104:107], a[44:47], v[60:75]
buffer_load_dwordx4 v2, s[32:35], s61 offen offset:3072 sc1 lds
buffer_load_dwordx4 a[76:79], v2, s[32:35], s62 offen offset:3072 sc1
s_waitcnt lgkmcnt(0)
v_mfma_f32_32x32x16_bf16 v[12:27], v[76:79], a[48:51], v[12:27]
ds_read_b128 v[92:95], v8 offset:13312
ds_read_b128 v[96:99], v8 offset:46080
v_mfma_f32_32x32x16_bf16 v[28:43], v[80:83], a[48:51], v[28:43]
s_add_u32 s61, s41, s63
s_add_u32 s62, s42, s63
s_add_u32 m0, s60, 20480
s_add_u32 s63, s63, 4096
s_and_b32 s63, s63, 0x7fff
ds_read_b128 v[100:103], v9 offset:13312
v_mfma_f32_32x32x16_bf16 v[44:59], v[84:87], a[48:51], v[44:59]
ds_read_b128 v[104:107], v9 offset:46080
buffer_load_dwordx4 v2, s[32:35], s61 offen offset:0 sc1 lds
v_mfma_f32_32x32x16_bf16 v[60:75], v[88:91], a[48:51], v[60:75]
buffer_load_dwordx4 a[80:83], v2, s[32:35], s62 offen offset:0 sc1
s_waitcnt lgkmcnt(0)
v_mfma_f32_32x32x16_bf16 v[12:27], v[92:95], a[52:55], v[12:27]
ds_read_b128 v[76:79], v8 offset:14336
ds_read_b128 v[80:83], v8 offset:47104
v_mfma_f32_32x32x16_bf16 v[28:43], v[96:99], a[52:55], v[28:43]
buffer_load_dwordx4 v2, s[32:35], s61 offen offset:1024 sc1 lds
v_mfma_f32_32x32x16_bf16 v[44:59], v[100:103], a[52:55], v[44:59]
ds_read_b128 v[84:87], v9 offset:14336
ds_read_b128 v[88:91], v9 offset:47104
v_mfma_f32_32x32x16_bf16 v[60:75], v[104:107], a[52:55], v[60:75]
buffer_load_dwordx4 a[84:87], v2, s[32:35], s62 offen offset:1024 sc1
s_waitcnt lgkmcnt(0)
v_mfma_f32_32x32x16_bf16 v[12:27], v[76:79], a[56:59], v[12:27]
ds_read_b128 v[92:95], v8 offset:15360
ds_read_b128 v[96:99], v8 offset:48128
v_mfma_f32_32x32x16_bf16 v[28:43], v[80:83], a[56:59], v[28:43]
buffer_load_dwordx4 v2, s[32:35], s61 offen offset:2048 sc1 lds
v_mfma_f32_32x32x16_bf16 v[44:59], v[84:87], a[56:59], v[44:59]
ds_read_b128 v[100:103], v9 offset:15360
ds_read_b128 v[104:107], v9 offset:48128
v_mfma_f32_32x32x16_bf16 v[60:75], v[88:91], a[56:59], v[60:75]
buffer_load_dwordx4 a[88:91], v2, s[32:35], s62 offen offset:2048 sc1
s_waitcnt lgkmcnt(0)
v_mfma_f32_32x32x16_bf16 v[12:27], v[92:95], a[60:63], v[12:27]
s_waitcnt vmcnt(6)
s_barrier
v_mfma_f32_32x32x16_bf16 v[28:43], v[96:99], a[60:63], v[28:43]
ds_read_b128 v[76:79], v8 offset:16384
ds_read_b128 v[80:83], v8 offset:49152
v_mfma_f32_32x32x16_bf16 v[44:59], v[100:103], a[60:63], v[44:59]
ds_read_b128 v[84:87], v9 offset:16384
ds_read_b128 v[88:91], v9 offset:49152
v_mfma_f32_32x32x16_bf16 v[60:75], v[104:107], a[60:63], v[60:75]
buffer_load_dwordx4 v2, s[32:35], s61 offen offset:3072 sc1 lds
buffer_load_dwordx4 a[92:95], v2, s[32:35], s62 offen offset:3072 sc1
s_waitcnt lgkmcnt(0)
v_mfma_f32_32x32x16_bf16 v[12:27], v[76:79], a[64:67], v[12:27]
ds_read_b128 v[92:95], v8 offset:17408
ds_read_b128 v[96:99], v8 offset:50176
v_mfma_f32_32x32x16_bf16 v[28:43], v[80:83], a[64:67], v[28:43]
s_add_u32 s61, s41, s63
s_add_u32 s62, s42, s63
s_add_u32 m0, s60, 24576
s_add_u32 s63, s63, 4096
s_and_b32 s63, s63, 0x7fff
ds_read_b128 v[100:103], v9 offset:17408
v_mfma_f32_32x32x16_bf16 v[44:59], v[84:87], a[64:67], v[44:59]
ds_read_b128 v[104:107], v9 offset:50176
buffer_load_dwordx4 v2, s[32:35], s61 offen offset:0 sc1 lds
v_mfma_f32_32x32x16_bf16 v[60:75], v[88:91], a[64:67], v[60:75]
buffer_load_dwordx4 a[96:99], v2, s[32:35], s62 offen offset:0 sc1
s_waitcnt lgkmcnt(0)
v_mfma_f32_32x32x16_bf16 v[12:27], v[92:95], a[68:71], v[12:27]
ds_read_b128 v[76:79], v8 offset:18432
ds_read_b128 v[80:83], v8 offset:51200
v_mfma_f32_32x32x16_bf16 v[28:43], v[96:99], a[68:71], v[28:43]
buffer_load_dwordx4 v2, s[32:35], s61 offen offset:1024 sc1 lds
v_mfma_f32_32x32x16_bf16 v[44:59], v[100:103], a[68:71], v[44:59]
ds_read_b128 v[84:87], v9 offset:18432
ds_read_b128 v[88:91], v9 offset:51200
v_mfma_f32_32x32x16_bf16 v[60:75], v[104:107], a[68:71], v[60:75]
buffer_load_dwordx4 a[100:103], v2, s[32:35], s62 offen offset:1024 sc1
s_waitcnt lgkmcnt(0)
v_mfma_f32_32x32x16_bf16 v[12:27], v[76:79], a[72:75], v[12:27]
ds_read_b128 v[92:95], v8 offset:19456
ds_read_b128 v[96:99], v8 offset:52224
v_mfma_f32_32x32x16_bf16 v[28:43], v[80:83], a[72:75], v[28:43]
buffer_load_dwordx4 v2, s[32:35], s61 offen offset:2048 sc1 lds
v_mfma_f32_32x32x16_bf16 v[44:59], v[84:87], a[72:75], v[44:59]
ds_read_b128 v[100:103], v9 offset:19456
ds_read_b128 v[104:107], v9 offset:52224
v_mfma_f32_32x32x16_bf16 v[60:75], v[88:91], a[72:75], v[60:75]
buffer_load_dwordx4 a[104:107], v2, s[32:35], s62 offen offset:2048 sc1
s_waitcnt lgkmcnt(0)
v_mfma_f32_32x32x16_bf16 v[12:27], v[92:95], a[76:79], v[12:27]
s_waitcnt vmcnt(6)
s_barrier
v_mfma_f32_32x32x16_bf16 v[28:43], v[96:99], a[76:79], v[28:43]
ds_read_b128 v[76:79], v8 offset:20480
ds_read_b128 v[80:83], v8 offset:53248
v_mfma_f32_32x32x16_bf16 v[44:59], v[100:103], a[76:79], v[44:59]
ds_read_b128 v[84:87], v9 offset:20480
ds_read_b128 v[88:91], v9 offset:53248
v_mfma_f32_32x32x16_bf16 v[60:75], v[104:107], a[76:79], v[60:75]
buffer_load_dwordx4 v2, s[32:35], s61 offen offset:3072 sc1 lds
buffer_load_dwordx4 a[108:111], v2, s[32:35], s62 offen offset:3072 sc1
s_waitcnt lgkmcnt(0)
v_mfma_f32_32x32x16_bf16 v[12:27], v[76:79], a[80:83], v[12:27]
ds_read_b128 v[92:95], v8 offset:21504
ds_read_b128 v[96:99], v8 offset:54272
v_mfma_f32_32x32x16_bf16 v[28:43], v[80:83], a[80:83], v[28:43]
s_add_u32 s61, s41, s63
s_add_u32 s62, s42, s63
s_add_u32 m0, s60, 28672
s_add_u32 s63, s63, 4096
s_and_b32 s63, s63, 0x7fff
ds_read_b128 v[100:103], v9 offset:21504
v_mfma_f32_32x32x16_bf16 v[44:59], v[84:87], a[80:83], v[44:59]
ds_read_b128 v[104:107], v9 offset:54272
buffer_load_dwordx4 v2, s[32:35], s61 offen offset:0 sc1 lds
v_mfma_f32_32x32x16_bf16 v[60:75], v[88:91], a[80:83], v[60:75]
buffer_load_dwordx4 a[112:115], v2, s[32:35], s62 offen offset:0 sc1
s_waitcnt lgkmcnt(0)
v_mfma_f32_32x32x16_bf16 v[12:27], v[92:95], a[84:87], v[12:27]
ds_read_b128 v[76:79], v8 offset:22528
ds_read_b128 v[80:83], v8 offset:55296
v_mfma_f32_32x32x16_bf16 v[28:43], v[96:99], a[84:87], v[28:43]
buffer_load_dwordx4 v2, s[32:35], s61 offen offset:1024 sc1 lds
v_mfma_f32_32x32x16_bf16 v[44:59], v[100:103], a[84:87], v[44:59]
ds_read_b128 v[84:87], v9 offset:22528
ds_read_b128 v[88:91], v9 offset:55296
v_mfma_f32_32x32x16_bf16 v[60:75], v[104:107], a[84:87], v[60:75]
buffer_load_dwordx4 a[116:119], v2, s[32:35], s62 offen offset:1024 sc1
s_waitcnt lgkmcnt(0)
v_mfma_f32_32x32x16_bf16 v[12:27], v[76:79], a[88:91], v[12:27]
ds_read_b128 v[92:95], v8 offset:23552
ds_read_b128 v[96:99], v8 offset:56320
v_mfma_f32_32x32x16_bf16 v[28:43], v[80:83], a[88:91], v[28:43]
buffer_load_dwordx4 v2, s[32:35], s61 offen offset:2048 sc1 lds
v_mfma_f32_32x32x16_bf16 v[44:59], v[84:87], a[88:91], v[44:59]
ds_read_b128 v[100:103], v9 offset:23552
ds_read_b128 v[104:107], v9 offset:56320
v_mfma_f32_32x32x16_bf16 v[60:75], v[88:91], a[88:91], v[60:75]
buffer_load_dwordx4 a[120:123], v2, s[32:35], s62 offen offset:2048 sc1
s_waitcnt lgkmcnt(0)
v_mfma_f32_32x32x16_bf16 v[12:27], v[92:95], a[92:95], v[12:27]
s_waitcnt vmcnt(6)
s_barrier
v_mfma_f32_32x32x16_bf16 v[28:43], v[96:99], a[92:95], v[28:43]
ds_read_b128 v[76:79], v8 offset:24576
ds_read_b128 v[80:83], v8 offset:57344
v_mfma_f32_32x32x16_bf16 v[44:59], v[100:103], a[92:95], v[44:59]
ds_read_b128 v[84:87], v9 offset:24576
ds_read_b128 v[88:91], v9 offset:57344
v_mfma_f32_32x32x16_bf16 v[60:75], v[104:107], a[92:95], v[60:75]
buffer_load_dwordx4 v2, s[32:35], s61 offen offset:3072 sc1 lds
buffer_load_dwordx4 a[124:127], v2, s[32:35], s62 offen offset:3072 sc1
s_waitcnt lgkmcnt(0)
v_mfma_f32_32x32x16_bf16 v[12:27], v[76:79], a[96:99], v[12:27]
ds_read_b128 v[92:95], v8 offset:25600
v_mfma_f32_32x32x16_bf16 v[28:43], v[80:83], a[96:99], v[28:43]
ds_read_b128 v[96:99], v8 offset:58368
v_mfma_f32_32x32x16_bf16 v[44:59], v[84:87], a[96:99], v[44:59]
ds_read_b128 v[100:103], v9 offset:25600
v_mfma_f32_32x32x16_bf16 v[60:75], v[88:91], a[96:99], v[60:75]
ds_read_b128 v[104:107], v9 offset:58368
s_waitcnt lgkmcnt(0)
v_mfma_f32_32x32x16_bf16 v[12:27], v[92:95], a[100:103], v[12:27]
ds_read_b128 v[76:79], v8 offset:26624
v_mfma_f32_32x32x16_bf16 v[28:43], v[96:99], a[100:103], v[28:43]
ds_read_b128 v[80:83], v8 offset:59392
v_mfma_f32_32x32x16_bf16 v[44:59], v[100:103], a[100:103], v[44:59]
ds_read_b128 v[84:87], v9 offset:26624
v_mfma_f32_32x32x16_bf16 v[60:75], v[104:107], a[100:103], v[60:75]
ds_read_b128 v[88:91], v9 offset:59392
s_waitcnt lgkmcnt(0)
v_mfma_f32_32x32x16_bf16 v[12:27], v[76:79], a[104:107], v[12:27]
ds_read_b128 v[92:95], v8 offset:27648
v_mfma_f32_32x32x16_bf16 v[28:43], v[80:83], a[104:107], v[28:43]
ds_read_b128 v[96:99], v8 offset:60416
v_mfma_f32_32x32x16_bf16 v[44:59], v[84:87], a[104:107], v[44:59]
ds_read_b128 v[100:103], v9 offset:27648
v_mfma_f32_32x32x16_bf16 v[60:75], v[88:91], a[104:107], v[60:75]
ds_read_b128 v[104:107], v9 offset:60416
s_waitcnt lgkmcnt(0)
v_mfma_f32_32x32x16_bf16 v[12:27], v[92:95], a[108:111], v[12:27]
s_waitcnt vmcnt(0)
s_barrier
v_mfma_f32_32x32x16_bf16 v[28:43], v[96:99], a[108:111], v[28:43]
ds_read_b128 v[76:79], v8 offset:28672
ds_read_b128 v[80:83], v8 offset:61440
v_mfma_f32_32x32x16_bf16 v[44:59], v[100:103], a[108:111], v[44:59]
ds_read_b128 v[84:87], v9 offset:28672
v_mfma_f32_32x32x16_bf16 v[60:75], v[104:107], a[108:111], v[60:75]
ds_read_b128 v[88:91], v9 offset:61440
s_waitcnt lgkmcnt(0)
v_mfma_f32_32x32x16_bf16 v[12:27], v[76:79], a[112:115], v[12:27]
ds_read_b128 v[92:95], v8 offset:29696
v_mfma_f32_32x32x16_bf16 v[28:43], v[80:83], a[112:115], v[28:43]
ds_read_b128 v[96:99], v8 offset:62464
v_mfma_f32_32x32x16_bf16 v[44:59], v[84:87], a[112:115], v[44:59]
ds_read_b128 v[100:103], v9 offset:29696
v_mfma_f32_32x32x16_bf16 v[60:75], v[88:91], a[112:115], v[60:75]
ds_read_b128 v[104:107], v9 offset:62464
s_waitcnt lgkmcnt(0)
v_mfma_f32_32x32x16_bf16 v[12:27], v[92:95], a[116:119], v[12:27]
ds_read_b128 v[76:79], v8 offset:30720
v_mfma_f32_32x32x16_bf16 v[28:43], v[96:99], a[116:119], v[28:43]
ds_read_b128 v[80:83], v8 offset:63488
v_mfma_f32_32x32x16_bf16 v[44:59], v[100:103], a[116:119], v[44:59]
ds_read_b128 v[84:87], v9 offset:30720
v_mfma_f32_32x32x16_bf16 v[60:75], v[104:107], a[116:119], v[60:75]
ds_read_b128 v[88:91], v9 offset:63488
s_waitcnt lgkmcnt(0)
v_mfma_f32_32x32x16_bf16 v[12:27], v[76:79], a[120:123], v[12:27]
ds_read_b128 v[92:95], v8 offset:31744
v_mfma_f32_32x32x16_bf16 v[28:43], v[80:83], a[120:123], v[28:43]
ds_read_b128 v[96:99], v8 offset:64512
v_mfma_f32_32x32x16_bf16 v[44:59], v[84:87], a[120:123], v[44:59]
ds_read_b128 v[100:103], v9 offset:31744
v_mfma_f32_32x32x16_bf16 v[60:75], v[88:91], a[120:123], v[60:75]
ds_read_b128 v[104:107], v9 offset:64512
s_waitcnt lgkmcnt(0)
v_mfma_f32_32x32x16_bf16 v[12:27], v[92:95], a[124:127], v[12:27]
v_mfma_f32_32x32x16_bf16 v[28:43], v[96:99], a[124:127], v[28:43]
v_mfma_f32_32x32x16_bf16 v[44:59], v[100:103], a[124:127], v[44:59]
v_mfma_f32_32x32x16_bf16 v[60:75], v[104:107], a[124:127], v[60:75]
v_cmp_lt_u32 vcc, 31, v1
v_mov_b32 v3, 0xff800000
s_nop 9
v_cndmask_b32 v73, v73, v3, vcc
v_cndmask_b32 v74, v74, v3, vcc
v_cndmask_b32 v75, v75, v3, vcc
v_max3_f32 v124, v12, v13, v14
v_max3_f32 v125, v15, v16, v17
v_max3_f32 v124, v124, v18, v19
v_max3_f32 v125, v125, v20, v21
v_max3_f32 v124, v124, v22, v23
v_max3_f32 v125, v125, v24, v25
v_max3_f32 v124, v124, v26, v27
v_max3_f32 v125, v125, v28, v29
v_max3_f32 v124, v124, v30, v31
v_max3_f32 v125, v125, v32, v33
v_max3_f32 v124, v124, v34, v35
v_max3_f32 v125, v125, v36, v37
v_max3_f32 v124, v124, v38, v39
v_max3_f32 v125, v125, v40, v41
v_max3_f32 v124, v124, v42, v43
v_max3_f32 v125, v125, v44, v45
v_max3_f32 v124, v124, v46, v47
v_max3_f32 v125, v125, v48, v49
v_max3_f32 v124, v124, v50, v51
v_max3_f32 v125, v125, v52, v53
v_max3_f32 v124, v124, v54, v55
v_max3_f32 v125, v125, v56, v57
v_max3_f32 v124, v124, v58, v59
v_max3_f32 v125, v125, v60, v61
v_max3_f32 v124, v124, v62, v63
v_max3_f32 v125, v125, v64, v65
v_max3_f32 v124, v124, v66, v67
v_max3_f32 v125, v125, v68, v69
v_max3_f32 v124, v124, v70, v71
v_max3_f32 v125, v125, v72, v73
v_max3_f32 v124, v124, v74, v75
v_max_f32 v124, v124, v125
v_mov_b32 v125, v124
s_nop 1
v_permlane32_swap_b32 v124, v125
v_max_f32 v124, v124, v125
v_pk_add_f32 v[12:13], v[12:13], v[124:125] op_sel_hi:[1,0] neg_lo:[0,1] neg_hi:[0,1]
v_pk_add_f32 v[14:15], v[14:15], v[124:125] op_sel_hi:[1,0] neg_lo:[0,1] neg_hi:[0,1]
v_pk_add_f32 v[16:17], v[16:17], v[124:125] op_sel_hi:[1,0] neg_lo:[0,1] neg_hi:[0,1]
v_pk_add_f32 v[18:19], v[18:19], v[124:125] op_sel_hi:[1,0] neg_lo:[0,1] neg_hi:[0,1]
v_pk_add_f32 v[20:21], v[20:21], v[124:125] op_sel_hi:[1,0] neg_lo:[0,1] neg_hi:[0,1]
v_pk_add_f32 v[22:23], v[22:23], v[124:125] op_sel_hi:[1,0] neg_lo:[0,1] neg_hi:[0,1]
v_pk_add_f32 v[24:25], v[24:25], v[124:125] op_sel_hi:[1,0] neg_lo:[0,1] neg_hi:[0,1]
v_pk_add_f32 v[26:27], v[26:27], v[124:125] op_sel_hi:[1,0] neg_lo:[0,1] neg_hi:[0,1]
v_exp_f32 v12, v12
v_exp_f32 v13, v13
v_exp_f32 v14, v14
v_exp_f32 v15, v15
v_exp_f32 v16, v16
v_exp_f32 v17, v17
v_exp_f32 v18, v18
v_exp_f32 v19, v19
v_exp_f32 v20, v20
v_exp_f32 v21, v21
v_exp_f32 v22, v22
v_exp_f32 v23, v23
v_exp_f32 v24, v24
v_exp_f32 v25, v25
v_exp_f32 v26, v26
v_exp_f32 v27, v27
v_pk_add_f32 v[126:127], v[12:13], v[16:17]
v_pk_add_f32 v[128:129], v[14:15], v[18:19]
v_pk_add_f32 v[126:127], v[126:127], v[20:21]
v_pk_add_f32 v[128:129], v[128:129], v[22:23]
v_pk_add_f32 v[126:127], v[126:127], v[24:25]
v_pk_add_f32 v[128:129], v[128:129], v[26:27]
v_cvt_pk_bf16_f32 v108, v12, v13
v_cvt_pk_bf16_f32 v109, v14, v15
v_cvt_pk_bf16_f32 v110, v16, v17
v_cvt_pk_bf16_f32 v111, v18, v19
v_cvt_pk_bf16_f32 v112, v20, v21
v_cvt_pk_bf16_f32 v113, v22, v23
v_cvt_pk_bf16_f32 v114, v24, v25
v_cvt_pk_bf16_f32 v115, v26, v27
s_add_u32 s48, s43, 0
buffer_store_dwordx4 v[108:111], v2, s[32:35], s48 offen offset:0 sc1
buffer_store_dwordx4 v[112:115], v2, s[32:35], s48 offen offset:1024 sc1
v_pk_add_f32 v[28:29], v[28:29], v[124:125] op_sel_hi:[1,0] neg_lo:[0,1] neg_hi:[0,1]
v_pk_add_f32 v[30:31], v[30:31], v[124:125] op_sel_hi:[1,0] neg_lo:[0,1] neg_hi:[0,1]
v_pk_add_f32 v[32:33], v[32:33], v[124:125] op_sel_hi:[1,0] neg_lo:[0,1] neg_hi:[0,1]
v_pk_add_f32 v[34:35], v[34:35], v[124:125] op_sel_hi:[1,0] neg_lo:[0,1] neg_hi:[0,1]
v_pk_add_f32 v[36:37], v[36:37], v[124:125] op_sel_hi:[1,0] neg_lo:[0,1] neg_hi:[0,1]
v_pk_add_f32 v[38:39], v[38:39], v[124:125] op_sel_hi:[1,0] neg_lo:[0,1] neg_hi:[0,1]
v_pk_add_f32 v[40:41], v[40:41], v[124:125] op_sel_hi:[1,0] neg_lo:[0,1] neg_hi:[0,1]
v_pk_add_f32 v[42:43], v[42:43], v[124:125] op_sel_hi:[1,0] neg_lo:[0,1] neg_hi:[0,1]
v_exp_f32 v28, v28
v_exp_f32 v29, v29
v_exp_f32 v30, v30
v_exp_f32 v31, v31
v_exp_f32 v32, v32
v_exp_f32 v33, v33
v_exp_f32 v34, v34
v_exp_f32 v35, v35
v_exp_f32 v36, v36
v_exp_f32 v37, v37
v_exp_f32 v38, v38
v_exp_f32 v39, v39
v_exp_f32 v40, v40
v_exp_f32 v41, v41
v_exp_f32 v42, v42
v_exp_f32 v43, v43
v_pk_add_f32 v[126:127], v[126:127], v[28:29]
v_pk_add_f32 v[128:129], v[128:129], v[30:31]
v_pk_add_f32 v[126:127], v[126:127], v[32:33]
v_pk_add_f32 v[128:129], v[128:129], v[34:35]
v_pk_add_f32 v[126:127], v[126:127], v[36:37]
v_pk_add_f32 v[128:129], v[128:129], v[38:39]
v_pk_add_f32 v[126:127], v[126:127], v[40:41]
v_pk_add_f32 v[128:129], v[128:129], v[42:43]
v_cvt_pk_bf16_f32 v116, v28, v29
v_cvt_pk_bf16_f32 v117, v30, v31
v_cvt_pk_bf16_f32 v118, v32, v33
v_cvt_pk_bf16_f32 v119, v34, v35
v_cvt_pk_bf16_f32 v120, v36, v37
v_cvt_pk_bf16_f32 v121, v38, v39
v_cvt_pk_bf16_f32 v122, v40, v41
v_cvt_pk_bf16_f32 v123, v42, v43
buffer_store_dwordx4 v[116:119], v2, s[32:35], s48 offen offset:2048 sc1
buffer_store_dwordx4 v[120:123], v2, s[32:35], s48 offen offset:3072 sc1
v_pk_add_f32 v[44:45], v[44:45], v[124:125] op_sel_hi:[1,0] neg_lo:[0,1] neg_hi:[0,1]
v_pk_add_f32 v[46:47], v[46:47], v[124:125] op_sel_hi:[1,0] neg_lo:[0,1] neg_hi:[0,1]
v_pk_add_f32 v[48:49], v[48:49], v[124:125] op_sel_hi:[1,0] neg_lo:[0,1] neg_hi:[0,1]
v_pk_add_f32 v[50:51], v[50:51], v[124:125] op_sel_hi:[1,0] neg_lo:[0,1] neg_hi:[0,1]
v_pk_add_f32 v[52:53], v[52:53], v[124:125] op_sel_hi:[1,0] neg_lo:[0,1] neg_hi:[0,1]
v_pk_add_f32 v[54:55], v[54:55], v[124:125] op_sel_hi:[1,0] neg_lo:[0,1] neg_hi:[0,1]
v_pk_add_f32 v[56:57], v[56:57], v[124:125] op_sel_hi:[1,0] neg_lo:[0,1] neg_hi:[0,1]
v_pk_add_f32 v[58:59], v[58:59], v[124:125] op_sel_hi:[1,0] neg_lo:[0,1] neg_hi:[0,1]
v_exp_f32 v44, v44
v_exp_f32 v45, v45
v_exp_f32 v46, v46
v_exp_f32 v47, v47
v_exp_f32 v48, v48
v_exp_f32 v49, v49
v_exp_f32 v50, v50
v_exp_f32 v51, v51
v_exp_f32 v52, v52
v_exp_f32 v53, v53
v_exp_f32 v54, v54
v_exp_f32 v55, v55
v_exp_f32 v56, v56
v_exp_f32 v57, v57
v_exp_f32 v58, v58
v_exp_f32 v59, v59
v_pk_add_f32 v[126:127], v[126:127], v[44:45]
v_pk_add_f32 v[128:129], v[128:129], v[46:47]
v_pk_add_f32 v[126:127], v[126:127], v[48:49]
v_pk_add_f32 v[128:129], v[128:129], v[50:51]
v_pk_add_f32 v[126:127], v[126:127], v[52:53]
v_pk_add_f32 v[128:129], v[128:129], v[54:55]
v_pk_add_f32 v[126:127], v[126:127], v[56:57]
v_pk_add_f32 v[128:129], v[128:129], v[58:59]
v_cvt_pk_bf16_f32 v108, v44, v45
v_cvt_pk_bf16_f32 v109, v46, v47
v_cvt_pk_bf16_f32 v110, v48, v49
v_cvt_pk_bf16_f32 v111, v50, v51
v_cvt_pk_bf16_f32 v112, v52, v53
v_cvt_pk_bf16_f32 v113, v54, v55
v_cvt_pk_bf16_f32 v114, v56, v57
v_cvt_pk_bf16_f32 v115, v58, v59
s_add_u32 s48, s43, 4096
buffer_store_dwordx4 v[108:111], v2, s[32:35], s48 offen offset:0 sc1
buffer_store_dwordx4 v[112:115], v2, s[32:35], s48 offen offset:1024 sc1
v_pk_add_f32 v[60:61], v[60:61], v[124:125] op_sel_hi:[1,0] neg_lo:[0,1] neg_hi:[0,1]
v_pk_add_f32 v[62:63], v[62:63], v[124:125] op_sel_hi:[1,0] neg_lo:[0,1] neg_hi:[0,1]
v_pk_add_f32 v[64:65], v[64:65], v[124:125] op_sel_hi:[1,0] neg_lo:[0,1] neg_hi:[0,1]
v_pk_add_f32 v[66:67], v[66:67], v[124:125] op_sel_hi:[1,0] neg_lo:[0,1] neg_hi:[0,1]
v_pk_add_f32 v[68:69], v[68:69], v[124:125] op_sel_hi:[1,0] neg_lo:[0,1] neg_hi:[0,1]
v_pk_add_f32 v[70:71], v[70:71], v[124:125] op_sel_hi:[1,0] neg_lo:[0,1] neg_hi:[0,1]
v_pk_add_f32 v[72:73], v[72:73], v[124:125] op_sel_hi:[1,0] neg_lo:[0,1] neg_hi:[0,1]
v_pk_add_f32 v[74:75], v[74:75], v[124:125] op_sel_hi:[1,0] neg_lo:[0,1] neg_hi:[0,1]
v_exp_f32 v60, v60
v_exp_f32 v61, v61
v_exp_f32 v62, v62
v_exp_f32 v63, v63
v_exp_f32 v64, v64
v_exp_f32 v65, v65
v_exp_f32 v66, v66
v_exp_f32 v67, v67
v_exp_f32 v68, v68
v_exp_f32 v69, v69
v_exp_f32 v70, v70
v_exp_f32 v71, v71
v_exp_f32 v72, v72
v_exp_f32 v73, v73
v_exp_f32 v74, v74
v_exp_f32 v75, v75
v_pk_add_f32 v[126:127], v[126:127], v[60:61]
v_pk_add_f32 v[128:129], v[128:129], v[62:63]
v_pk_add_f32 v[126:127], v[126:127], v[64:65]
v_pk_add_f32 v[128:129], v[128:129], v[66:67]
v_pk_add_f32 v[126:127], v[126:127], v[68:69]
v_pk_add_f32 v[128:129], v[128:129], v[70:71]
v_pk_add_f32 v[126:127], v[126:127], v[72:73]
v_pk_add_f32 v[128:129], v[128:129], v[74:75]
v_cvt_pk_bf16_f32 v116, v60, v61
v_cvt_pk_bf16_f32 v117, v62, v63
v_cvt_pk_bf16_f32 v118, v64, v65
v_cvt_pk_bf16_f32 v119, v66, v67
v_cvt_pk_bf16_f32 v120, v68, v69
v_cvt_pk_bf16_f32 v121, v70, v71
v_cvt_pk_bf16_f32 v122, v72, v73
v_cvt_pk_bf16_f32 v123, v74, v75
buffer_store_dwordx4 v[116:119], v2, s[32:35], s48 offen offset:2048 sc1
buffer_store_dwordx4 v[120:123], v2, s[32:35], s48 offen offset:3072 sc1
v_pk_add_f32 v[126:127], v[126:127], v[128:129]
v_add_f32 v126, v126, v127
v_mov_b32 v127, v126
s_nop 1
v_permlane32_swap_b32 v126, v127
v_add_f32 v131, v126, v127
v_mov_b32 v130, v124
v_lshlrev_b32 v3, 3, v1
v_mov_b32 v5, 0x7ff00000
v_cmp_gt_u32 vcc, 32, v1
s_nop 1
v_cndmask_b32 v3, v5, v3, vcc
buffer_store_dwordx2 v[130:131], v3, s[32:35], s44 offen sc1
s_mov_b64 exec, -1
v_mov_b32 v5, 1
s_waitcnt vmcnt(0) lgkmcnt(0)
s_barrier
s_cmp_lg_u32 s28, 0
s_cbranch_scc1 L_p2_nopub_11
s_mov_b64 exec, 1
buffer_store_dword v5, off, s[32:35], s65 sc1
s_mov_b64 exec, -1
L_p2_nopub_11:
s_mov_b32 s73, 0
s_branch L_p3_start
L_p2_vsetup:
s_sub_u32 s49, s49, 16
s_and_b32 s50, s48, 3
s_lshl_b32 s50, s50, 1
s_and_b32 s51, s49, 1
s_add_u32 s50, s50, s51
s_lshr_b32 s51, s49, 1
s_lshl_b32 s52, s40, 3
s_add_u32 s53, s52, s50
s_lshl_b32 s53, s53, 2
s_add_u32 s53, s53, s28
s_lshl_b32 s53, s53, 15
s_add_u32 s41, s53, 0x400000
s_lshl_b32 s53, s51, 2
s_add_u32 s53, s53, s28
s_lshl_b32 s54, s53, 15
s_add_u32 s42, s54, 0x9e8000
s_lshl_b32 s54, s40, 4
s_add_u32 s54, s54, s53
s_lshl_b32 s54, s54, 16
s_lshl_b32 s55, s50, 13
s_add_u32 s54, s54, s55
s_add_u32 s43, s54, 0x1000000
s_lshl_b32 s53, s40, 2
s_add_u32 s53, s53, s51
s_lshl_b32 s53, s53, 3
s_add_u32 s53, s53, s50
s_add_u32 s65, s53, 128
s_lshl_b32 s65, s65, 7
s_add_u32 s65, s65, 0xb50000
s_mov_b32 s53, s51
s_mov_b32 s63, 0
s_waitcnt lgkmcnt(0)
s_mov_b32 s32, s26
s_and_b32 s33, s27, 0xffff
s_mov_b32 s34, 0x1440000
s_mov_b32 s35, 0x20000
s_lshl_b32 s52, s40, 3
s_add_u32 s53, s52, s50
s_mul_i32 s53, s53, 14
s_add_u32 s53, s53, 8
s_add_u32 s54, s51, 208
v_lshlrev_b32 v5, 2, v1
v_add_u32 v5, s54, v5
v_add_u32 v6, s53, v1
v_cmp_gt_u32 vcc, 4, v1
s_nop 1
v_cndmask_b32 v5, v5, v6, vcc
v_lshlrev_b32 v5, 7, v5
v_add_u32 v5, 0xb58000, v5
v_mov_b32 v6, 0x7ff00000
v_cmp_gt_u32 vcc, 8, v1
s_nop 1
v_cndmask_b32 v5, v6, v5, vcc
s_mov_b32 s66, 0x100000
L_p2_ppv_12:
buffer_load_dword v6, v5, s[32:35], 0 offen sc1
s_waitcnt vmcnt(0)
v_cmp_eq_u32 vcc, 1, v6
s_nop 4
s_and_b32 vcc_lo, vcc_lo, 0xff
s_cmp_lg_u32 vcc_lo, 0xff
s_cbranch_scc1 L_p2_ppnv_14
s_branch L_p2_ppokv_13
L_p2_ppnv_14:
s_sub_u32 s66, s66, 1
s_cmp_eq_u32 s66, 0
s_cbranch_scc1 L_p2_ppokv_13
s_sleep 2
s_branch L_p2_ppv_12
L_p2_ppokv_13:
s_add_u32 s61, s41, s63
s_add_u32 s62, s42, s63
s_add_u32 m0, s60, 0
s_add_u32 s63, s63, 4096
s_and_b32 s63, s63, 0x7fff
buffer_load_dwordx4 v2, s[32:35], s61 offen offset:0 sc1 lds
buffer_load_dwordx4 a[0:3], v2, s[32:35], s62 offen offset:0 sc1
buffer_load_dwordx4 v2, s[32:35], s61 offen offset:1024 sc1 lds
buffer_load_dwordx4 a[4:7], v2, s[32:35], s62 offen offset:1024 sc1
buffer_load_dwordx4 v2, s[32:35], s61 offen offset:2048 sc1 lds
buffer_load_dwordx4 a[8:11], v2, s[32:35], s62 offen offset:2048 sc1
buffer_load_dwordx4 v2, s[32:35], s61 offen offset:3072 sc1 lds
buffer_load_dwordx4 a[12:15], v2, s[32:35], s62 offen offset:3072 sc1
s_add_u32 s61, s41, s63
s_add_u32 s62, s42, s63
s_add_u32 m0, s60, 4096
s_add_u32 s63, s63, 4096
s_and_b32 s63, s63, 0x7fff
buffer_load_dwordx4 v2, s[32:35], s61 offen offset:0 sc1 lds
buffer_load_dwordx4 a[16:19], v2, s[32:35], s62 offen offset:0 sc1
buffer_load_dwordx4 v2, s[32:35], s61 offen offset:1024 sc1 lds
buffer_load_dwordx4 a[20:23], v2, s[32:35], s62 offen offset:1024 sc1
buffer_load_dwordx4 v2, s[32:35], s61 offen offset:2048 sc1 lds
buffer_load_dwordx4 a[24:27], v2, s[32:35], s62 offen offset:2048 sc1
buffer_load_dwordx4 v2, s[32:35], s61 offen offset:3072 sc1 lds
buffer_load_dwordx4 a[28:31], v2, s[32:35], s62 offen offset:3072 sc1
s_waitcnt vmcnt(8)
s_barrier
ds_read_b128 v[76:79], v8 offset:0
ds_read_b128 v[80:83], v8 offset:32768
ds_read_b128 v[84:87], v9 offset:0
ds_read_b128 v[88:91], v9 offset:32768
s_waitcnt lgkmcnt(0)
v_mfma_f32_32x32x16_bf16 v[12:27], v[76:79], a[0:3], 0
ds_read_b128 v[92:95], v8 offset:1024
ds_read_b128 v[96:99], v8 offset:33792
v_mfma_f32_32x32x16_bf16 v[28:43], v[80:83], a[0:3], 0
s_add_u32 s61, s41, s63
s_add_u32 s62, s42, s63
s_add_u32 m0, s60, 8192
s_add_u32 s63, s63, 4096
s_and_b32 s63, s63, 0x7fff
ds_read_b128 v[100:103], v9 offset:1024
v_mfma_f32_32x32x16_bf16 v[44:59], v[84:87], a[0:3], 0
ds_read_b128 v[104:107], v9 offset:33792
buffer_load_dwordx4 v2, s[32:35], s61 offen offset:0 sc1 lds
v_mfma_f32_32x32x16_bf16 v[60:75], v[88:91], a[0:3], 0
buffer_load_dwordx4 a[32:35], v2, s[32:35], s62 offen offset:0 sc1
s_waitcnt lgkmcnt(0)
v_mfma_f32_32x32x16_bf16 v[12:27], v[92:95], a[4:7], v[12:27]
ds_read_b128 v[76:79], v8 offset:2048
ds_read_b128 v[80:83], v8 offset:34816
v_mfma_f32_32x32x16_bf16 v[28:43], v[96:99], a[4:7], v[28:43]
buffer_load_dwordx4 v2, s[32:35], s61 offen offset:1024 sc1 lds
v_mfma_f32_32x32x16_bf16 v[44:59], v[100:103], a[4:7], v[44:59]
ds_read_b128 v[84:87], v9 offset:2048
ds_read_b128 v[88:91], v9 offset:34816
v_mfma_f32_32x32x16_bf16 v[60:75], v[104:107], a[4:7], v[60:75]
buffer_load_dwordx4 a[36:39], v2, s[32:35], s62 offen offset:1024 sc1
s_waitcnt lgkmcnt(0)
v_mfma_f32_32x32x16_bf16 v[12:27], v[76:79], a[8:11], v[12:27]
ds_read_b128 v[92:95], v8 offset:3072
ds_read_b128 v[96:99], v8 offset:35840
v_mfma_f32_32x32x16_bf16 v[28:43], v[80:83], a[8:11], v[28:43]
buffer_load_dwordx4 v2, s[32:35], s61 offen offset:2048 sc1 lds
v_mfma_f32_32x32x16_bf16 v[44:59], v[84:87], a[8:11], v[44:59]
ds_read_b128 v[100:103], v9 offset:3072
ds_read_b128 v[104:107], v9 offset:35840
v_mfma_f32_32x32x16_bf16 v[60:75], v[88:91], a[8:11], v[60:75]
buffer_load_dwordx4 a[40:43], v2, s[32:35], s62 offen offset:2048 sc1
s_waitcnt lgkmcnt(0)
v_mfma_f32_32x32x16_bf16 v[12:27], v[92:95], a[12:15], v[12:27]
s_waitcnt vmcnt(6)
s_barrier
v_mfma_f32_32x32x16_bf16 v[28:43], v[96:99], a[12:15], v[28:43]
ds_read_b128 v[76:79], v8 offset:4096
ds_read_b128 v[80:83], v8 offset:36864
v_mfma_f32_32x32x16_bf16 v[44:59], v[100:103], a[12:15], v[44:59]
ds_read_b128 v[84:87], v9 offset:4096
ds_read_b128 v[88:91], v9 offset:36864
v_mfma_f32_32x32x16_bf16 v[60:75], v[104:107], a[12:15], v[60:75]
buffer_load_dwordx4 v2, s[32:35], s61 offen offset:3072 sc1 lds
buffer_load_dwordx4 a[44:47], v2, s[32:35], s62 offen offset:3072 sc1
s_waitcnt lgkmcnt(0)
v_mfma_f32_32x32x16_bf16 v[12:27], v[76:79], a[16:19], v[12:27]
ds_read_b128 v[92:95], v8 offset:5120
ds_read_b128 v[96:99], v8 offset:37888
v_mfma_f32_32x32x16_bf16 v[28:43], v[80:83], a[16:19], v[28:43]
s_add_u32 s61, s41, s63
s_add_u32 s62, s42, s63
s_add_u32 m0, s60, 12288
s_add_u32 s63, s63, 4096
s_and_b32 s63, s63, 0x7fff
ds_read_b128 v[100:103], v9 offset:5120
v_mfma_f32_32x32x16_bf16 v[44:59], v[84:87], a[16:19], v[44:59]
ds_read_b128 v[104:107], v9 offset:37888
buffer_load_dwordx4 v2, s[32:35], s61 offen offset:0 sc1 lds
v_mfma_f32_32x32x16_bf16 v[60:75], v[88:91], a[16:19], v[60:75]
buffer_load_dwordx4 a[48:51], v2, s[32:35], s62 offen offset:0 sc1
s_waitcnt lgkmcnt(0)
v_mfma_f32_32x32x16_bf16 v[12:27], v[92:95], a[20:23], v[12:27]
ds_read_b128 v[76:79], v8 offset:6144
ds_read_b128 v[80:83], v8 offset:38912
v_mfma_f32_32x32x16_bf16 v[28:43], v[96:99], a[20:23], v[28:43]
buffer_load_dwordx4 v2, s[32:35], s61 offen offset:1024 sc1 lds
v_mfma_f32_32x32x16_bf16 v[44:59], v[100:103], a[20:23], v[44:59]
ds_read_b128 v[84:87], v9 offset:6144
ds_read_b128 v[88:91], v9 offset:38912
v_mfma_f32_32x32x16_bf16 v[60:75], v[104:107], a[20:23], v[60:75]
buffer_load_dwordx4 a[52:55], v2, s[32:35], s62 offen offset:1024 sc1
s_waitcnt lgkmcnt(0)
v_mfma_f32_32x32x16_bf16 v[12:27], v[76:79], a[24:27], v[12:27]
ds_read_b128 v[92:95], v8 offset:7168
ds_read_b128 v[96:99], v8 offset:39936
v_mfma_f32_32x32x16_bf16 v[28:43], v[80:83], a[24:27], v[28:43]
buffer_load_dwordx4 v2, s[32:35], s61 offen offset:2048 sc1 lds
v_mfma_f32_32x32x16_bf16 v[44:59], v[84:87], a[24:27], v[44:59]
ds_read_b128 v[100:103], v9 offset:7168
ds_read_b128 v[104:107], v9 offset:39936
v_mfma_f32_32x32x16_bf16 v[60:75], v[88:91], a[24:27], v[60:75]
buffer_load_dwordx4 a[56:59], v2, s[32:35], s62 offen offset:2048 sc1
s_waitcnt lgkmcnt(0)
v_mfma_f32_32x32x16_bf16 v[12:27], v[92:95], a[28:31], v[12:27]
s_waitcnt vmcnt(6)
s_barrier
v_mfma_f32_32x32x16_bf16 v[28:43], v[96:99], a[28:31], v[28:43]
ds_read_b128 v[76:79], v8 offset:8192
ds_read_b128 v[80:83], v8 offset:40960
v_mfma_f32_32x32x16_bf16 v[44:59], v[100:103], a[28:31], v[44:59]
ds_read_b128 v[84:87], v9 offset:8192
ds_read_b128 v[88:91], v9 offset:40960
v_mfma_f32_32x32x16_bf16 v[60:75], v[104:107], a[28:31], v[60:75]
buffer_load_dwordx4 v2, s[32:35], s61 offen offset:3072 sc1 lds
buffer_load_dwordx4 a[60:63], v2, s[32:35], s62 offen offset:3072 sc1
s_waitcnt lgkmcnt(0)
v_mfma_f32_32x32x16_bf16 v[12:27], v[76:79], a[32:35], v[12:27]
ds_read_b128 v[92:95], v8 offset:9216
ds_read_b128 v[96:99], v8 offset:41984
v_mfma_f32_32x32x16_bf16 v[28:43], v[80:83], a[32:35], v[28:43]
s_add_u32 s61, s41, s63
s_add_u32 s62, s42, s63
s_add_u32 m0, s60, 16384
s_add_u32 s63, s63, 4096
s_and_b32 s63, s63, 0x7fff
ds_read_b128 v[100:103], v9 offset:9216
v_mfma_f32_32x32x16_bf16 v[44:59], v[84:87], a[32:35], v[44:59]
ds_read_b128 v[104:107], v9 offset:41984
buffer_load_dwordx4 v2, s[32:35], s61 offen offset:0 sc1 lds
v_mfma_f32_32x32x16_bf16 v[60:75], v[88:91], a[32:35], v[60:75]
buffer_load_dwordx4 a[64:67], v2, s[32:35], s62 offen offset:0 sc1
s_waitcnt lgkmcnt(0)
v_mfma_f32_32x32x16_bf16 v[12:27], v[92:95], a[36:39], v[12:27]
ds_read_b128 v[76:79], v8 offset:10240
ds_read_b128 v[80:83], v8 offset:43008
v_mfma_f32_32x32x16_bf16 v[28:43], v[96:99], a[36:39], v[28:43]
buffer_load_dwordx4 v2, s[32:35], s61 offen offset:1024 sc1 lds
v_mfma_f32_32x32x16_bf16 v[44:59], v[100:103], a[36:39], v[44:59]
ds_read_b128 v[84:87], v9 offset:10240
ds_read_b128 v[88:91], v9 offset:43008
v_mfma_f32_32x32x16_bf16 v[60:75], v[104:107], a[36:39], v[60:75]
buffer_load_dwordx4 a[68:71], v2, s[32:35], s62 offen offset:1024 sc1
s_waitcnt lgkmcnt(0)
v_mfma_f32_32x32x16_bf16 v[12:27], v[76:79], a[40:43], v[12:27]
ds_read_b128 v[92:95], v8 offset:11264
ds_read_b128 v[96:99], v8 offset:44032
v_mfma_f32_32x32x16_bf16 v[28:43], v[80:83], a[40:43], v[28:43]
buffer_load_dwordx4 v2, s[32:35], s61 offen offset:2048 sc1 lds
v_mfma_f32_32x32x16_bf16 v[44:59], v[84:87], a[40:43], v[44:59]
ds_read_b128 v[100:103], v9 offset:11264
ds_read_b128 v[104:107], v9 offset:44032
v_mfma_f32_32x32x16_bf16 v[60:75], v[88:91], a[40:43], v[60:75]
buffer_load_dwordx4 a[72:75], v2, s[32:35], s62 offen offset:2048 sc1
s_waitcnt lgkmcnt(0)
v_mfma_f32_32x32x16_bf16 v[12:27], v[92:95], a[44:47], v[12:27]
s_waitcnt vmcnt(6)
s_barrier
v_mfma_f32_32x32x16_bf16 v[28:43], v[96:99], a[44:47], v[28:43]
ds_read_b128 v[76:79], v8 offset:12288
ds_read_b128 v[80:83], v8 offset:45056
v_mfma_f32_32x32x16_bf16 v[44:59], v[100:103], a[44:47], v[44:59]
ds_read_b128 v[84:87], v9 offset:12288
ds_read_b128 v[88:91], v9 offset:45056
v_mfma_f32_32x32x16_bf16 v[60:75], v[104:107], a[44:47], v[60:75]
buffer_load_dwordx4 v2, s[32:35], s61 offen offset:3072 sc1 lds
buffer_load_dwordx4 a[76:79], v2, s[32:35], s62 offen offset:3072 sc1
s_waitcnt lgkmcnt(0)
v_mfma_f32_32x32x16_bf16 v[12:27], v[76:79], a[48:51], v[12:27]
ds_read_b128 v[92:95], v8 offset:13312
ds_read_b128 v[96:99], v8 offset:46080
v_mfma_f32_32x32x16_bf16 v[28:43], v[80:83], a[48:51], v[28:43]
s_add_u32 s61, s41, s63
s_add_u32 s62, s42, s63
s_add_u32 m0, s60, 20480
s_add_u32 s63, s63, 4096
s_and_b32 s63, s63, 0x7fff
ds_read_b128 v[100:103], v9 offset:13312
v_mfma_f32_32x32x16_bf16 v[44:59], v[84:87], a[48:51], v[44:59]
ds_read_b128 v[104:107], v9 offset:46080
buffer_load_dwordx4 v2, s[32:35], s61 offen offset:0 sc1 lds
v_mfma_f32_32x32x16_bf16 v[60:75], v[88:91], a[48:51], v[60:75]
buffer_load_dwordx4 a[80:83], v2, s[32:35], s62 offen offset:0 sc1
s_waitcnt lgkmcnt(0)
v_mfma_f32_32x32x16_bf16 v[12:27], v[92:95], a[52:55], v[12:27]
ds_read_b128 v[76:79], v8 offset:14336
ds_read_b128 v[80:83], v8 offset:47104
v_mfma_f32_32x32x16_bf16 v[28:43], v[96:99], a[52:55], v[28:43]
buffer_load_dwordx4 v2, s[32:35], s61 offen offset:1024 sc1 lds
v_mfma_f32_32x32x16_bf16 v[44:59], v[100:103], a[52:55], v[44:59]
ds_read_b128 v[84:87], v9 offset:14336
ds_read_b128 v[88:91], v9 offset:47104
v_mfma_f32_32x32x16_bf16 v[60:75], v[104:107], a[52:55], v[60:75]
buffer_load_dwordx4 a[84:87], v2, s[32:35], s62 offen offset:1024 sc1
s_waitcnt lgkmcnt(0)
v_mfma_f32_32x32x16_bf16 v[12:27], v[76:79], a[56:59], v[12:27]
ds_read_b128 v[92:95], v8 offset:15360
ds_read_b128 v[96:99], v8 offset:48128
v_mfma_f32_32x32x16_bf16 v[28:43], v[80:83], a[56:59], v[28:43]
buffer_load_dwordx4 v2, s[32:35], s61 offen offset:2048 sc1 lds
v_mfma_f32_32x32x16_bf16 v[44:59], v[84:87], a[56:59], v[44:59]
ds_read_b128 v[100:103], v9 offset:15360
ds_read_b128 v[104:107], v9 offset:48128
v_mfma_f32_32x32x16_bf16 v[60:75], v[88:91], a[56:59], v[60:75]
buffer_load_dwordx4 a[88:91], v2, s[32:35], s62 offen offset:2048 sc1
s_waitcnt lgkmcnt(0)
v_mfma_f32_32x32x16_bf16 v[12:27], v[92:95], a[60:63], v[12:27]
s_waitcnt vmcnt(6)
s_barrier
v_mfma_f32_32x32x16_bf16 v[28:43], v[96:99], a[60:63], v[28:43]
ds_read_b128 v[76:79], v8 offset:16384
ds_read_b128 v[80:83], v8 offset:49152
v_mfma_f32_32x32x16_bf16 v[44:59], v[100:103], a[60:63], v[44:59]
ds_read_b128 v[84:87], v9 offset:16384
ds_read_b128 v[88:91], v9 offset:49152
v_mfma_f32_32x32x16_bf16 v[60:75], v[104:107], a[60:63], v[60:75]
buffer_load_dwordx4 v2, s[32:35], s61 offen offset:3072 sc1 lds
buffer_load_dwordx4 a[92:95], v2, s[32:35], s62 offen offset:3072 sc1
s_waitcnt lgkmcnt(0)
v_mfma_f32_32x32x16_bf16 v[12:27], v[76:79], a[64:67], v[12:27]
ds_read_b128 v[92:95], v8 offset:17408
ds_read_b128 v[96:99], v8 offset:50176
v_mfma_f32_32x32x16_bf16 v[28:43], v[80:83], a[64:67], v[28:43]
s_add_u32 s61, s41, s63
s_add_u32 s62, s42, s63
s_add_u32 m0, s60, 24576
s_add_u32 s63, s63, 4096
s_and_b32 s63, s63, 0x7fff
ds_read_b128 v[100:103], v9 offset:17408
v_mfma_f32_32x32x16_bf16 v[44:59], v[84:87], a[64:67], v[44:59]
ds_read_b128 v[104:107], v9 offset:50176
buffer_load_dwordx4 v2, s[32:35], s61 offen offset:0 sc1 lds
v_mfma_f32_32x32x16_bf16 v[60:75], v[88:91], a[64:67], v[60:75]
buffer_load_dwordx4 a[96:99], v2, s[32:35], s62 offen offset:0 sc1
s_waitcnt lgkmcnt(0)
v_mfma_f32_32x32x16_bf16 v[12:27], v[92:95], a[68:71], v[12:27]
ds_read_b128 v[76:79], v8 offset:18432
ds_read_b128 v[80:83], v8 offset:51200
v_mfma_f32_32x32x16_bf16 v[28:43], v[96:99], a[68:71], v[28:43]
buffer_load_dwordx4 v2, s[32:35], s61 offen offset:1024 sc1 lds
v_mfma_f32_32x32x16_bf16 v[44:59], v[100:103], a[68:71], v[44:59]
ds_read_b128 v[84:87], v9 offset:18432
ds_read_b128 v[88:91], v9 offset:51200
v_mfma_f32_32x32x16_bf16 v[60:75], v[104:107], a[68:71], v[60:75]
buffer_load_dwordx4 a[100:103], v2, s[32:35], s62 offen offset:1024 sc1
s_waitcnt lgkmcnt(0)
v_mfma_f32_32x32x16_bf16 v[12:27], v[76:79], a[72:75], v[12:27]
ds_read_b128 v[92:95], v8 offset:19456
ds_read_b128 v[96:99], v8 offset:52224
v_mfma_f32_32x32x16_bf16 v[28:43], v[80:83], a[72:75], v[28:43]
buffer_load_dwordx4 v2, s[32:35], s61 offen offset:2048 sc1 lds
v_mfma_f32_32x32x16_bf16 v[44:59], v[84:87], a[72:75], v[44:59]
ds_read_b128 v[100:103], v9 offset:19456
ds_read_b128 v[104:107], v9 offset:52224
v_mfma_f32_32x32x16_bf16 v[60:75], v[88:91], a[72:75], v[60:75]
buffer_load_dwordx4 a[104:107], v2, s[32:35], s62 offen offset:2048 sc1
s_waitcnt lgkmcnt(0)
v_mfma_f32_32x32x16_bf16 v[12:27], v[92:95], a[76:79], v[12:27]
s_waitcnt vmcnt(6)
s_barrier
v_mfma_f32_32x32x16_bf16 v[28:43], v[96:99], a[76:79], v[28:43]
ds_read_b128 v[76:79], v8 offset:20480
ds_read_b128 v[80:83], v8 offset:53248
v_mfma_f32_32x32x16_bf16 v[44:59], v[100:103], a[76:79], v[44:59]
ds_read_b128 v[84:87], v9 offset:20480
ds_read_b128 v[88:91], v9 offset:53248
v_mfma_f32_32x32x16_bf16 v[60:75], v[104:107], a[76:79], v[60:75]
buffer_load_dwordx4 v2, s[32:35], s61 offen offset:3072 sc1 lds
buffer_load_dwordx4 a[108:111], v2, s[32:35], s62 offen offset:3072 sc1
s_waitcnt lgkmcnt(0)
v_mfma_f32_32x32x16_bf16 v[12:27], v[76:79], a[80:83], v[12:27]
ds_read_b128 v[92:95], v8 offset:21504
ds_read_b128 v[96:99], v8 offset:54272
v_mfma_f32_32x32x16_bf16 v[28:43], v[80:83], a[80:83], v[28:43]
s_add_u32 s61, s41, s63
s_add_u32 s62, s42, s63
s_add_u32 m0, s60, 28672
s_add_u32 s63, s63, 4096
s_and_b32 s63, s63, 0x7fff
ds_read_b128 v[100:103], v9 offset:21504
v_mfma_f32_32x32x16_bf16 v[44:59], v[84:87], a[80:83], v[44:59]
ds_read_b128 v[104:107], v9 offset:54272
buffer_load_dwordx4 v2, s[32:35], s61 offen offset:0 sc1 lds
v_mfma_f32_32x32x16_bf16 v[60:75], v[88:91], a[80:83], v[60:75]
buffer_load_dwordx4 a[112:115], v2, s[32:35], s62 offen offset:0 sc1
s_waitcnt lgkmcnt(0)
v_mfma_f32_32x32x16_bf16 v[12:27], v[92:95], a[84:87], v[12:27]
ds_read_b128 v[76:79], v8 offset:22528
ds_read_b128 v[80:83], v8 offset:55296
v_mfma_f32_32x32x16_bf16 v[28:43], v[96:99], a[84:87], v[28:43]
buffer_load_dwordx4 v2, s[32:35], s61 offen offset:1024 sc1 lds
v_mfma_f32_32x32x16_bf16 v[44:59], v[100:103], a[84:87], v[44:59]
ds_read_b128 v[84:87], v9 offset:22528
ds_read_b128 v[88:91], v9 offset:55296
v_mfma_f32_32x32x16_bf16 v[60:75], v[104:107], a[84:87], v[60:75]
buffer_load_dwordx4 a[116:119], v2, s[32:35], s62 offen offset:1024 sc1
s_waitcnt lgkmcnt(0)
v_mfma_f32_32x32x16_bf16 v[12:27], v[76:79], a[88:91], v[12:27]
ds_read_b128 v[92:95], v8 offset:23552
ds_read_b128 v[96:99], v8 offset:56320
v_mfma_f32_32x32x16_bf16 v[28:43], v[80:83], a[88:91], v[28:43]
buffer_load_dwordx4 v2, s[32:35], s61 offen offset:2048 sc1 lds
v_mfma_f32_32x32x16_bf16 v[44:59], v[84:87], a[88:91], v[44:59]
ds_read_b128 v[100:103], v9 offset:23552
ds_read_b128 v[104:107], v9 offset:56320
v_mfma_f32_32x32x16_bf16 v[60:75], v[88:91], a[88:91], v[60:75]
buffer_load_dwordx4 a[120:123], v2, s[32:35], s62 offen offset:2048 sc1
s_waitcnt lgkmcnt(0)
v_mfma_f32_32x32x16_bf16 v[12:27], v[92:95], a[92:95], v[12:27]
s_waitcnt vmcnt(6)
s_barrier
v_mfma_f32_32x32x16_bf16 v[28:43], v[96:99], a[92:95], v[28:43]
ds_read_b128 v[76:79], v8 offset:24576
ds_read_b128 v[80:83], v8 offset:57344
v_mfma_f32_32x32x16_bf16 v[44:59], v[100:103], a[92:95], v[44:59]
ds_read_b128 v[84:87], v9 offset:24576
ds_read_b128 v[88:91], v9 offset:57344
v_mfma_f32_32x32x16_bf16 v[60:75], v[104:107], a[92:95], v[60:75]
buffer_load_dwordx4 v2, s[32:35], s61 offen offset:3072 sc1 lds
buffer_load_dwordx4 a[124:127], v2, s[32:35], s62 offen offset:3072 sc1
s_waitcnt lgkmcnt(0)
v_mfma_f32_32x32x16_bf16 v[12:27], v[76:79], a[96:99], v[12:27]
ds_read_b128 v[92:95], v8 offset:25600
v_mfma_f32_32x32x16_bf16 v[28:43], v[80:83], a[96:99], v[28:43]
ds_read_b128 v[96:99], v8 offset:58368
v_mfma_f32_32x32x16_bf16 v[44:59], v[84:87], a[96:99], v[44:59]
ds_read_b128 v[100:103], v9 offset:25600
v_mfma_f32_32x32x16_bf16 v[60:75], v[88:91], a[96:99], v[60:75]
ds_read_b128 v[104:107], v9 offset:58368
s_waitcnt lgkmcnt(0)
v_mfma_f32_32x32x16_bf16 v[12:27], v[92:95], a[100:103], v[12:27]
ds_read_b128 v[76:79], v8 offset:26624
v_mfma_f32_32x32x16_bf16 v[28:43], v[96:99], a[100:103], v[28:43]
ds_read_b128 v[80:83], v8 offset:59392
v_mfma_f32_32x32x16_bf16 v[44:59], v[100:103], a[100:103], v[44:59]
ds_read_b128 v[84:87], v9 offset:26624
v_mfma_f32_32x32x16_bf16 v[60:75], v[104:107], a[100:103], v[60:75]
ds_read_b128 v[88:91], v9 offset:59392
s_waitcnt lgkmcnt(0)
v_mfma_f32_32x32x16_bf16 v[12:27], v[76:79], a[104:107], v[12:27]
ds_read_b128 v[92:95], v8 offset:27648
v_mfma_f32_32x32x16_bf16 v[28:43], v[80:83], a[104:107], v[28:43]
ds_read_b128 v[96:99], v8 offset:60416
v_mfma_f32_32x32x16_bf16 v[44:59], v[84:87], a[104:107], v[44:59]
ds_read_b128 v[100:103], v9 offset:27648
v_mfma_f32_32x32x16_bf16 v[60:75], v[88:91], a[104:107], v[60:75]
ds_read_b128 v[104:107], v9 offset:60416
s_waitcnt lgkmcnt(0)
v_mfma_f32_32x32x16_bf16 v[12:27], v[92:95], a[108:111], v[12:27]
s_waitcnt vmcnt(0)
s_barrier
v_mfma_f32_32x32x16_bf16 v[28:43], v[96:99], a[108:111], v[28:43]
ds_read_b128 v[76:79], v8 offset:28672
ds_read_b128 v[80:83], v8 offset:61440
v_mfma_f32_32x32x16_bf16 v[44:59], v[100:103], a[108:111], v[44:59]
ds_read_b128 v[84:87], v9 offset:28672
v_mfma_f32_32x32x16_bf16 v[60:75], v[104:107], a[108:111], v[60:75]
ds_read_b128 v[88:91], v9 offset:61440
s_waitcnt lgkmcnt(0)
v_mfma_f32_32x32x16_bf16 v[12:27], v[76:79], a[112:115], v[12:27]
ds_read_b128 v[92:95], v8 offset:29696
v_mfma_f32_32x32x16_bf16 v[28:43], v[80:83], a[112:115], v[28:43]
ds_read_b128 v[96:99], v8 offset:62464
v_mfma_f32_32x32x16_bf16 v[44:59], v[84:87], a[112:115], v[44:59]
ds_read_b128 v[100:103], v9 offset:29696
v_mfma_f32_32x32x16_bf16 v[60:75], v[88:91], a[112:115], v[60:75]
ds_read_b128 v[104:107], v9 offset:62464
s_waitcnt lgkmcnt(0)
v_mfma_f32_32x32x16_bf16 v[12:27], v[92:95], a[116:119], v[12:27]
ds_read_b128 v[76:79], v8 offset:30720
v_mfma_f32_32x32x16_bf16 v[28:43], v[96:99], a[116:119], v[28:43]
ds_read_b128 v[80:83], v8 offset:63488
v_mfma_f32_32x32x16_bf16 v[44:59], v[100:103], a[116:119], v[44:59]
ds_read_b128 v[84:87], v9 offset:30720
v_mfma_f32_32x32x16_bf16 v[60:75], v[104:107], a[116:119], v[60:75]
ds_read_b128 v[88:91], v9 offset:63488
s_waitcnt lgkmcnt(0)
v_mfma_f32_32x32x16_bf16 v[12:27], v[76:79], a[120:123], v[12:27]
ds_read_b128 v[92:95], v8 offset:31744
v_mfma_f32_32x32x16_bf16 v[28:43], v[80:83], a[120:123], v[28:43]
ds_read_b128 v[96:99], v8 offset:64512
v_mfma_f32_32x32x16_bf16 v[44:59], v[84:87], a[120:123], v[44:59]
ds_read_b128 v[100:103], v9 offset:31744
v_mfma_f32_32x32x16_bf16 v[60:75], v[88:91], a[120:123], v[60:75]
ds_read_b128 v[104:107], v9 offset:64512
s_waitcnt lgkmcnt(0)
v_mfma_f32_32x32x16_bf16 v[12:27], v[92:95], a[124:127], v[12:27]
v_mfma_f32_32x32x16_bf16 v[28:43], v[96:99], a[124:127], v[28:43]
v_mfma_f32_32x32x16_bf16 v[44:59], v[100:103], a[124:127], v[44:59]
v_mfma_f32_32x32x16_bf16 v[60:75], v[104:107], a[124:127], v[60:75]
v_lshlrev_b32 v3, 4, v0
s_nop 7
v_cvt_pk_bf16_f32 v108, v12, v13
v_cvt_pk_bf16_f32 v109, v14, v15
v_cvt_pk_bf16_f32 v110, v16, v17
v_cvt_pk_bf16_f32 v111, v18, v19
v_cvt_pk_bf16_f32 v112, v20, v21
v_cvt_pk_bf16_f32 v113, v22, v23
v_cvt_pk_bf16_f32 v114, v24, v25
v_cvt_pk_bf16_f32 v115, v26, v27
s_add_u32 s48, s43, 0
buffer_store_dwordx4 v[108:111], v2, s[32:35], s48 offen offset:0 sc1
buffer_store_dwordx4 v[112:115], v2, s[32:35], s48 offen offset:1024 sc1
v_cvt_pk_bf16_f32 v116, v28, v29
v_cvt_pk_bf16_f32 v117, v30, v31
v_cvt_pk_bf16_f32 v118, v32, v33
v_cvt_pk_bf16_f32 v119, v34, v35
v_cvt_pk_bf16_f32 v120, v36, v37
v_cvt_pk_bf16_f32 v121, v38, v39
v_cvt_pk_bf16_f32 v122, v40, v41
v_cvt_pk_bf16_f32 v123, v42, v43
buffer_store_dwordx4 v[116:119], v2, s[32:35], s48 offen offset:2048 sc1
buffer_store_dwordx4 v[120:123], v2, s[32:35], s48 offen offset:3072 sc1
v_cvt_pk_bf16_f32 v108, v44, v45
v_cvt_pk_bf16_f32 v109, v46, v47
v_cvt_pk_bf16_f32 v110, v48, v49
v_cvt_pk_bf16_f32 v111, v50, v51
v_cvt_pk_bf16_f32 v112, v52, v53
v_cvt_pk_bf16_f32 v113, v54, v55
v_cvt_pk_bf16_f32 v114, v56, v57
v_cvt_pk_bf16_f32 v115, v58, v59
s_add_u32 s48, s43, 4096
buffer_store_dwordx4 v[108:111], v2, s[32:35], s48 offen offset:0 sc1
buffer_store_dwordx4 v[112:115], v2, s[32:35], s48 offen offset:1024 sc1
v_cvt_pk_bf16_f32 v116, v60, v61
v_cvt_pk_bf16_f32 v117, v62, v63
v_cvt_pk_bf16_f32 v118, v64, v65
v_cvt_pk_bf16_f32 v119, v66, v67
v_cvt_pk_bf16_f32 v120, v68, v69
v_cvt_pk_bf16_f32 v121, v70, v71
v_cvt_pk_bf16_f32 v122, v72, v73
v_cvt_pk_bf16_f32 v123, v74, v75
buffer_store_dwordx4 v[116:119], v2, s[32:35], s48 offen offset:2048 sc1
buffer_store_dwordx4 v[120:123], v2, s[32:35], s48 offen offset:3072 sc1
s_mov_b64 exec, -1
v_mov_b32 v5, 1
s_waitcnt vmcnt(0) lgkmcnt(0)
s_barrier
s_cmp_lg_u32 s28, 0
s_cbranch_scc1 L_p2_nopub_15
s_mov_b64 exec, 1
buffer_store_dword v5, off, s[32:35], s65 sc1
s_mov_b64 exec, -1
L_p2_nopub_15:
s_mov_b32 s73, 0
s_branch L_p3_start
L_p2_conv:
s_and_b32 s50, s48, 3
s_lshl_b32 s50, s50, 1
s_lshr_b32 s51, s49, 2
s_add_u32 s50, s50, s51
s_and_b32 s51, s49, 3
s_mul_i32 s52, s50, 125
s_lshl_b32 s53, s51, 5
s_add_u32 s52, s52, s53
s_mul_i32 s53, s40, 1000
s_add_u32 s53, s53, s52
s_mov_b32 s64, s53
s_lshl_b32 s53, s53, 6
s_add_u32 s56, s53, 0x7f3c40
s_add_u32 s57, s53, 0x600000
s_mov_b32 s58, s52
s_lshl_b32 s53, s40, 3
s_add_u32 s53, s53, s50
s_lshl_b32 s53, s53, 2
s_add_u32 s53, s53, s51
s_lshl_b32 s53, s53, 15
s_add_u32 s43, s53, 0x1200000
s_lshr_b32 s65, s53, 15
s_add_u32 s65, s65, 192
s_lshl_b32 s65, s65, 7
s_add_u32 s65, s65, 0xb50000
s_lshl_b32 s59, s28, 15
v_lshrrev_b32 v3, 4, v1
v_lshlrev_b32 v6, 10, v3
v_and_b32 v5, 15, v1
v_lshl_add_u32 v242, v5, 4, v6
s_lshl_b32 s53, s28, 8
v_add_u32 v242, s53, v242
v_lshlrev_b32 v243, 6, v3
v_and_b32 v6, 3, v1
v_lshl_add_u32 v243, v6, 4, v243
v_bfe_u32 v6, v1, 2, 2
s_lshl_b32 s53, s28, 2
v_add_u32 v6, s53, v6
s_mov_b32 s53, 128000
v_mul_lo_u32 v6, s53, v6
v_add_u32 v243, v243, v6
v_lshrrev_b32 v3, 2, v1
s_lshl_b32 s53, s28, 4
v_add_u32 v3, s53, v3
v_and_b32 v5, 3, v1
s_sub_u32 s53, s64, 15
v_add_u32 v6, s53, v3
v_lshlrev_b32 v6, 3, v6
v_mul_u32_u24 v7, 49152, v5
v_add_u32 v6, v6, v7
s_waitcnt lgkmcnt(0)
s_mov_b32 s32, s26
s_and_b32 s33, s27, 0xffff
s_mov_b32 s34, 0x1440000
s_mov_b32 s35, 0x20000
s_mov_b32 s36, s16
s_and_b32 s37, s17, 0xffff
s_mov_b32 s38, 0x7c00
s_mov_b32 s39, 0x20000
s_add_u32 m0, s59, 16384
s_mov_b32 s62, 0
buffer_load_dwordx4 v242, s[36:39], s62 offen lds
s_add_u32 m0, s59, 17408
s_mov_b32 s62, 4096
buffer_load_dwordx4 v242, s[36:39], s62 offen lds
s_add_u32 m0, s59, 18432
s_mov_b32 s62, 8192
buffer_load_dwordx4 v242, s[36:39], s62 offen lds
s_add_u32 m0, s59, 19456
s_mov_b32 s62, 12288
buffer_load_dwordx4 v242, s[36:39], s62 offen lds
s_add_u32 m0, s59, 20480
s_mov_b32 s62, 16384
buffer_load_dwordx4 v242, s[36:39], s62 offen lds
s_add_u32 m0, s59, 21504
s_mov_b32 s62, 20480
buffer_load_dwordx4 v242, s[36:39], s62 offen lds
s_add_u32 m0, s59, 22528
s_mov_b32 s62, 24576
buffer_load_dwordx4 v242, s[36:39], s62 offen lds
s_mov_b32 exec_hi, 0xffff
s_add_u32 m0, s59, 23552
s_mov_b32 s62, 28672
buffer_load_dwordx4 v242, s[36:39], s62 offen lds
s_mov_b32 exec_hi, -1
v_lshlrev_b32 v244, 2, v1
v_add_u32 v244, s59, v244
v_add_u32 v245, 16384, v244
v_add_u32 v248, 24576, v244
v_mov_b32 v246, 0xffff0000
v_add_u32 v249, 16128, v244
v_mov_b32 v247, 131072
s_waitcnt vmcnt(0)
ds_read2st64_b32 v[8:9], v245 offset0:0 offset1:1
ds_read2st64_b32 v[10:11], v245 offset0:2 offset1:3
ds_read2st64_b32 v[12:13], v245 offset0:4 offset1:5
ds_read2st64_b32 v[14:15], v245 offset0:6 offset1:7
ds_read2st64_b32 v[16:17], v245 offset0:8 offset1:9
ds_read2st64_b32 v[18:19], v245 offset0:10 offset1:11
ds_read2st64_b32 v[20:21], v245 offset0:12 offset1:13
ds_read2st64_b32 v[22:23], v245 offset0:14 offset1:15
s_waitcnt lgkmcnt(2)
ds_read2st64_b32 v[24:25], v245 offset0:16 offset1:17
ds_read2st64_b32 v[26:27], v245 offset0:18 offset1:19
ds_read2st64_b32 v[28:29], v245 offset0:20 offset1:21
ds_read2st64_b32 v[30:31], v245 offset0:22 offset1:23
ds_read2st64_b32 v[32:33], v245 offset0:24 offset1:25
ds_read2st64_b32 v[34:35], v245 offset0:26 offset1:27
ds_read2st64_b32 v[36:37], v245 offset0:28 offset1:29
ds_read2st64_b32 v[38:39], v245 offset0:30 offset1:31
s_waitcnt lgkmcnt(3)
v_lshlrev_b32 v108, 16, v8
v_and_b32 v109, v246, v8
v_lshlrev_b32 v140, 16, v9
v_and_b32 v141, v246, v9
v_lshlrev_b32 v110, 16, v10
v_and_b32 v111, v246, v10
v_lshlrev_b32 v142, 16, v11
v_and_b32 v143, v246, v11
v_lshlrev_b32 v112, 16, v12
v_and_b32 v113, v246, v12
v_lshlrev_b32 v144, 16, v13
v_and_b32 v145, v246, v13
v_lshlrev_b32 v114, 16, v14
v_and_b32 v115, v246, v14
v_lshlrev_b32 v146, 16, v15
v_and_b32 v147, v246, v15
s_waitcnt lgkmcnt(0)
v_lshlrev_b32 v116, 16, v16
v_and_b32 v117, v246, v16
v_lshlrev_b32 v148, 16, v17
v_and_b32 v149, v246, v17
v_lshlrev_b32 v118, 16, v18
v_and_b32 v119, v246, v18
v_lshlrev_b32 v150, 16, v19
v_and_b32 v151, v246, v19
v_lshlrev_b32 v120, 16, v20
v_and_b32 v121, v246, v20
v_lshlrev_b32 v152, 16, v21
v_and_b32 v153, v246, v21
v_lshlrev_b32 v122, 16, v22
v_and_b32 v123, v246, v22
v_lshlrev_b32 v154, 16, v23
v_and_b32 v155, v246, v23
s_waitcnt lgkmcnt(0)
v_lshlrev_b32 v124, 16, v24
v_and_b32 v125, v246, v24
v_lshlrev_b32 v156, 16, v25
v_and_b32 v157, v246, v25
v_lshlrev_b32 v126, 16, v26
v_and_b32 v127, v246, v26
v_lshlrev_b32 v158, 16, v27
v_and_b32 v159, v246, v27
v_lshlrev_b32 v128, 16, v28
v_and_b32 v129, v246, v28
v_lshlrev_b32 v160, 16, v29
v_and_b32 v161, v246, v29
v_lshlrev_b32 v130, 16, v30
v_and_b32 v131, v246, v30
v_lshlrev_b32 v162, 16, v31
v_and_b32 v163, v246, v31
s_waitcnt lgkmcnt(0)
v_lshlrev_b32 v132, 16, v32
v_and_b32 v133, v246, v32
v_lshlrev_b32 v164, 16, v33
v_and_b32 v165, v246, v33
v_lshlrev_b32 v134, 16, v34
v_and_b32 v135, v246, v34
v_lshlrev_b32 v166, 16, v35
v_and_b32 v167, v246, v35
v_lshlrev_b32 v136, 16, v36
v_and_b32 v137, v246, v36
v_lshlrev_b32 v168, 16, v37
v_and_b32 v169, v246, v37
v_lshlrev_b32 v138, 16, v38
v_and_b32 v139, v246, v38
v_pk_add_f32 v[170:171], v[108:109], v[140:141]
v_pk_add_f32 v[172:173], v[110:111], v[142:143]
v_pk_add_f32 v[174:175], v[112:113], v[144:145]
v_pk_add_f32 v[176:177], v[114:115], v[146:147]
v_pk_add_f32 v[178:179], v[116:117], v[148:149]
v_pk_add_f32 v[180:181], v[118:119], v[150:151]
v_pk_add_f32 v[182:183], v[120:121], v[152:153]
v_pk_add_f32 v[184:185], v[122:123], v[154:155]
v_pk_add_f32 v[186:187], v[124:125], v[156:157]
v_pk_add_f32 v[188:189], v[126:127], v[158:159]
v_pk_add_f32 v[190:191], v[128:129], v[160:161]
v_pk_add_f32 v[192:193], v[130:131], v[162:163]
v_pk_add_f32 v[194:195], v[132:133], v[164:165]
v_pk_add_f32 v[196:197], v[134:135], v[166:167]
v_pk_add_f32 v[198:199], v[136:137], v[168:169]
s_lshl_b32 s53, s40, 3
s_add_u32 s53, s53, s50
s_add_u32 s53, s53, 15
v_mul_u32_u24 v234, 4682, v1
v_lshrrev_b32 v234, 16, v234
v_mul_u32_u24 v235, 14, v234
v_sub_u32 v235, v1, v235
v_add_u32 v234, s53, v234
v_and_b32 v234, 15, v234
v_mul_u32_u24 v234, 14, v234
v_add_u32 v234, v234, v235
v_mov_b32 v235, 224
v_cmp_eq_u32 vcc, 42, v1
s_nop 1
v_cndmask_b32 v234, v234, v235, vcc
v_lshlrev_b32 v234, 7, v234
v_add_u32 v234, 0xb58000, v234
v_mov_b32 v235, 0x7ff00000
v_cmp_gt_u32 vcc, 43, v1
s_nop 1
v_cndmask_b32 v234, v235, v234, vcc
s_mov_b32 s66, 0x100000
L_p2_ppc_16:
buffer_load_dword v235, v234, s[32:35], 0 offen sc1
s_waitcnt vmcnt(0)
v_cmp_eq_u32 vcc, 1, v235
s_nop 4
s_and_b32 vcc_lo, vcc_lo, 0xffffffff
s_cmp_lg_u32 vcc_lo, 0xffffffff
s_cbranch_scc1 L_p2_ppnc_18
s_and_b32 vcc_hi, vcc_hi, 0x7ff
s_cmp_lg_u32 vcc_hi, 0x7ff
s_cbranch_scc1 L_p2_ppnc_18
s_branch L_p2_ppokc_17
L_p2_ppnc_18:
s_sub_u32 s66, s66, 1
s_cmp_eq_u32 s66, 0
s_cbranch_scc1 L_p2_ppokc_17
s_sleep 2
s_branch L_p2_ppc_16
L_p2_ppokc_17:
s_mov_b32 s53, 0xb10000
buffer_load_dwordx2 v[40:41], v6, s[32:35], s53 offen sc1
s_mov_b32 s53, 0xb14000
buffer_load_dwordx2 v[42:43], v6, s[32:35], s53 offen sc1
s_mov_b32 s53, 0xb18000
buffer_load_dwordx2 v[44:45], v6, s[32:35], s53 offen sc1
s_add_u32 m0, s59, 7168
s_add_u32 s62, s56, 1792
buffer_load_dwordx4 v243, s[32:35], s62 offen sc1 lds
s_add_u32 m0, s59, 8192
s_add_u32 s62, s56, 2048
buffer_load_dwordx4 v243, s[32:35], s62 offen sc1 lds
s_add_u32 m0, s59, 6144
s_add_u32 s62, s56, 1536
buffer_load_dwordx4 v243, s[32:35], s62 offen sc1 lds
s_add_u32 m0, s59, 9216
s_add_u32 s62, s56, 2304
buffer_load_dwordx4 v243, s[32:35], s62 offen sc1 lds
s_add_u32 m0, s59, 5120
s_add_u32 s62, s56, 1280
buffer_load_dwordx4 v243, s[32:35], s62 offen sc1 lds
s_add_u32 m0, s59, 10240
s_add_u32 s62, s56, 2560
buffer_load_dwordx4 v243, s[32:35], s62 offen sc1 lds
s_waitcnt vmcnt(6)
v_pk_add_f32 v[40:41], v[40:41], v[42:43]
v_pk_add_f32 v[40:41], v[40:41], v[44:45]
s_nop 1
v_add_f32_dpp v40, v40, v40 quad_perm:[1,0,3,2] row_mask:0xf bank_mask:0xf
v_add_f32_dpp v41, v41, v41 quad_perm:[1,0,3,2] row_mask:0xf bank_mask:0xf
s_nop 0
v_add_f32_dpp v40, v40, v40 quad_perm:[2,3,0,1] row_mask:0xf bank_mask:0xf
v_add_f32_dpp v41, v41, v41 quad_perm:[2,3,0,1] row_mask:0xf bank_mask:0xf
v_mul_f32 v224, 0x3b000000, v40
v_mul_f32 v225, 0x3b000000, v41
v_fma_f32 v225, -v224, v224, v225
v_max_f32 v225, 0, v225
v_add_f32 v225, 0x3727c5ac, v225
v_rsq_f32 v225, v225
s_nop 0
v_mul_f32 v6, v224, v225
v_sub_f32 v6, 0, v6
s_sub_u32 s53, s58, 15
v_add_u32 v7, s53, v3
v_cmp_gt_u32 vcc, 1000, v7
s_nop 1
v_cndmask_b32 v224, 0, v225, vcc
v_cndmask_b32 v225, 0, v6, vcc
v_lshlrev_b32 v6, 3, v3
v_add_u32 v6, 131072, v6
v_cmp_eq_u32 vcc, 0, v5
s_nop 3
s_and_saveexec_b64 s[54:55], vcc
ds_write_b64 v6, v[224:225]
s_mov_b64 exec, s[54:55]
s_waitcnt lgkmcnt(0)
s_barrier
s_waitcnt vmcnt(5)
ds_read_b128 v[200:203], v247 offset:240
ds_read2st64_b32 v[234:235], v244 offset0:30 offset1:31
s_waitcnt vmcnt(4)
ds_read_b128 v[204:207], v247 offset:256
ds_read2st64_b32 v[236:237], v244 offset0:32 offset1:33
ds_read2st64_b32 v[238:239], v244 offset0:28 offset1:29
s_add_u32 m0, s59, 4096
s_add_u32 s62, s56, 1024
buffer_load_dwordx4 v243, s[32:35], s62 offen sc1 lds
s_add_u32 m0, s59, 11264
s_add_u32 s62, s56, 2816
buffer_load_dwordx4 v243, s[32:35], s62 offen sc1 lds
s_waitcnt lgkmcnt(3)
v_lshlrev_b32 v216, 16, v234
v_and_b32 v217, v246, v234
v_pk_fma_f32 v[216:217], v[216:217], v[200:201], v[200:201] op_sel:[0,0,1] op_sel_hi:[1,0,1]
v_lshlrev_b32 v212, 16, v235
v_and_b32 v213, v246, v235
v_pk_fma_f32 v[212:213], v[212:213], v[202:203], v[202:203] op_sel:[0,0,1] op_sel_hi:[1,0,1]
ds_read_b128 v[208:211], v247 offset:224
ds_read2st64_b32 v[240:241], v244 offset0:34 offset1:35
v_pk_mul_f32 v[8:9], v[216:217], v[138:139]
v_pk_mul_f32 v[10:11], v[216:217], v[136:137]
v_pk_mul_f32 v[12:13], v[216:217], v[134:135]
v_pk_mul_f32 v[14:15], v[216:217], v[132:133]
v_pk_mul_f32 v[16:17], v[216:217], v[130:131]
v_pk_mul_f32 v[18:19], v[216:217], v[128:129]
v_pk_mul_f32 v[20:21], v[216:217], v[126:127]
v_pk_mul_f32 v[22:23], v[216:217], v[124:125]
v_pk_mul_f32 v[24:25], v[216:217], v[122:123]
v_pk_mul_f32 v[26:27], v[216:217], v[120:121]
v_pk_mul_f32 v[28:29], v[216:217], v[118:119]
v_pk_mul_f32 v[30:31], v[216:217], v[116:117]
v_pk_mul_f32 v[32:33], v[216:217], v[114:115]
v_pk_mul_f32 v[34:35], v[216:217], v[112:113]
v_pk_mul_f32 v[36:37], v[216:217], v[110:111]
v_pk_mul_f32 v[38:39], v[216:217], v[108:109]
v_pk_mul_f32 v[44:45], v[212:213], v[168:169]
v_pk_mul_f32 v[46:47], v[212:213], v[166:167]
v_pk_mul_f32 v[48:49], v[212:213], v[164:165]
v_pk_mul_f32 v[50:51], v[212:213], v[162:163]
v_pk_mul_f32 v[52:53], v[212:213], v[160:161]
v_pk_mul_f32 v[54:55], v[212:213], v[158:159]
v_pk_mul_f32 v[56:57], v[212:213], v[156:157]
v_pk_mul_f32 v[58:59], v[212:213], v[154:155]
v_pk_mul_f32 v[60:61], v[212:213], v[152:153]
v_pk_mul_f32 v[62:63], v[212:213], v[150:151]
v_pk_mul_f32 v[64:65], v[212:213], v[148:149]
v_pk_mul_f32 v[66:67], v[212:213], v[146:147]
v_pk_mul_f32 v[68:69], v[212:213], v[144:145]
v_pk_mul_f32 v[70:71], v[212:213], v[142:143]
v_pk_mul_f32 v[72:73], v[212:213], v[140:141]
s_add_u32 m0, s59, 3072
s_add_u32 s62, s56, 768
buffer_load_dwordx4 v243, s[32:35], s62 offen sc1 lds
s_add_u32 m0, s59, 12288
s_add_u32 s62, s56, 3072
buffer_load_dwordx4 v243, s[32:35], s62 offen sc1 lds
s_waitcnt lgkmcnt(3)
v_lshlrev_b32 v220, 16, v236
v_and_b32 v221, v246, v236
v_pk_fma_f32 v[220:221], v[220:221], v[204:205], v[204:205] op_sel:[0,0,1] op_sel_hi:[1,0,1]
v_lshlrev_b32 v214, 16, v237
v_and_b32 v215, v246, v237
v_pk_fma_f32 v[214:215], v[214:215], v[206:207], v[206:207] op_sel:[0,0,1] op_sel_hi:[1,0,1]
ds_read_b128 v[200:203], v247 offset:272
s_waitcnt vmcnt(7)
ds_read2st64_b32 v[234:235], v244 offset0:26 offset1:27
v_pk_fma_f32 v[10:11], v[220:221], v[138:139], v[10:11]
v_pk_fma_f32 v[12:13], v[220:221], v[136:137], v[12:13]
v_pk_fma_f32 v[14:15], v[220:221], v[134:135], v[14:15]
v_pk_fma_f32 v[16:17], v[220:221], v[132:133], v[16:17]
v_pk_add_f32 v[224:225], v[212:213], v[220:221]
v_pk_fma_f32 v[18:19], v[220:221], v[130:131], v[18:19]
v_pk_fma_f32 v[20:21], v[220:221], v[128:129], v[20:21]
v_pk_fma_f32 v[22:23], v[220:221], v[126:127], v[22:23]
v_pk_fma_f32 v[24:25], v[220:221], v[124:125], v[24:25]
v_pk_fma_f32 v[26:27], v[220:221], v[122:123], v[26:27]
v_pk_fma_f32 v[28:29], v[220:221], v[120:121], v[28:29]
v_pk_fma_f32 v[30:31], v[220:221], v[118:119], v[30:31]
v_pk_fma_f32 v[32:33], v[220:221], v[116:117], v[32:33]
v_pk_fma_f32 v[34:35], v[220:221], v[114:115], v[34:35]
v_pk_fma_f32 v[36:37], v[220:221], v[112:113], v[36:37]
v_pk_fma_f32 v[38:39], v[220:221], v[110:111], v[38:39]
v_pk_mul_f32 v[40:41], v[220:221], v[108:109]
v_pk_fma_f32 v[46:47], v[214:215], v[168:169], v[46:47]
v_pk_fma_f32 v[48:49], v[214:215], v[166:167], v[48:49]
v_pk_fma_f32 v[50:51], v[214:215], v[164:165], v[50:51]
v_pk_fma_f32 v[52:53], v[214:215], v[162:163], v[52:53]
v_pk_fma_f32 v[54:55], v[214:215], v[160:161], v[54:55]
v_pk_fma_f32 v[56:57], v[214:215], v[158:159], v[56:57]
v_pk_fma_f32 v[58:59], v[214:215], v[156:157], v[58:59]
v_pk_fma_f32 v[60:61], v[214:215], v[154:155], v[60:61]
v_pk_fma_f32 v[62:63], v[214:215], v[152:153], v[62:63]
v_pk_fma_f32 v[64:65], v[214:215], v[150:151], v[64:65]
v_pk_fma_f32 v[66:67], v[214:215], v[148:149], v[66:67]
v_pk_fma_f32 v[68:69], v[214:215], v[146:147], v[68:69]
v_pk_fma_f32 v[70:71], v[214:215], v[144:145], v[70:71]
v_pk_fma_f32 v[72:73], v[214:215], v[142:143], v[72:73]
v_pk_mul_f32 v[74:75], v[224:225], v[138:139]
v_pk_mul_f32 v[76:77], v[224:225], v[198:199]
v_pk_mul_f32 v[78:79], v[224:225], v[196:197]
v_pk_mul_f32 v[80:81], v[224:225], v[194:195]
v_pk_mul_f32 v[82:83], v[224:225], v[192:193]
v_pk_mul_f32 v[84:85], v[224:225], v[190:191]
v_pk_mul_f32 v[86:87], v[224:225], v[188:189]
v_pk_mul_f32 v[88:89], v[224:225], v[186:187]
v_pk_mul_f32 v[90:91], v[224:225], v[184:185]
v_pk_mul_f32 v[92:93], v[224:225], v[182:183]
v_pk_mul_f32 v[94:95], v[224:225], v[180:181]
v_pk_mul_f32 v[96:97], v[224:225], v[178:179]
v_pk_mul_f32 v[98:99], v[224:225], v[176:177]
v_pk_mul_f32 v[100:101], v[224:225], v[174:175]
v_pk_mul_f32 v[102:103], v[224:225], v[172:173]
v_pk_mul_f32 v[104:105], v[224:225], v[170:171]
s_add_u32 m0, s59, 24576
s_add_u32 s62, s57, 0
buffer_load_dwordx4 v243, s[32:35], s62 offen sc1 lds
s_add_u32 m0, s59, 25600
s_add_u32 s62, s57, 256
buffer_load_dwordx4 v243, s[32:35], s62 offen sc1 lds
s_waitcnt lgkmcnt(3)
v_lshlrev_b32 v218, 16, v238
v_and_b32 v219, v246, v238
v_pk_fma_f32 v[218:219], v[218:219], v[208:209], v[208:209] op_sel:[0,0,1] op_sel_hi:[1,0,1]
v_lshlrev_b32 v222, 16, v239
v_and_b32 v223, v246, v239
v_pk_fma_f32 v[222:223], v[222:223], v[210:211], v[210:211] op_sel:[0,0,1] op_sel_hi:[1,0,1]
ds_read_b128 v[204:207], v247 offset:208
s_waitcnt vmcnt(8)
ds_read2st64_b32 v[236:237], v244 offset0:36 offset1:37
v_pk_fma_f32 v[8:9], v[218:219], v[136:137], v[8:9]
v_pk_fma_f32 v[10:11], v[218:219], v[134:135], v[10:11]
v_pk_fma_f32 v[12:13], v[218:219], v[132:133], v[12:13]
v_pk_fma_f32 v[14:15], v[218:219], v[130:131], v[14:15]
v_pk_add_f32 v[224:225], v[222:223], v[216:217]
v_pk_fma_f32 v[16:17], v[218:219], v[128:129], v[16:17]
v_pk_fma_f32 v[18:19], v[218:219], v[126:127], v[18:19]
v_pk_fma_f32 v[20:21], v[218:219], v[124:125], v[20:21]
v_pk_fma_f32 v[22:23], v[218:219], v[122:123], v[22:23]
v_pk_fma_f32 v[24:25], v[218:219], v[120:121], v[24:25]
v_pk_fma_f32 v[26:27], v[218:219], v[118:119], v[26:27]
v_pk_fma_f32 v[28:29], v[218:219], v[116:117], v[28:29]
v_pk_fma_f32 v[30:31], v[218:219], v[114:115], v[30:31]
v_pk_fma_f32 v[32:33], v[218:219], v[112:113], v[32:33]
v_pk_fma_f32 v[34:35], v[218:219], v[110:111], v[34:35]
v_pk_fma_f32 v[36:37], v[218:219], v[108:109], v[36:37]
v_pk_mul_f32 v[42:43], v[222:223], v[168:169]
v_pk_fma_f32 v[44:45], v[222:223], v[166:167], v[44:45]
v_pk_fma_f32 v[46:47], v[222:223], v[164:165], v[46:47]
v_pk_fma_f32 v[48:49], v[222:223], v[162:163], v[48:49]
v_pk_fma_f32 v[50:51], v[222:223], v[160:161], v[50:51]
v_pk_fma_f32 v[52:53], v[222:223], v[158:159], v[52:53]
v_pk_fma_f32 v[54:55], v[222:223], v[156:157], v[54:55]
v_pk_fma_f32 v[56:57], v[222:223], v[154:155], v[56:57]
v_pk_fma_f32 v[58:59], v[222:223], v[152:153], v[58:59]
v_pk_fma_f32 v[60:61], v[222:223], v[150:151], v[60:61]
v_pk_fma_f32 v[62:63], v[222:223], v[148:149], v[62:63]
v_pk_fma_f32 v[64:65], v[222:223], v[146:147], v[64:65]
v_pk_fma_f32 v[66:67], v[222:223], v[144:145], v[66:67]
v_pk_fma_f32 v[68:69], v[222:223], v[142:143], v[68:69]
v_pk_fma_f32 v[70:71], v[222:223], v[140:141], v[70:71]
v_pk_fma_f32 v[74:75], v[224:225], v[198:199], v[74:75]
v_pk_fma_f32 v[76:77], v[224:225], v[196:197], v[76:77]
v_pk_fma_f32 v[78:79], v[224:225], v[194:195], v[78:79]
v_pk_fma_f32 v[80:81], v[224:225], v[192:193], v[80:81]
v_pk_fma_f32 v[82:83], v[224:225], v[190:191], v[82:83]
v_pk_fma_f32 v[84:85], v[224:225], v[188:189], v[84:85]
v_pk_fma_f32 v[86:87], v[224:225], v[186:187], v[86:87]
v_pk_fma_f32 v[88:89], v[224:225], v[184:185], v[88:89]
v_pk_fma_f32 v[90:91], v[224:225], v[182:183], v[90:91]
v_pk_fma_f32 v[92:93], v[224:225], v[180:181], v[92:93]
v_pk_fma_f32 v[94:95], v[224:225], v[178:179], v[94:95]
v_pk_fma_f32 v[96:97], v[224:225], v[176:177], v[96:97]
v_pk_fma_f32 v[98:99], v[224:225], v[174:175], v[98:99]
v_pk_fma_f32 v[100:101], v[224:225], v[172:173], v[100:101]
v_pk_fma_f32 v[102:103], v[224:225], v[170:171], v[102:103]
s_add_u32 m0, s59, 26624
s_add_u32 s62, s57, 512
buffer_load_dwordx4 v243, s[32:35], s62 offen sc1 lds
s_add_u32 m0, s59, 27648
s_add_u32 s62, s57, 768
buffer_load_dwordx4 v243, s[32:35], s62 offen sc1 lds
s_waitcnt lgkmcnt(3)
v_lshlrev_b32 v220, 16, v240
v_and_b32 v221, v246, v240
v_pk_fma_f32 v[220:221], v[220:221], v[200:201], v[200:201] op_sel:[0,0,1] op_sel_hi:[1,0,1]
v_lshlrev_b32 v212, 16, v241
v_and_b32 v213, v246, v241
v_pk_fma_f32 v[212:213], v[212:213], v[202:203], v[202:203] op_sel:[0,0,1] op_sel_hi:[1,0,1]
ds_read_b128 v[208:211], v247 offset:288
ds_read2st64_b32 v[238:239], v244 offset0:24 offset1:25
v_pk_fma_f32 v[12:13], v[220:221], v[138:139], v[12:13]
v_pk_fma_f32 v[14:15], v[220:221], v[136:137], v[14:15]
v_pk_fma_f32 v[16:17], v[220:221], v[134:135], v[16:17]
v_pk_fma_f32 v[18:19], v[220:221], v[132:133], v[18:19]
v_pk_add_f32 v[224:225], v[214:215], v[220:221]
v_pk_fma_f32 v[20:21], v[220:221], v[130:131], v[20:21]
v_pk_fma_f32 v[22:23], v[220:221], v[128:129], v[22:23]
v_pk_fma_f32 v[24:25], v[220:221], v[126:127], v[24:25]
v_pk_fma_f32 v[26:27], v[220:221], v[124:125], v[26:27]
v_pk_fma_f32 v[28:29], v[220:221], v[122:123], v[28:29]
v_pk_fma_f32 v[30:31], v[220:221], v[120:121], v[30:31]
v_pk_fma_f32 v[32:33], v[220:221], v[118:119], v[32:33]
v_pk_fma_f32 v[34:35], v[220:221], v[116:117], v[34:35]
v_pk_fma_f32 v[36:37], v[220:221], v[114:115], v[36:37]
v_pk_fma_f32 v[38:39], v[220:221], v[112:113], v[38:39]
v_pk_fma_f32 v[40:41], v[220:221], v[110:111], v[40:41]
v_pk_fma_f32 v[48:49], v[212:213], v[168:169], v[48:49]
v_pk_fma_f32 v[50:51], v[212:213], v[166:167], v[50:51]
v_pk_fma_f32 v[52:53], v[212:213], v[164:165], v[52:53]
v_pk_fma_f32 v[54:55], v[212:213], v[162:163], v[54:55]
v_pk_fma_f32 v[56:57], v[212:213], v[160:161], v[56:57]
v_pk_fma_f32 v[58:59], v[212:213], v[158:159], v[58:59]
v_pk_fma_f32 v[60:61], v[212:213], v[156:157], v[60:61]
v_pk_fma_f32 v[62:63], v[212:213], v[154:155], v[62:63]
v_pk_fma_f32 v[64:65], v[212:213], v[152:153], v[64:65]
v_pk_fma_f32 v[66:67], v[212:213], v[150:151], v[66:67]
v_pk_fma_f32 v[68:69], v[212:213], v[148:149], v[68:69]
v_pk_fma_f32 v[70:71], v[212:213], v[146:147], v[70:71]
v_pk_fma_f32 v[72:73], v[212:213], v[144:145], v[72:73]
v_pk_fma_f32 v[76:77], v[224:225], v[138:139], v[76:77]
v_pk_fma_f32 v[78:79], v[224:225], v[198:199], v[78:79]
v_pk_fma_f32 v[80:81], v[224:225], v[196:197], v[80:81]
v_pk_fma_f32 v[82:83], v[224:225], v[194:195], v[82:83]
v_pk_fma_f32 v[84:85], v[224:225], v[192:193], v[84:85]
v_pk_fma_f32 v[86:87], v[224:225], v[190:191], v[86:87]
v_pk_fma_f32 v[88:89], v[224:225], v[188:189], v[88:89]
v_pk_fma_f32 v[90:91], v[224:225], v[186:187], v[90:91]
v_pk_fma_f32 v[92:93], v[224:225], v[184:185], v[92:93]
v_pk_fma_f32 v[94:95], v[224:225], v[182:183], v[94:95]
v_pk_fma_f32 v[96:97], v[224:225], v[180:181], v[96:97]
v_pk_fma_f32 v[98:99], v[224:225], v[178:179], v[98:99]
v_pk_fma_f32 v[100:101], v[224:225], v[176:177], v[100:101]
v_pk_fma_f32 v[102:103], v[224:225], v[174:175], v[102:103]
v_pk_fma_f32 v[104:105], v[224:225], v[172:173], v[104:105]
s_add_u32 m0, s59, 2048
s_add_u32 s62, s56, 512
buffer_load_dwordx4 v243, s[32:35], s62 offen sc1 lds
s_add_u32 m0, s59, 13312
s_add_u32 s62, s56, 3328
buffer_load_dwordx4 v243, s[32:35], s62 offen sc1 lds
s_waitcnt lgkmcnt(3)
v_lshlrev_b32 v216, 16, v234
v_and_b32 v217, v246, v234
v_pk_fma_f32 v[216:217], v[216:217], v[204:205], v[204:205] op_sel:[0,0,1] op_sel_hi:[1,0,1]
v_lshlrev_b32 v222, 16, v235
v_and_b32 v223, v246, v235
v_pk_fma_f32 v[222:223], v[222:223], v[206:207], v[206:207] op_sel:[0,0,1] op_sel_hi:[1,0,1]
ds_read_b128 v[200:203], v247 offset:192
ds_read2st64_b32 v[240:241], v244 offset0:38 offset1:39
v_pk_fma_f32 v[8:9], v[216:217], v[134:135], v[8:9]
v_pk_fma_f32 v[10:11], v[216:217], v[132:133], v[10:11]
v_pk_fma_f32 v[12:13], v[216:217], v[130:131], v[12:13]
v_pk_fma_f32 v[14:15], v[216:217], v[128:129], v[14:15]
v_pk_add_f32 v[224:225], v[222:223], v[218:219]
v_pk_fma_f32 v[16:17], v[216:217], v[126:127], v[16:17]
v_pk_fma_f32 v[18:19], v[216:217], v[124:125], v[18:19]
v_pk_fma_f32 v[20:21], v[216:217], v[122:123], v[20:21]
v_pk_fma_f32 v[22:23], v[216:217], v[120:121], v[22:23]
v_pk_fma_f32 v[24:25], v[216:217], v[118:119], v[24:25]
v_pk_fma_f32 v[26:27], v[216:217], v[116:117], v[26:27]
v_pk_fma_f32 v[28:29], v[216:217], v[114:115], v[28:29]
v_pk_fma_f32 v[30:31], v[216:217], v[112:113], v[30:31]
v_pk_fma_f32 v[32:33], v[216:217], v[110:111], v[32:33]
v_pk_fma_f32 v[34:35], v[216:217], v[108:109], v[34:35]
v_pk_fma_f32 v[42:43], v[222:223], v[166:167], v[42:43]
v_pk_fma_f32 v[44:45], v[222:223], v[164:165], v[44:45]
v_pk_fma_f32 v[46:47], v[222:223], v[162:163], v[46:47]
v_pk_fma_f32 v[48:49], v[222:223], v[160:161], v[48:49]
v_pk_fma_f32 v[50:51], v[222:223], v[158:159], v[50:51]
v_pk_fma_f32 v[52:53], v[222:223], v[156:157], v[52:53]
v_pk_fma_f32 v[54:55], v[222:223], v[154:155], v[54:55]
v_pk_fma_f32 v[56:57], v[222:223], v[152:153], v[56:57]
v_pk_fma_f32 v[58:59], v[222:223], v[150:151], v[58:59]
v_pk_fma_f32 v[60:61], v[222:223], v[148:149], v[60:61]
v_pk_fma_f32 v[62:63], v[222:223], v[146:147], v[62:63]
v_pk_fma_f32 v[64:65], v[222:223], v[144:145], v[64:65]
v_pk_fma_f32 v[66:67], v[222:223], v[142:143], v[66:67]
v_pk_fma_f32 v[68:69], v[222:223], v[140:141], v[68:69]
v_pk_fma_f32 v[74:75], v[224:225], v[196:197], v[74:75]
v_pk_fma_f32 v[76:77], v[224:225], v[194:195], v[76:77]
v_pk_fma_f32 v[78:79], v[224:225], v[192:193], v[78:79]
v_pk_fma_f32 v[80:81], v[224:225], v[190:191], v[80:81]
v_pk_fma_f32 v[82:83], v[224:225], v[188:189], v[82:83]
v_pk_fma_f32 v[84:85], v[224:225], v[186:187], v[84:85]
v_pk_fma_f32 v[86:87], v[224:225], v[184:185], v[86:87]
v_pk_fma_f32 v[88:89], v[224:225], v[182:183], v[88:89]
v_pk_fma_f32 v[90:91], v[224:225], v[180:181], v[90:91]
v_pk_fma_f32 v[92:93], v[224:225], v[178:179], v[92:93]
v_pk_fma_f32 v[94:95], v[224:225], v[176:177], v[94:95]
v_pk_fma_f32 v[96:97], v[224:225], v[174:175], v[96:97]
v_pk_fma_f32 v[98:99], v[224:225], v[172:173], v[98:99]
v_pk_fma_f32 v[100:101], v[224:225], v[170:171], v[100:101]
s_add_u32 m0, s59, 28672
s_add_u32 s62, s57, 1024
buffer_load_dwordx4 v243, s[32:35], s62 offen sc1 lds
s_add_u32 m0, s59, 29696
s_add_u32 s62, s57, 1280
buffer_load_dwordx4 v243, s[32:35], s62 offen sc1 lds
s_waitcnt lgkmcnt(3)
v_lshlrev_b32 v220, 16, v236
v_and_b32 v221, v246, v236
v_pk_fma_f32 v[220:221], v[220:221], v[208:209], v[208:209] op_sel:[0,0,1] op_sel_hi:[1,0,1]
v_lshlrev_b32 v214, 16, v237
v_and_b32 v215, v246, v237
v_pk_fma_f32 v[214:215], v[214:215], v[210:211], v[210:211] op_sel:[0,0,1] op_sel_hi:[1,0,1]
ds_read_b128 v[204:207], v247 offset:304
s_waitcnt vmcnt(13)
ds_read2st64_b32 v[234:235], v244 offset0:22 offset1:23
v_pk_fma_f32 v[14:15], v[220:221], v[138:139], v[14:15]
v_pk_fma_f32 v[16:17], v[220:221], v[136:137], v[16:17]
v_pk_fma_f32 v[18:19], v[220:221], v[134:135], v[18:19]
v_pk_fma_f32 v[20:21], v[220:221], v[132:133], v[20:21]
v_pk_add_f32 v[224:225], v[212:213], v[220:221]
v_pk_fma_f32 v[22:23], v[220:221], v[130:131], v[22:23]
v_pk_fma_f32 v[24:25], v[220:221], v[128:129], v[24:25]
v_pk_fma_f32 v[26:27], v[220:221], v[126:127], v[26:27]
v_pk_fma_f32 v[28:29], v[220:221], v[124:125], v[28:29]
v_pk_fma_f32 v[30:31], v[220:221], v[122:123], v[30:31]
v_pk_fma_f32 v[32:33], v[220:221], v[120:121], v[32:33]
v_pk_fma_f32 v[34:35], v[220:221], v[118:119], v[34:35]
v_pk_fma_f32 v[36:37], v[220:221], v[116:117], v[36:37]
v_pk_fma_f32 v[38:39], v[220:221], v[114:115], v[38:39]
v_pk_fma_f32 v[40:41], v[220:221], v[112:113], v[40:41]
v_pk_fma_f32 v[50:51], v[214:215], v[168:169], v[50:51]
v_pk_fma_f32 v[52:53], v[214:215], v[166:167], v[52:53]
v_pk_fma_f32 v[54:55], v[214:215], v[164:165], v[54:55]
v_pk_fma_f32 v[56:57], v[214:215], v[162:163], v[56:57]
v_pk_fma_f32 v[58:59], v[214:215], v[160:161], v[58:59]
v_pk_fma_f32 v[60:61], v[214:215], v[158:159], v[60:61]
v_pk_fma_f32 v[62:63], v[214:215], v[156:157], v[62:63]
v_pk_fma_f32 v[64:65], v[214:215], v[154:155], v[64:65]
v_pk_fma_f32 v[66:67], v[214:215], v[152:153], v[66:67]
v_pk_fma_f32 v[68:69], v[214:215], v[150:151], v[68:69]
v_pk_fma_f32 v[70:71], v[214:215], v[148:149], v[70:71]
v_pk_fma_f32 v[72:73], v[214:215], v[146:147], v[72:73]
v_pk_fma_f32 v[78:79], v[224:225], v[138:139], v[78:79]
v_pk_fma_f32 v[80:81], v[224:225], v[198:199], v[80:81]
v_pk_fma_f32 v[82:83], v[224:225], v[196:197], v[82:83]
v_pk_fma_f32 v[84:85], v[224:225], v[194:195], v[84:85]
v_pk_fma_f32 v[86:87], v[224:225], v[192:193], v[86:87]
v_pk_fma_f32 v[88:89], v[224:225], v[190:191], v[88:89]
v_pk_fma_f32 v[90:91], v[224:225], v[188:189], v[90:91]
v_pk_fma_f32 v[92:93], v[224:225], v[186:187], v[92:93]
v_pk_fma_f32 v[94:95], v[224:225], v[184:185], v[94:95]
v_pk_fma_f32 v[96:97], v[224:225], v[182:183], v[96:97]
v_pk_fma_f32 v[98:99], v[224:225], v[180:181], v[98:99]
v_pk_fma_f32 v[100:101], v[224:225], v[178:179], v[100:101]
v_pk_fma_f32 v[102:103], v[224:225], v[176:177], v[102:103]
v_pk_fma_f32 v[104:105], v[224:225], v[174:175], v[104:105]
s_add_u32 m0, s59, 30720
s_add_u32 s62, s57, 1536
buffer_load_dwordx4 v243, s[32:35], s62 offen sc1 lds
s_waitcnt lgkmcnt(3)
v_lshlrev_b32 v218, 16, v238
v_and_b32 v219, v246, v238
v_pk_fma_f32 v[218:219], v[218:219], v[200:201], v[200:201] op_sel:[0,0,1] op_sel_hi:[1,0,1]
v_lshlrev_b32 v222, 16, v239
v_and_b32 v223, v246, v239
v_pk_fma_f32 v[222:223], v[222:223], v[202:203], v[202:203] op_sel:[0,0,1] op_sel_hi:[1,0,1]
ds_read_b128 v[208:211], v247 offset:176
s_waitcnt vmcnt(13)
ds_read2st64_b32 v[236:237], v244 offset0:40 offset1:41
v_pk_fma_f32 v[8:9], v[218:219], v[132:133], v[8:9]
v_pk_fma_f32 v[10:11], v[218:219], v[130:131], v[10:11]
v_pk_fma_f32 v[12:13], v[218:219], v[128:129], v[12:13]
v_pk_fma_f32 v[14:15], v[218:219], v[126:127], v[14:15]
v_pk_add_f32 v[224:225], v[222:223], v[216:217]
v_pk_fma_f32 v[16:17], v[218:219], v[124:125], v[16:17]
v_pk_fma_f32 v[18:19], v[218:219], v[122:123], v[18:19]
v_pk_fma_f32 v[20:21], v[218:219], v[120:121], v[20:21]
v_pk_fma_f32 v[22:23], v[218:219], v[118:119], v[22:23]
v_pk_fma_f32 v[24:25], v[218:219], v[116:117], v[24:25]
v_pk_fma_f32 v[26:27], v[218:219], v[114:115], v[26:27]
v_pk_fma_f32 v[28:29], v[218:219], v[112:113], v[28:29]
v_pk_fma_f32 v[30:31], v[218:219], v[110:111], v[30:31]
v_pk_fma_f32 v[32:33], v[218:219], v[108:109], v[32:33]
v_pk_fma_f32 v[42:43], v[222:223], v[164:165], v[42:43]
v_pk_fma_f32 v[44:45], v[222:223], v[162:163], v[44:45]
v_pk_fma_f32 v[46:47], v[222:223], v[160:161], v[46:47]
v_pk_fma_f32 v[48:49], v[222:223], v[158:159], v[48:49]
v_pk_fma_f32 v[50:51], v[222:223], v[156:157], v[50:51]
v_pk_fma_f32 v[52:53], v[222:223], v[154:155], v[52:53]
v_pk_fma_f32 v[54:55], v[222:223], v[152:153], v[54:55]
v_pk_fma_f32 v[56:57], v[222:223], v[150:151], v[56:57]
v_pk_fma_f32 v[58:59], v[222:223], v[148:149], v[58:59]
v_pk_fma_f32 v[60:61], v[222:223], v[146:147], v[60:61]
v_pk_fma_f32 v[62:63], v[222:223], v[144:145], v[62:63]
v_pk_fma_f32 v[64:65], v[222:223], v[142:143], v[64:65]
v_pk_fma_f32 v[66:67], v[222:223], v[140:141], v[66:67]
v_pk_fma_f32 v[74:75], v[224:225], v[194:195], v[74:75]
v_pk_fma_f32 v[76:77], v[224:225], v[192:193], v[76:77]
v_pk_fma_f32 v[78:79], v[224:225], v[190:191], v[78:79]
v_pk_fma_f32 v[80:81], v[224:225], v[188:189], v[80:81]
v_pk_fma_f32 v[82:83], v[224:225], v[186:187], v[82:83]
v_pk_fma_f32 v[84:85], v[224:225], v[184:185], v[84:85]
v_pk_fma_f32 v[86:87], v[224:225], v[182:183], v[86:87]
v_pk_fma_f32 v[88:89], v[224:225], v[180:181], v[88:89]
v_pk_fma_f32 v[90:91], v[224:225], v[178:179], v[90:91]
v_pk_fma_f32 v[92:93], v[224:225], v[176:177], v[92:93]
v_pk_fma_f32 v[94:95], v[224:225], v[174:175], v[94:95]
v_pk_fma_f32 v[96:97], v[224:225], v[172:173], v[96:97]
v_pk_fma_f32 v[98:99], v[224:225], v[170:171], v[98:99]
s_add_u32 m0, s59, 31744
s_add_u32 s62, s57, 1792
buffer_load_dwordx4 v243, s[32:35], s62 offen sc1 lds
s_waitcnt lgkmcnt(3)
v_lshlrev_b32 v220, 16, v240
v_and_b32 v221, v246, v240
v_pk_fma_f32 v[220:221], v[220:221], v[204:205], v[204:205] op_sel:[0,0,1] op_sel_hi:[1,0,1]
v_lshlrev_b32 v212, 16, v241
v_and_b32 v213, v246, v241
v_pk_fma_f32 v[212:213], v[212:213], v[206:207], v[206:207] op_sel:[0,0,1] op_sel_hi:[1,0,1]
ds_read_b128 v[200:203], v247 offset:320
ds_read2st64_b32 v[238:239], v244 offset0:20 offset1:21
v_pk_fma_f32 v[16:17], v[220:221], v[138:139], v[16:17]
v_pk_fma_f32 v[18:19], v[220:221], v[136:137], v[18:19]
v_pk_fma_f32 v[20:21], v[220:221], v[134:135], v[20:21]
v_pk_fma_f32 v[22:23], v[220:221], v[132:133], v[22:23]
v_pk_add_f32 v[224:225], v[214:215], v[220:221]
v_pk_fma_f32 v[24:25], v[220:221], v[130:131], v[24:25]
v_pk_fma_f32 v[26:27], v[220:221], v[128:129], v[26:27]
v_pk_fma_f32 v[28:29], v[220:221], v[126:127], v[28:29]
v_pk_fma_f32 v[30:31], v[220:221], v[124:125], v[30:31]
v_pk_fma_f32 v[32:33], v[220:221], v[122:123], v[32:33]
v_pk_fma_f32 v[34:35], v[220:221], v[120:121], v[34:35]
v_pk_fma_f32 v[36:37], v[220:221], v[118:119], v[36:37]
v_pk_fma_f32 v[38:39], v[220:221], v[116:117], v[38:39]
v_pk_fma_f32 v[40:41], v[220:221], v[114:115], v[40:41]
v_pk_fma_f32 v[52:53], v[212:213], v[168:169], v[52:53]
v_pk_fma_f32 v[54:55], v[212:213], v[166:167], v[54:55]
v_pk_fma_f32 v[56:57], v[212:213], v[164:165], v[56:57]
v_pk_fma_f32 v[58:59], v[212:213], v[162:163], v[58:59]
v_pk_fma_f32 v[60:61], v[212:213], v[160:161], v[60:61]
v_pk_fma_f32 v[62:63], v[212:213], v[158:159], v[62:63]
v_pk_fma_f32 v[64:65], v[212:213], v[156:157], v[64:65]
v_pk_fma_f32 v[66:67], v[212:213], v[154:155], v[66:67]
v_pk_fma_f32 v[68:69], v[212:213], v[152:153], v[68:69]
v_pk_fma_f32 v[70:71], v[212:213], v[150:151], v[70:71]
v_pk_fma_f32 v[72:73], v[212:213], v[148:149], v[72:73]
v_pk_fma_f32 v[80:81], v[224:225], v[138:139], v[80:81]
v_pk_fma_f32 v[82:83], v[224:225], v[198:199], v[82:83]
v_pk_fma_f32 v[84:85], v[224:225], v[196:197], v[84:85]
v_pk_fma_f32 v[86:87], v[224:225], v[194:195], v[86:87]
v_pk_fma_f32 v[88:89], v[224:225], v[192:193], v[88:89]
v_pk_fma_f32 v[90:91], v[224:225], v[190:191], v[90:91]
v_pk_fma_f32 v[92:93], v[224:225], v[188:189], v[92:93]
v_pk_fma_f32 v[94:95], v[224:225], v[186:187], v[94:95]
v_pk_fma_f32 v[96:97], v[224:225], v[184:185], v[96:97]
v_pk_fma_f32 v[98:99], v[224:225], v[182:183], v[98:99]
v_pk_fma_f32 v[100:101], v[224:225], v[180:181], v[100:101]
v_pk_fma_f32 v[102:103], v[224:225], v[178:179], v[102:103]
v_pk_fma_f32 v[104:105], v[224:225], v[176:177], v[104:105]
s_add_u32 m0, s59, 1024
s_add_u32 s62, s56, 256
buffer_load_dwordx4 v243, s[32:35], s62 offen sc1 lds
s_waitcnt lgkmcnt(3)
v_lshlrev_b32 v216, 16, v234
v_and_b32 v217, v246, v234
v_pk_fma_f32 v[216:217], v[216:217], v[208:209], v[208:209] op_sel:[0,0,1] op_sel_hi:[1,0,1]
v_lshlrev_b32 v222, 16, v235
v_and_b32 v223, v246, v235
v_pk_fma_f32 v[222:223], v[222:223], v[210:211], v[210:211] op_sel:[0,0,1] op_sel_hi:[1,0,1]
ds_read_b128 v[204:207], v247 offset:160
ds_read2st64_b32 v[240:241], v244 offset0:42 offset1:43
v_pk_fma_f32 v[8:9], v[216:217], v[130:131], v[8:9]
v_pk_fma_f32 v[10:11], v[216:217], v[128:129], v[10:11]
v_pk_fma_f32 v[12:13], v[216:217], v[126:127], v[12:13]
v_pk_fma_f32 v[14:15], v[216:217], v[124:125], v[14:15]
v_pk_add_f32 v[224:225], v[222:223], v[218:219]
v_pk_fma_f32 v[16:17], v[216:217], v[122:123], v[16:17]
v_pk_fma_f32 v[18:19], v[216:217], v[120:121], v[18:19]
v_pk_fma_f32 v[20:21], v[216:217], v[118:119], v[20:21]
v_pk_fma_f32 v[22:23], v[216:217], v[116:117], v[22:23]
v_pk_fma_f32 v[24:25], v[216:217], v[114:115], v[24:25]
v_pk_fma_f32 v[26:27], v[216:217], v[112:113], v[26:27]
v_pk_fma_f32 v[28:29], v[216:217], v[110:111], v[28:29]
v_pk_fma_f32 v[30:31], v[216:217], v[108:109], v[30:31]
v_pk_fma_f32 v[42:43], v[222:223], v[162:163], v[42:43]
v_pk_fma_f32 v[44:45], v[222:223], v[160:161], v[44:45]
v_pk_fma_f32 v[46:47], v[222:223], v[158:159], v[46:47]
v_pk_fma_f32 v[48:49], v[222:223], v[156:157], v[48:49]
v_pk_fma_f32 v[50:51], v[222:223], v[154:155], v[50:51]
v_pk_fma_f32 v[52:53], v[222:223], v[152:153], v[52:53]
v_pk_fma_f32 v[54:55], v[222:223], v[150:151], v[54:55]
v_pk_fma_f32 v[56:57], v[222:223], v[148:149], v[56:57]
v_pk_fma_f32 v[58:59], v[222:223], v[146:147], v[58:59]
v_pk_fma_f32 v[60:61], v[222:223], v[144:145], v[60:61]
v_pk_fma_f32 v[62:63], v[222:223], v[142:143], v[62:63]
v_pk_fma_f32 v[64:65], v[222:223], v[140:141], v[64:65]
v_pk_fma_f32 v[74:75], v[224:225], v[192:193], v[74:75]
v_pk_fma_f32 v[76:77], v[224:225], v[190:191], v[76:77]
v_pk_fma_f32 v[78:79], v[224:225], v[188:189], v[78:79]
v_pk_fma_f32 v[80:81], v[224:225], v[186:187], v[80:81]
v_pk_fma_f32 v[82:83], v[224:225], v[184:185], v[82:83]
v_pk_fma_f32 v[84:85], v[224:225], v[182:183], v[84:85]
v_pk_fma_f32 v[86:87], v[224:225], v[180:181], v[86:87]
v_pk_fma_f32 v[88:89], v[224:225], v[178:179], v[88:89]
v_pk_fma_f32 v[90:91], v[224:225], v[176:177], v[90:91]
v_pk_fma_f32 v[92:93], v[224:225], v[174:175], v[92:93]
v_pk_fma_f32 v[94:95], v[224:225], v[172:173], v[94:95]
v_pk_fma_f32 v[96:97], v[224:225], v[170:171], v[96:97]
s_add_u32 m0, s59, 14336
s_add_u32 s62, s56, 3584
buffer_load_dwordx4 v243, s[32:35], s62 offen sc1 lds
s_waitcnt lgkmcnt(3)
v_lshlrev_b32 v220, 16, v236
v_and_b32 v221, v246, v236
v_pk_fma_f32 v[220:221], v[220:221], v[200:201], v[200:201] op_sel:[0,0,1] op_sel_hi:[1,0,1]
v_lshlrev_b32 v214, 16, v237
v_and_b32 v215, v246, v237
v_pk_fma_f32 v[214:215], v[214:215], v[202:203], v[202:203] op_sel:[0,0,1] op_sel_hi:[1,0,1]
ds_read_b128 v[208:211], v247 offset:336
s_waitcnt vmcnt(15)
ds_read2st64_b32 v[234:235], v244 offset0:18 offset1:19
v_pk_fma_f32 v[18:19], v[220:221], v[138:139], v[18:19]
v_pk_fma_f32 v[20:21], v[220:221], v[136:137], v[20:21]
v_pk_fma_f32 v[22:23], v[220:221], v[134:135], v[22:23]
v_pk_fma_f32 v[24:25], v[220:221], v[132:133], v[24:25]
v_pk_add_f32 v[224:225], v[212:213], v[220:221]
v_pk_fma_f32 v[26:27], v[220:221], v[130:131], v[26:27]
v_pk_fma_f32 v[28:29], v[220:221], v[128:129], v[28:29]
v_pk_fma_f32 v[30:31], v[220:221], v[126:127], v[30:31]
v_pk_fma_f32 v[32:33], v[220:221], v[124:125], v[32:33]
v_pk_fma_f32 v[34:35], v[220:221], v[122:123], v[34:35]
v_pk_fma_f32 v[36:37], v[220:221], v[120:121], v[36:37]
v_pk_fma_f32 v[38:39], v[220:221], v[118:119], v[38:39]
v_pk_fma_f32 v[40:41], v[220:221], v[116:117], v[40:41]
v_pk_fma_f32 v[54:55], v[214:215], v[168:169], v[54:55]
v_pk_fma_f32 v[56:57], v[214:215], v[166:167], v[56:57]
v_pk_fma_f32 v[58:59], v[214:215], v[164:165], v[58:59]
v_pk_fma_f32 v[60:61], v[214:215], v[162:163], v[60:61]
v_pk_fma_f32 v[62:63], v[214:215], v[160:161], v[62:63]
v_pk_fma_f32 v[64:65], v[214:215], v[158:159], v[64:65]
v_pk_fma_f32 v[66:67], v[214:215], v[156:157], v[66:67]
v_pk_fma_f32 v[68:69], v[214:215], v[154:155], v[68:69]
v_pk_fma_f32 v[70:71], v[214:215], v[152:153], v[70:71]
v_pk_fma_f32 v[72:73], v[214:215], v[150:151], v[72:73]
v_pk_fma_f32 v[82:83], v[224:225], v[138:139], v[82:83]
v_pk_fma_f32 v[84:85], v[224:225], v[198:199], v[84:85]
v_pk_fma_f32 v[86:87], v[224:225], v[196:197], v[86:87]
v_pk_fma_f32 v[88:89], v[224:225], v[194:195], v[88:89]
v_pk_fma_f32 v[90:91], v[224:225], v[192:193], v[90:91]
v_pk_fma_f32 v[92:93], v[224:225], v[190:191], v[92:93]
v_pk_fma_f32 v[94:95], v[224:225], v[188:189], v[94:95]
v_pk_fma_f32 v[96:97], v[224:225], v[186:187], v[96:97]
v_pk_fma_f32 v[98:99], v[224:225], v[184:185], v[98:99]
v_pk_fma_f32 v[100:101], v[224:225], v[182:183], v[100:101]
v_pk_fma_f32 v[102:103], v[224:225], v[180:181], v[102:103]
v_pk_fma_f32 v[104:105], v[224:225], v[178:179], v[104:105]
s_add_u32 m0, s59, 0
s_add_u32 s62, s56, 0
buffer_load_dwordx4 v243, s[32:35], s62 offen sc1 lds
s_waitcnt lgkmcnt(3)
v_lshlrev_b32 v218, 16, v238
v_and_b32 v219, v246, v238
v_pk_fma_f32 v[218:219], v[218:219], v[204:205], v[204:205] op_sel:[0,0,1] op_sel_hi:[1,0,1]
v_lshlrev_b32 v222, 16, v239
v_and_b32 v223, v246, v239
v_pk_fma_f32 v[222:223], v[222:223], v[206:207], v[206:207] op_sel:[0,0,1] op_sel_hi:[1,0,1]
ds_read_b128 v[200:203], v247 offset:144
s_waitcnt vmcnt(15)
ds_read2st64_b32 v[236:237], v244 offset0:44 offset1:45
v_pk_fma_f32 v[8:9], v[218:219], v[128:129], v[8:9]
v_pk_fma_f32 v[10:11], v[218:219], v[126:127], v[10:11]
v_pk_fma_f32 v[12:13], v[218:219], v[124:125], v[12:13]
v_pk_fma_f32 v[14:15], v[218:219], v[122:123], v[14:15]
v_pk_add_f32 v[224:225], v[222:223], v[216:217]
v_pk_fma_f32 v[16:17], v[218:219], v[120:121], v[16:17]
v_pk_fma_f32 v[18:19], v[218:219], v[118:119], v[18:19]
v_pk_fma_f32 v[20:21], v[218:219], v[116:117], v[20:21]
v_pk_fma_f32 v[22:23], v[218:219], v[114:115], v[22:23]
v_pk_fma_f32 v[24:25], v[218:219], v[112:113], v[24:25]
v_pk_fma_f32 v[26:27], v[218:219], v[110:111], v[26:27]
v_pk_fma_f32 v[28:29], v[218:219], v[108:109], v[28:29]
v_pk_fma_f32 v[42:43], v[222:223], v[160:161], v[42:43]
v_pk_fma_f32 v[44:45], v[222:223], v[158:159], v[44:45]
v_pk_fma_f32 v[46:47], v[222:223], v[156:157], v[46:47]
v_pk_fma_f32 v[48:49], v[222:223], v[154:155], v[48:49]
v_pk_fma_f32 v[50:51], v[222:223], v[152:153], v[50:51]
v_pk_fma_f32 v[52:53], v[222:223], v[150:151], v[52:53]
v_pk_fma_f32 v[54:55], v[222:223], v[148:149], v[54:55]
v_pk_fma_f32 v[56:57], v[222:223], v[146:147], v[56:57]
v_pk_fma_f32 v[58:59], v[222:223], v[144:145], v[58:59]
v_pk_fma_f32 v[60:61], v[222:223], v[142:143], v[60:61]
v_pk_fma_f32 v[62:63], v[222:223], v[140:141], v[62:63]
v_pk_fma_f32 v[74:75], v[224:225], v[190:191], v[74:75]
v_pk_fma_f32 v[76:77], v[224:225], v[188:189], v[76:77]
v_pk_fma_f32 v[78:79], v[224:225], v[186:187], v[78:79]
v_pk_fma_f32 v[80:81], v[224:225], v[184:185], v[80:81]
v_pk_fma_f32 v[82:83], v[224:225], v[182:183], v[82:83]
v_pk_fma_f32 v[84:85], v[224:225], v[180:181], v[84:85]
v_pk_fma_f32 v[86:87], v[224:225], v[178:179], v[86:87]
v_pk_fma_f32 v[88:89], v[224:225], v[176:177], v[88:89]
v_pk_fma_f32 v[90:91], v[224:225], v[174:175], v[90:91]
v_pk_fma_f32 v[92:93], v[224:225], v[172:173], v[92:93]
v_pk_fma_f32 v[94:95], v[224:225], v[170:171], v[94:95]
s_add_u32 m0, s59, 15360
s_add_u32 s62, s56, 3840
buffer_load_dwordx4 v243, s[32:35], s62 offen sc1 lds
s_waitcnt lgkmcnt(3)
v_lshlrev_b32 v220, 16, v240
v_and_b32 v221, v246, v240
v_pk_fma_f32 v[220:221], v[220:221], v[208:209], v[208:209] op_sel:[0,0,1] op_sel_hi:[1,0,1]
v_lshlrev_b32 v212, 16, v241
v_and_b32 v213, v246, v241
v_pk_fma_f32 v[212:213], v[212:213], v[210:211], v[210:211] op_sel:[0,0,1] op_sel_hi:[1,0,1]
ds_read_b128 v[204:207], v247 offset:352
ds_read2st64_b32 v[238:239], v244 offset0:16 offset1:17
v_pk_fma_f32 v[20:21], v[220:221], v[138:139], v[20:21]
v_pk_fma_f32 v[22:23], v[220:221], v[136:137], v[22:23]
v_pk_fma_f32 v[24:25], v[220:221], v[134:135], v[24:25]
v_pk_fma_f32 v[26:27], v[220:221], v[132:133], v[26:27]
v_pk_add_f32 v[224:225], v[214:215], v[220:221]
v_pk_fma_f32 v[28:29], v[220:221], v[130:131], v[28:29]
v_pk_fma_f32 v[30:31], v[220:221], v[128:129], v[30:31]
v_pk_fma_f32 v[32:33], v[220:221], v[126:127], v[32:33]
v_pk_fma_f32 v[34:35], v[220:221], v[124:125], v[34:35]
v_pk_fma_f32 v[36:37], v[220:221], v[122:123], v[36:37]
v_pk_fma_f32 v[38:39], v[220:221], v[120:121], v[38:39]
v_pk_fma_f32 v[40:41], v[220:221], v[118:119], v[40:41]
v_pk_fma_f32 v[56:57], v[212:213], v[168:169], v[56:57]
v_pk_fma_f32 v[58:59], v[212:213], v[166:167], v[58:59]
v_pk_fma_f32 v[60:61], v[212:213], v[164:165], v[60:61]
v_pk_fma_f32 v[62:63], v[212:213], v[162:163], v[62:63]
v_pk_fma_f32 v[64:65], v[212:213], v[160:161], v[64:65]
v_pk_fma_f32 v[66:67], v[212:213], v[158:159], v[66:67]
v_pk_fma_f32 v[68:69], v[212:213], v[156:157], v[68:69]
v_pk_fma_f32 v[70:71], v[212:213], v[154:155], v[70:71]
v_pk_fma_f32 v[72:73], v[212:213], v[152:153], v[72:73]
v_pk_fma_f32 v[84:85], v[224:225], v[138:139], v[84:85]
v_pk_fma_f32 v[86:87], v[224:225], v[198:199], v[86:87]
v_pk_fma_f32 v[88:89], v[224:225], v[196:197], v[88:89]
v_pk_fma_f32 v[90:91], v[224:225], v[194:195], v[90:91]
v_pk_fma_f32 v[92:93], v[224:225], v[192:193], v[92:93]
v_pk_fma_f32 v[94:95], v[224:225], v[190:191], v[94:95]
v_pk_fma_f32 v[96:97], v[224:225], v[188:189], v[96:97]
v_pk_fma_f32 v[98:99], v[224:225], v[186:187], v[98:99]
v_pk_fma_f32 v[100:101], v[224:225], v[184:185], v[100:101]
v_pk_fma_f32 v[102:103], v[224:225], v[182:183], v[102:103]
v_pk_fma_f32 v[104:105], v[224:225], v[180:181], v[104:105]
s_waitcnt lgkmcnt(3)
v_lshlrev_b32 v216, 16, v234
v_and_b32 v217, v246, v234
v_pk_fma_f32 v[216:217], v[216:217], v[200:201], v[200:201] op_sel:[0,0,1] op_sel_hi:[1,0,1]
v_lshlrev_b32 v222, 16, v235
v_and_b32 v223, v246, v235
v_pk_fma_f32 v[222:223], v[222:223], v[202:203], v[202:203] op_sel:[0,0,1] op_sel_hi:[1,0,1]
ds_read_b128 v[208:211], v247 offset:128
ds_read2st64_b32 v[240:241], v244 offset0:46 offset1:47
v_pk_fma_f32 v[8:9], v[216:217], v[126:127], v[8:9]
v_pk_fma_f32 v[10:11], v[216:217], v[124:125], v[10:11]
v_pk_fma_f32 v[12:13], v[216:217], v[122:123], v[12:13]
v_pk_fma_f32 v[14:15], v[216:217], v[120:121], v[14:15]
v_pk_add_f32 v[224:225], v[222:223], v[218:219]
v_pk_fma_f32 v[16:17], v[216:217], v[118:119], v[16:17]
v_pk_fma_f32 v[18:19], v[216:217], v[116:117], v[18:19]
v_pk_fma_f32 v[20:21], v[216:217], v[114:115], v[20:21]
v_pk_fma_f32 v[22:23], v[216:217], v[112:113], v[22:23]
v_pk_fma_f32 v[24:25], v[216:217], v[110:111], v[24:25]
v_pk_fma_f32 v[26:27], v[216:217], v[108:109], v[26:27]
v_pk_fma_f32 v[42:43], v[222:223], v[158:159], v[42:43]
v_pk_fma_f32 v[44:45], v[222:223], v[156:157], v[44:45]
v_pk_fma_f32 v[46:47], v[222:223], v[154:155], v[46:47]
v_pk_fma_f32 v[48:49], v[222:223], v[152:153], v[48:49]
v_pk_fma_f32 v[50:51], v[222:223], v[150:151], v[50:51]
v_pk_fma_f32 v[52:53], v[222:223], v[148:149], v[52:53]
v_pk_fma_f32 v[54:55], v[222:223], v[146:147], v[54:55]
v_pk_fma_f32 v[56:57], v[222:223], v[144:145], v[56:57]
v_pk_fma_f32 v[58:59], v[222:223], v[142:143], v[58:59]
v_pk_fma_f32 v[60:61], v[222:223], v[140:141], v[60:61]
v_pk_fma_f32 v[74:75], v[224:225], v[188:189], v[74:75]
v_pk_fma_f32 v[76:77], v[224:225], v[186:187], v[76:77]
v_pk_fma_f32 v[78:79], v[224:225], v[184:185], v[78:79]
v_pk_fma_f32 v[80:81], v[224:225], v[182:183], v[80:81]
v_pk_fma_f32 v[82:83], v[224:225], v[180:181], v[82:83]
v_pk_fma_f32 v[84:85], v[224:225], v[178:179], v[84:85]
v_pk_fma_f32 v[86:87], v[224:225], v[176:177], v[86:87]
v_pk_fma_f32 v[88:89], v[224:225], v[174:175], v[88:89]
v_pk_fma_f32 v[90:91], v[224:225], v[172:173], v[90:91]
v_pk_fma_f32 v[92:93], v[224:225], v[170:171], v[92:93]
s_waitcnt lgkmcnt(3)
v_lshlrev_b32 v220, 16, v236
v_and_b32 v221, v246, v236
v_pk_fma_f32 v[220:221], v[220:221], v[204:205], v[204:205] op_sel:[0,0,1] op_sel_hi:[1,0,1]
v_lshlrev_b32 v214, 16, v237
v_and_b32 v215, v246, v237
v_pk_fma_f32 v[214:215], v[214:215], v[206:207], v[206:207] op_sel:[0,0,1] op_sel_hi:[1,0,1]
ds_read_b128 v[200:203], v247 offset:368
s_waitcnt vmcnt(15)
ds_read2st64_b32 v[234:235], v244 offset0:14 offset1:15
v_pk_fma_f32 v[22:23], v[220:221], v[138:139], v[22:23]
v_pk_fma_f32 v[24:25], v[220:221], v[136:137], v[24:25]
v_pk_fma_f32 v[26:27], v[220:221], v[134:135], v[26:27]
v_pk_fma_f32 v[28:29], v[220:221], v[132:133], v[28:29]
v_pk_add_f32 v[224:225], v[212:213], v[220:221]
v_pk_fma_f32 v[30:31], v[220:221], v[130:131], v[30:31]
v_pk_fma_f32 v[32:33], v[220:221], v[128:129], v[32:33]
v_pk_fma_f32 v[34:35], v[220:221], v[126:127], v[34:35]
v_pk_fma_f32 v[36:37], v[220:221], v[124:125], v[36:37]
v_pk_fma_f32 v[38:39], v[220:221], v[122:123], v[38:39]
v_pk_fma_f32 v[40:41], v[220:221], v[120:121], v[40:41]
v_pk_fma_f32 v[58:59], v[214:215], v[168:169], v[58:59]
v_pk_fma_f32 v[60:61], v[214:215], v[166:167], v[60:61]
v_pk_fma_f32 v[62:63], v[214:215], v[164:165], v[62:63]
v_pk_fma_f32 v[64:65], v[214:215], v[162:163], v[64:65]
v_pk_fma_f32 v[66:67], v[214:215], v[160:161], v[66:67]
v_pk_fma_f32 v[68:69], v[214:215], v[158:159], v[68:69]
v_pk_fma_f32 v[70:71], v[214:215], v[156:157], v[70:71]
v_pk_fma_f32 v[72:73], v[214:215], v[154:155], v[72:73]
v_pk_fma_f32 v[86:87], v[224:225], v[138:139], v[86:87]
v_pk_fma_f32 v[88:89], v[224:225], v[198:199], v[88:89]
v_pk_fma_f32 v[90:91], v[224:225], v[196:197], v[90:91]
v_pk_fma_f32 v[92:93], v[224:225], v[194:195], v[92:93]
v_pk_fma_f32 v[94:95], v[224:225], v[192:193], v[94:95]
v_pk_fma_f32 v[96:97], v[224:225], v[190:191], v[96:97]
v_pk_fma_f32 v[98:99], v[224:225], v[188:189], v[98:99]
v_pk_fma_f32 v[100:101], v[224:225], v[186:187], v[100:101]
v_pk_fma_f32 v[102:103], v[224:225], v[184:185], v[102:103]
v_pk_fma_f32 v[104:105], v[224:225], v[182:183], v[104:105]
s_waitcnt lgkmcnt(3)
v_lshlrev_b32 v218, 16, v238
v_and_b32 v219, v246, v238
v_pk_fma_f32 v[218:219], v[218:219], v[208:209], v[208:209] op_sel:[0,0,1] op_sel_hi:[1,0,1]
v_lshlrev_b32 v222, 16, v239
v_and_b32 v223, v246, v239
v_pk_fma_f32 v[222:223], v[222:223], v[210:211], v[210:211] op_sel:[0,0,1] op_sel_hi:[1,0,1]
ds_read_b128 v[204:207], v247 offset:112
s_waitcnt vmcnt(14)
ds_read2st64_b32 v[236:237], v244 offset0:48 offset1:49
v_pk_fma_f32 v[8:9], v[218:219], v[124:125], v[8:9]
v_pk_fma_f32 v[10:11], v[218:219], v[122:123], v[10:11]
v_pk_fma_f32 v[12:13], v[218:219], v[120:121], v[12:13]
v_pk_fma_f32 v[14:15], v[218:219], v[118:119], v[14:15]
v_pk_add_f32 v[224:225], v[222:223], v[216:217]
v_pk_fma_f32 v[16:17], v[218:219], v[116:117], v[16:17]
v_pk_fma_f32 v[18:19], v[218:219], v[114:115], v[18:19]
v_pk_fma_f32 v[20:21], v[218:219], v[112:113], v[20:21]
v_pk_fma_f32 v[22:23], v[218:219], v[110:111], v[22:23]
v_pk_fma_f32 v[24:25], v[218:219], v[108:109], v[24:25]
v_pk_fma_f32 v[42:43], v[222:223], v[156:157], v[42:43]
v_pk_fma_f32 v[44:45], v[222:223], v[154:155], v[44:45]
v_pk_fma_f32 v[46:47], v[222:223], v[152:153], v[46:47]
v_pk_fma_f32 v[48:49], v[222:223], v[150:151], v[48:49]
v_pk_fma_f32 v[50:51], v[222:223], v[148:149], v[50:51]
v_pk_fma_f32 v[52:53], v[222:223], v[146:147], v[52:53]
v_pk_fma_f32 v[54:55], v[222:223], v[144:145], v[54:55]
v_pk_fma_f32 v[56:57], v[222:223], v[142:143], v[56:57]
v_pk_fma_f32 v[58:59], v[222:223], v[140:141], v[58:59]
v_pk_fma_f32 v[74:75], v[224:225], v[186:187], v[74:75]
v_pk_fma_f32 v[76:77], v[224:225], v[184:185], v[76:77]
v_pk_fma_f32 v[78:79], v[224:225], v[182:183], v[78:79]
v_pk_fma_f32 v[80:81], v[224:225], v[180:181], v[80:81]
v_pk_fma_f32 v[82:83], v[224:225], v[178:179], v[82:83]
v_pk_fma_f32 v[84:85], v[224:225], v[176:177], v[84:85]
v_pk_fma_f32 v[86:87], v[224:225], v[174:175], v[86:87]
v_pk_fma_f32 v[88:89], v[224:225], v[172:173], v[88:89]
v_pk_fma_f32 v[90:91], v[224:225], v[170:171], v[90:91]
s_waitcnt lgkmcnt(3)
v_lshlrev_b32 v220, 16, v240
v_and_b32 v221, v246, v240
v_pk_fma_f32 v[220:221], v[220:221], v[200:201], v[200:201] op_sel:[0,0,1] op_sel_hi:[1,0,1]
v_lshlrev_b32 v212, 16, v241
v_and_b32 v213, v246, v241
v_pk_fma_f32 v[212:213], v[212:213], v[202:203], v[202:203] op_sel:[0,0,1] op_sel_hi:[1,0,1]
ds_read_b128 v[208:211], v247 offset:384
ds_read2st64_b32 v[238:239], v244 offset0:12 offset1:13
s_waitcnt vmcnt(4)
ds_read2st64_b32 v[226:227], v248 offset0:14 offset1:15
v_pk_fma_f32 v[24:25], v[220:221], v[138:139], v[24:25]
v_pk_fma_f32 v[26:27], v[220:221], v[136:137], v[26:27]
v_pk_fma_f32 v[28:29], v[220:221], v[134:135], v[28:29]
v_pk_fma_f32 v[30:31], v[220:221], v[132:133], v[30:31]
v_pk_add_f32 v[224:225], v[214:215], v[220:221]
v_pk_fma_f32 v[32:33], v[220:221], v[130:131], v[32:33]
v_pk_fma_f32 v[34:35], v[220:221], v[128:129], v[34:35]
v_pk_fma_f32 v[36:37], v[220:221], v[126:127], v[36:37]
v_pk_fma_f32 v[38:39], v[220:221], v[124:125], v[38:39]
v_pk_fma_f32 v[40:41], v[220:221], v[122:123], v[40:41]
v_pk_fma_f32 v[60:61], v[212:213], v[168:169], v[60:61]
v_pk_fma_f32 v[62:63], v[212:213], v[166:167], v[62:63]
v_pk_fma_f32 v[64:65], v[212:213], v[164:165], v[64:65]
v_pk_fma_f32 v[66:67], v[212:213], v[162:163], v[66:67]
v_pk_fma_f32 v[68:69], v[212:213], v[160:161], v[68:69]
v_pk_fma_f32 v[70:71], v[212:213], v[158:159], v[70:71]
v_pk_fma_f32 v[72:73], v[212:213], v[156:157], v[72:73]
v_pk_fma_f32 v[88:89], v[224:225], v[138:139], v[88:89]
v_pk_fma_f32 v[90:91], v[224:225], v[198:199], v[90:91]
v_pk_fma_f32 v[92:93], v[224:225], v[196:197], v[92:93]
v_pk_fma_f32 v[94:95], v[224:225], v[194:195], v[94:95]
v_pk_fma_f32 v[96:97], v[224:225], v[192:193], v[96:97]
v_pk_fma_f32 v[98:99], v[224:225], v[190:191], v[98:99]
v_pk_fma_f32 v[100:101], v[224:225], v[188:189], v[100:101]
v_pk_fma_f32 v[102:103], v[224:225], v[186:187], v[102:103]
v_pk_fma_f32 v[104:105], v[224:225], v[184:185], v[104:105]
s_waitcnt lgkmcnt(4)
v_lshlrev_b32 v216, 16, v234
v_and_b32 v217, v246, v234
v_pk_fma_f32 v[216:217], v[216:217], v[204:205], v[204:205] op_sel:[0,0,1] op_sel_hi:[1,0,1]
v_lshlrev_b32 v222, 16, v235
v_and_b32 v223, v246, v235
v_pk_fma_f32 v[222:223], v[222:223], v[206:207], v[206:207] op_sel:[0,0,1] op_sel_hi:[1,0,1]
ds_read_b128 v[200:203], v247 offset:96
ds_read2st64_b32 v[240:241], v244 offset0:50 offset1:51
ds_read2st64_b32 v[228:229], v248 offset0:16 offset1:17
v_pk_fma_f32 v[8:9], v[216:217], v[122:123], v[8:9]
v_pk_fma_f32 v[10:11], v[216:217], v[120:121], v[10:11]
v_pk_fma_f32 v[12:13], v[216:217], v[118:119], v[12:13]
v_pk_fma_f32 v[14:15], v[216:217], v[116:117], v[14:15]
v_pk_add_f32 v[224:225], v[222:223], v[218:219]
v_pk_fma_f32 v[16:17], v[216:217], v[114:115], v[16:17]
v_pk_fma_f32 v[18:19], v[216:217], v[112:113], v[18:19]
v_pk_fma_f32 v[20:21], v[216:217], v[110:111], v[20:21]
v_pk_fma_f32 v[22:23], v[216:217], v[108:109], v[22:23]
v_pk_fma_f32 v[42:43], v[222:223], v[154:155], v[42:43]
v_pk_fma_f32 v[44:45], v[222:223], v[152:153], v[44:45]
v_pk_fma_f32 v[46:47], v[222:223], v[150:151], v[46:47]
v_pk_fma_f32 v[48:49], v[222:223], v[148:149], v[48:49]
v_pk_fma_f32 v[50:51], v[222:223], v[146:147], v[50:51]
v_pk_fma_f32 v[52:53], v[222:223], v[144:145], v[52:53]
v_pk_fma_f32 v[54:55], v[222:223], v[142:143], v[54:55]
v_pk_fma_f32 v[56:57], v[222:223], v[140:141], v[56:57]
v_pk_fma_f32 v[74:75], v[224:225], v[184:185], v[74:75]
v_pk_fma_f32 v[76:77], v[224:225], v[182:183], v[76:77]
v_pk_fma_f32 v[78:79], v[224:225], v[180:181], v[78:79]
v_pk_fma_f32 v[80:81], v[224:225], v[178:179], v[80:81]
v_pk_fma_f32 v[82:83], v[224:225], v[176:177], v[82:83]
v_pk_fma_f32 v[84:85], v[224:225], v[174:175], v[84:85]
v_pk_fma_f32 v[86:87], v[224:225], v[172:173], v[86:87]
v_pk_fma_f32 v[88:89], v[224:225], v[170:171], v[88:89]
s_waitcnt lgkmcnt(3)
v_lshlrev_b32 v220, 16, v236
v_and_b32 v221, v246, v236
v_pk_fma_f32 v[220:221], v[220:221], v[208:209], v[208:209] op_sel:[0,0,1] op_sel_hi:[1,0,1]
v_lshlrev_b32 v214, 16, v237
v_and_b32 v215, v246, v237
v_pk_fma_f32 v[214:215], v[214:215], v[210:211], v[210:211] op_sel:[0,0,1] op_sel_hi:[1,0,1]
ds_read_b128 v[204:207], v247 offset:400
s_waitcnt vmcnt(9)
ds_read2st64_b32 v[234:235], v244 offset0:10 offset1:11
ds_read2st64_b32 v[230:231], v248 offset0:12 offset1:13
v_pk_fma_f32 v[26:27], v[220:221], v[138:139], v[26:27]
v_pk_add_f32 v[88:89], v[88:89], v[24:25] neg_lo:[0,1] neg_hi:[0,1]
v_pk_fma_f32 v[28:29], v[220:221], v[136:137], v[28:29]
v_pk_add_f32 v[88:89], v[88:89], v[56:57] neg_lo:[0,1] neg_hi:[0,1]
v_pk_fma_f32 v[30:31], v[220:221], v[134:135], v[30:31]
v_pk_fma_f32 v[32:33], v[220:221], v[132:133], v[32:33]
v_pk_add_f32 v[56:57], v[56:57], v[22:23]
v_pk_add_f32 v[224:225], v[212:213], v[220:221]
v_pk_fma_f32 v[34:35], v[220:221], v[130:131], v[34:35]
v_lshlrev_b32 v250, 16, v226
v_pk_fma_f32 v[36:37], v[220:221], v[128:129], v[36:37]
v_pk_fma_f32 v[38:39], v[220:221], v[126:127], v[38:39]
v_and_b32 v251, v246, v226
v_pk_fma_f32 v[40:41], v[220:221], v[124:125], v[40:41]
v_pk_mul_f32 v[56:57], v[56:57], v[250:251]
v_pk_fma_f32 v[62:63], v[214:215], v[168:169], v[62:63]
v_pk_fma_f32 v[64:65], v[214:215], v[166:167], v[64:65]
v_cvt_pk_bf16_f32 v226, v56, v57
v_pk_fma_f32 v[66:67], v[214:215], v[164:165], v[66:67]
v_pk_fma_f32 v[68:69], v[214:215], v[162:163], v[68:69]
ds_write_b32 v249, v226 offset:3696
v_pk_fma_f32 v[70:71], v[214:215], v[160:161], v[70:71]
v_pk_fma_f32 v[72:73], v[214:215], v[158:159], v[72:73]
v_lshlrev_b32 v252, 16, v227
v_pk_fma_f32 v[90:91], v[224:225], v[138:139], v[90:91]
v_and_b32 v253, v246, v227
v_pk_fma_f32 v[92:93], v[224:225], v[198:199], v[92:93]
v_pk_fma_f32 v[94:95], v[224:225], v[196:197], v[94:95]
v_pk_mul_f32 v[88:89], v[88:89], v[252:253]
v_pk_fma_f32 v[96:97], v[224:225], v[194:195], v[96:97]
v_pk_fma_f32 v[98:99], v[224:225], v[192:193], v[98:99]
v_cvt_pk_bf16_f32 v227, v88, v89
v_pk_fma_f32 v[100:101], v[224:225], v[190:191], v[100:101]
v_pk_fma_f32 v[102:103], v[224:225], v[188:189], v[102:103]
ds_write_b32 v249, v227 offset:3960
v_pk_fma_f32 v[104:105], v[224:225], v[186:187], v[104:105]
s_waitcnt lgkmcnt(5)
v_lshlrev_b32 v218, 16, v238
v_and_b32 v219, v246, v238
v_pk_fma_f32 v[218:219], v[218:219], v[200:201], v[200:201] op_sel:[0,0,1] op_sel_hi:[1,0,1]
v_lshlrev_b32 v222, 16, v239
v_and_b32 v223, v246, v239
v_pk_fma_f32 v[222:223], v[222:223], v[202:203], v[202:203] op_sel:[0,0,1] op_sel_hi:[1,0,1]
ds_read_b128 v[208:211], v247 offset:80
s_waitcnt vmcnt(8)
ds_read2st64_b32 v[236:237], v244 offset0:52 offset1:53
ds_read2st64_b32 v[232:233], v248 offset0:18 offset1:19
v_pk_fma_f32 v[8:9], v[218:219], v[120:121], v[8:9]
v_pk_add_f32 v[90:91], v[90:91], v[26:27] neg_lo:[0,1] neg_hi:[0,1]
v_pk_fma_f32 v[10:11], v[218:219], v[118:119], v[10:11]
v_pk_add_f32 v[90:91], v[90:91], v[58:59] neg_lo:[0,1] neg_hi:[0,1]
v_pk_fma_f32 v[12:13], v[218:219], v[116:117], v[12:13]
v_pk_fma_f32 v[14:15], v[218:219], v[114:115], v[14:15]
v_pk_add_f32 v[58:59], v[58:59], v[24:25]
v_pk_add_f32 v[224:225], v[222:223], v[216:217]
v_pk_fma_f32 v[16:17], v[218:219], v[112:113], v[16:17]
v_lshlrev_b32 v250, 16, v228
v_pk_fma_f32 v[18:19], v[218:219], v[110:111], v[18:19]
v_and_b32 v251, v246, v228
v_pk_fma_f32 v[20:21], v[218:219], v[108:109], v[20:21]
v_pk_fma_f32 v[42:43], v[222:223], v[152:153], v[42:43]
v_pk_mul_f32 v[58:59], v[58:59], v[250:251]
v_pk_fma_f32 v[44:45], v[222:223], v[150:151], v[44:45]
v_pk_fma_f32 v[46:47], v[222:223], v[148:149], v[46:47]
v_cvt_pk_bf16_f32 v228, v58, v59
v_pk_fma_f32 v[48:49], v[222:223], v[146:147], v[48:49]
ds_write_b32 v249, v228 offset:4224
v_pk_fma_f32 v[50:51], v[222:223], v[144:145], v[50:51]
v_pk_fma_f32 v[52:53], v[222:223], v[142:143], v[52:53]
v_lshlrev_b32 v252, 16, v229
v_pk_fma_f32 v[54:55], v[222:223], v[140:141], v[54:55]
v_pk_fma_f32 v[74:75], v[224:225], v[182:183], v[74:75]
v_and_b32 v253, v246, v229
v_pk_fma_f32 v[76:77], v[224:225], v[180:181], v[76:77]
v_pk_mul_f32 v[90:91], v[90:91], v[252:253]
v_pk_fma_f32 v[78:79], v[224:225], v[178:179], v[78:79]
v_pk_fma_f32 v[80:81], v[224:225], v[176:177], v[80:81]
v_cvt_pk_bf16_f32 v229, v90, v91
v_pk_fma_f32 v[82:83], v[224:225], v[174:175], v[82:83]
v_pk_fma_f32 v[84:85], v[224:225], v[172:173], v[84:85]
ds_write_b32 v249, v229 offset:4488
v_pk_fma_f32 v[86:87], v[224:225], v[170:171], v[86:87]
s_waitcnt lgkmcnt(7)
v_lshlrev_b32 v220, 16, v240
v_and_b32 v221, v246, v240
v_pk_fma_f32 v[220:221], v[220:221], v[204:205], v[204:205] op_sel:[0,0,1] op_sel_hi:[1,0,1]
v_lshlrev_b32 v212, 16, v241
v_and_b32 v213, v246, v241
v_pk_fma_f32 v[212:213], v[212:213], v[206:207], v[206:207] op_sel:[0,0,1] op_sel_hi:[1,0,1]
ds_read_b128 v[200:203], v247 offset:416
ds_read2st64_b32 v[238:239], v244 offset0:8 offset1:9
ds_read2st64_b32 v[226:227], v248 offset0:10 offset1:11
v_pk_fma_f32 v[28:29], v[220:221], v[138:139], v[28:29]
v_pk_add_f32 v[86:87], v[86:87], v[22:23] neg_lo:[0,1] neg_hi:[0,1]
v_pk_fma_f32 v[30:31], v[220:221], v[136:137], v[30:31]
v_pk_add_f32 v[86:87], v[86:87], v[54:55] neg_lo:[0,1] neg_hi:[0,1]
v_pk_fma_f32 v[32:33], v[220:221], v[134:135], v[32:33]
v_pk_fma_f32 v[34:35], v[220:221], v[132:133], v[34:35]
v_pk_add_f32 v[54:55], v[54:55], v[20:21]
v_pk_add_f32 v[224:225], v[214:215], v[220:221]
v_lshlrev_b32 v250, 16, v230
v_pk_fma_f32 v[36:37], v[220:221], v[130:131], v[36:37]
v_pk_fma_f32 v[38:39], v[220:221], v[128:129], v[38:39]
v_and_b32 v251, v246, v230
v_pk_fma_f32 v[40:41], v[220:221], v[126:127], v[40:41]
v_pk_mul_f32 v[54:55], v[54:55], v[250:251]
v_pk_fma_f32 v[64:65], v[212:213], v[168:169], v[64:65]
v_pk_fma_f32 v[66:67], v[212:213], v[166:167], v[66:67]
v_cvt_pk_bf16_f32 v230, v54, v55
v_pk_fma_f32 v[68:69], v[212:213], v[164:165], v[68:69]
ds_write_b32 v249, v230 offset:3168
v_pk_fma_f32 v[70:71], v[212:213], v[162:163], v[70:71]
v_pk_fma_f32 v[72:73], v[212:213], v[160:161], v[72:73]
v_lshlrev_b32 v252, 16, v231
v_pk_fma_f32 v[92:93], v[224:225], v[138:139], v[92:93]
v_and_b32 v253, v246, v231
v_pk_fma_f32 v[94:95], v[224:225], v[198:199], v[94:95]
v_pk_fma_f32 v[96:97], v[224:225], v[196:197], v[96:97]
v_pk_mul_f32 v[86:87], v[86:87], v[252:253]
v_pk_fma_f32 v[98:99], v[224:225], v[194:195], v[98:99]
v_cvt_pk_bf16_f32 v231, v86, v87
v_pk_fma_f32 v[100:101], v[224:225], v[192:193], v[100:101]
v_pk_fma_f32 v[102:103], v[224:225], v[190:191], v[102:103]
ds_write_b32 v249, v231 offset:3432
v_pk_fma_f32 v[104:105], v[224:225], v[188:189], v[104:105]
s_waitcnt lgkmcnt(7)
v_lshlrev_b32 v216, 16, v234
v_and_b32 v217, v246, v234
v_pk_fma_f32 v[216:217], v[216:217], v[208:209], v[208:209] op_sel:[0,0,1] op_sel_hi:[1,0,1]
v_lshlrev_b32 v222, 16, v235
v_and_b32 v223, v246, v235
v_pk_fma_f32 v[222:223], v[222:223], v[210:211], v[210:211] op_sel:[0,0,1] op_sel_hi:[1,0,1]
ds_read_b128 v[204:207], v247 offset:64
ds_read2st64_b32 v[240:241], v244 offset0:54 offset1:55
ds_read2st64_b32 v[228:229], v248 offset0:20 offset1:21
v_pk_fma_f32 v[8:9], v[216:217], v[118:119], v[8:9]
v_pk_add_f32 v[92:93], v[92:93], v[28:29] neg_lo:[0,1] neg_hi:[0,1]
v_pk_fma_f32 v[10:11], v[216:217], v[116:117], v[10:11]
v_pk_add_f32 v[92:93], v[92:93], v[60:61] neg_lo:[0,1] neg_hi:[0,1]
v_pk_fma_f32 v[12:13], v[216:217], v[114:115], v[12:13]
v_pk_add_f32 v[60:61], v[60:61], v[26:27]
v_pk_fma_f32 v[14:15], v[216:217], v[112:113], v[14:15]
v_pk_add_f32 v[224:225], v[222:223], v[218:219]
v_lshlrev_b32 v250, 16, v232
v_pk_fma_f32 v[16:17], v[216:217], v[110:111], v[16:17]
v_and_b32 v251, v246, v232
v_pk_fma_f32 v[18:19], v[216:217], v[108:109], v[18:19]
v_pk_fma_f32 v[42:43], v[222:223], v[150:151], v[42:43]
v_pk_mul_f32 v[60:61], v[60:61], v[250:251]
v_pk_fma_f32 v[44:45], v[222:223], v[148:149], v[44:45]
v_cvt_pk_bf16_f32 v232, v60, v61
v_pk_fma_f32 v[46:47], v[222:223], v[146:147], v[46:47]
v_pk_fma_f32 v[48:49], v[222:223], v[144:145], v[48:49]
ds_write_b32 v249, v232 offset:4752
v_pk_fma_f32 v[50:51], v[222:223], v[142:143], v[50:51]
v_lshlrev_b32 v252, 16, v233
v_pk_fma_f32 v[52:53], v[222:223], v[140:141], v[52:53]
v_pk_fma_f32 v[74:75], v[224:225], v[180:181], v[74:75]
v_and_b32 v253, v246, v233
v_pk_fma_f32 v[76:77], v[224:225], v[178:179], v[76:77]
v_pk_mul_f32 v[92:93], v[92:93], v[252:253]
v_pk_fma_f32 v[78:79], v[224:225], v[176:177], v[78:79]
v_pk_fma_f32 v[80:81], v[224:225], v[174:175], v[80:81]
v_cvt_pk_bf16_f32 v233, v92, v93
v_pk_fma_f32 v[82:83], v[224:225], v[172:173], v[82:83]
ds_write_b32 v249, v233 offset:5016
v_pk_fma_f32 v[84:85], v[224:225], v[170:171], v[84:85]
s_waitcnt lgkmcnt(7)
v_lshlrev_b32 v220, 16, v236
v_and_b32 v221, v246, v236
v_pk_fma_f32 v[220:221], v[220:221], v[200:201], v[200:201] op_sel:[0,0,1] op_sel_hi:[1,0,1]
v_lshlrev_b32 v214, 16, v237
v_and_b32 v215, v246, v237
v_pk_fma_f32 v[214:215], v[214:215], v[202:203], v[202:203] op_sel:[0,0,1] op_sel_hi:[1,0,1]
ds_read_b128 v[208:211], v247 offset:432
s_waitcnt vmcnt(3)
ds_read2st64_b32 v[234:235], v244 offset0:6 offset1:7
ds_read2st64_b32 v[230:231], v248 offset0:8 offset1:9
v_pk_fma_f32 v[30:31], v[220:221], v[138:139], v[30:31]
v_pk_add_f32 v[84:85], v[84:85], v[20:21] neg_lo:[0,1] neg_hi:[0,1]
v_pk_fma_f32 v[32:33], v[220:221], v[136:137], v[32:33]
v_pk_add_f32 v[84:85], v[84:85], v[52:53] neg_lo:[0,1] neg_hi:[0,1]
v_pk_fma_f32 v[34:35], v[220:221], v[134:135], v[34:35]
v_pk_add_f32 v[52:53], v[52:53], v[18:19]
v_pk_fma_f32 v[36:37], v[220:221], v[132:133], v[36:37]
v_lshlrev_b32 v250, 16, v226
v_pk_add_f32 v[224:225], v[212:213], v[220:221]
v_pk_fma_f32 v[38:39], v[220:221], v[130:131], v[38:39]
v_and_b32 v251, v246, v226
v_pk_fma_f32 v[40:41], v[220:221], v[128:129], v[40:41]
v_pk_mul_f32 v[52:53], v[52:53], v[250:251]
v_pk_fma_f32 v[66:67], v[214:215], v[168:169], v[66:67]
v_cvt_pk_bf16_f32 v226, v52, v53
v_pk_fma_f32 v[68:69], v[214:215], v[166:167], v[68:69]
v_pk_fma_f32 v[70:71], v[214:215], v[164:165], v[70:71]
ds_write_b32 v249, v226 offset:2640
v_pk_fma_f32 v[72:73], v[214:215], v[162:163], v[72:73]
v_lshlrev_b32 v252, 16, v227
v_pk_fma_f32 v[94:95], v[224:225], v[138:139], v[94:95]
v_and_b32 v253, v246, v227
v_pk_fma_f32 v[96:97], v[224:225], v[198:199], v[96:97]
v_pk_fma_f32 v[98:99], v[224:225], v[196:197], v[98:99]
v_pk_mul_f32 v[84:85], v[84:85], v[252:253]
v_pk_fma_f32 v[100:101], v[224:225], v[194:195], v[100:101]
v_cvt_pk_bf16_f32 v227, v84, v85
v_pk_fma_f32 v[102:103], v[224:225], v[192:193], v[102:103]
ds_write_b32 v249, v227 offset:2904
v_pk_fma_f32 v[104:105], v[224:225], v[190:191], v[104:105]
s_waitcnt lgkmcnt(7)
v_lshlrev_b32 v218, 16, v238
v_and_b32 v219, v246, v238
v_pk_fma_f32 v[218:219], v[218:219], v[204:205], v[204:205] op_sel:[0,0,1] op_sel_hi:[1,0,1]
v_lshlrev_b32 v222, 16, v239
v_and_b32 v223, v246, v239
v_pk_fma_f32 v[222:223], v[222:223], v[206:207], v[206:207] op_sel:[0,0,1] op_sel_hi:[1,0,1]
ds_read_b128 v[200:203], v247 offset:48
s_waitcnt vmcnt(2)
ds_read2st64_b32 v[236:237], v244 offset0:56 offset1:57
ds_read2st64_b32 v[232:233], v248 offset0:22 offset1:23
v_pk_fma_f32 v[8:9], v[218:219], v[116:117], v[8:9]
v_pk_add_f32 v[94:95], v[94:95], v[30:31] neg_lo:[0,1] neg_hi:[0,1]
v_pk_fma_f32 v[10:11], v[218:219], v[114:115], v[10:11]
v_pk_add_f32 v[94:95], v[94:95], v[62:63] neg_lo:[0,1] neg_hi:[0,1]
v_pk_fma_f32 v[12:13], v[218:219], v[112:113], v[12:13]
v_pk_add_f32 v[62:63], v[62:63], v[28:29]
v_pk_fma_f32 v[14:15], v[218:219], v[110:111], v[14:15]
v_lshlrev_b32 v250, 16, v228
v_pk_add_f32 v[224:225], v[222:223], v[216:217]
v_and_b32 v251, v246, v228
v_pk_fma_f32 v[16:17], v[218:219], v[108:109], v[16:17]
v_pk_fma_f32 v[42:43], v[222:223], v[148:149], v[42:43]
v_pk_mul_f32 v[62:63], v[62:63], v[250:251]
v_pk_fma_f32 v[44:45], v[222:223], v[146:147], v[44:45]
v_cvt_pk_bf16_f32 v228, v62, v63
v_pk_fma_f32 v[46:47], v[222:223], v[144:145], v[46:47]
ds_write_b32 v249, v228 offset:5280
v_pk_fma_f32 v[48:49], v[222:223], v[142:143], v[48:49]
v_lshlrev_b32 v252, 16, v229
v_pk_fma_f32 v[50:51], v[222:223], v[140:141], v[50:51]
v_pk_fma_f32 v[74:75], v[224:225], v[178:179], v[74:75]
v_and_b32 v253, v246, v229
v_pk_fma_f32 v[76:77], v[224:225], v[176:177], v[76:77]
v_pk_mul_f32 v[94:95], v[94:95], v[252:253]
v_pk_fma_f32 v[78:79], v[224:225], v[174:175], v[78:79]
v_cvt_pk_bf16_f32 v229, v94, v95
v_pk_fma_f32 v[80:81], v[224:225], v[172:173], v[80:81]
ds_write_b32 v249, v229 offset:5544
v_pk_fma_f32 v[82:83], v[224:225], v[170:171], v[82:83]
s_waitcnt lgkmcnt(7)
v_lshlrev_b32 v220, 16, v240
v_and_b32 v221, v246, v240
v_pk_fma_f32 v[220:221], v[220:221], v[208:209], v[208:209] op_sel:[0,0,1] op_sel_hi:[1,0,1]
v_lshlrev_b32 v212, 16, v241
v_and_b32 v213, v246, v241
v_pk_fma_f32 v[212:213], v[212:213], v[210:211], v[210:211] op_sel:[0,0,1] op_sel_hi:[1,0,1]
ds_read_b128 v[204:207], v247 offset:448
ds_read2st64_b32 v[238:239], v244 offset0:4 offset1:5
ds_read2st64_b32 v[226:227], v248 offset0:6 offset1:7
v_pk_fma_f32 v[32:33], v[220:221], v[138:139], v[32:33]
v_pk_add_f32 v[82:83], v[82:83], v[18:19] neg_lo:[0,1] neg_hi:[0,1]
v_pk_fma_f32 v[34:35], v[220:221], v[136:137], v[34:35]
v_pk_add_f32 v[82:83], v[82:83], v[50:51] neg_lo:[0,1] neg_hi:[0,1]
v_pk_fma_f32 v[36:37], v[220:221], v[134:135], v[36:37]
v_pk_add_f32 v[50:51], v[50:51], v[16:17]
v_pk_fma_f32 v[38:39], v[220:221], v[132:133], v[38:39]
v_lshlrev_b32 v250, 16, v230
v_pk_add_f32 v[224:225], v[214:215], v[220:221]
v_and_b32 v251, v246, v230
v_pk_fma_f32 v[40:41], v[220:221], v[130:131], v[40:41]
v_pk_mul_f32 v[50:51], v[50:51], v[250:251]
v_pk_fma_f32 v[68:69], v[212:213], v[168:169], v[68:69]
v_cvt_pk_bf16_f32 v230, v50, v51
v_pk_fma_f32 v[70:71], v[212:213], v[166:167], v[70:71]
ds_write_b32 v249, v230 offset:2112
v_pk_fma_f32 v[72:73], v[212:213], v[164:165], v[72:73]
v_lshlrev_b32 v252, 16, v231
v_pk_fma_f32 v[96:97], v[224:225], v[138:139], v[96:97]
v_and_b32 v253, v246, v231
v_pk_fma_f32 v[98:99], v[224:225], v[198:199], v[98:99]
v_pk_mul_f32 v[82:83], v[82:83], v[252:253]
v_pk_fma_f32 v[100:101], v[224:225], v[196:197], v[100:101]
v_cvt_pk_bf16_f32 v231, v82, v83
v_pk_fma_f32 v[102:103], v[224:225], v[194:195], v[102:103]
ds_write_b32 v249, v231 offset:2376
v_pk_fma_f32 v[104:105], v[224:225], v[192:193], v[104:105]
s_waitcnt lgkmcnt(7)
v_lshlrev_b32 v216, 16, v234
v_and_b32 v217, v246, v234
v_pk_fma_f32 v[216:217], v[216:217], v[200:201], v[200:201] op_sel:[0,0,1] op_sel_hi:[1,0,1]
v_lshlrev_b32 v222, 16, v235
v_and_b32 v223, v246, v235
v_pk_fma_f32 v[222:223], v[222:223], v[202:203], v[202:203] op_sel:[0,0,1] op_sel_hi:[1,0,1]
ds_read_b128 v[208:211], v247 offset:32
ds_read2st64_b32 v[240:241], v244 offset0:58 offset1:59
ds_read2st64_b32 v[228:229], v248 offset0:24 offset1:25
v_pk_fma_f32 v[8:9], v[216:217], v[114:115], v[8:9]
v_pk_add_f32 v[96:97], v[96:97], v[32:33] neg_lo:[0,1] neg_hi:[0,1]
v_pk_fma_f32 v[10:11], v[216:217], v[112:113], v[10:11]
v_pk_add_f32 v[96:97], v[96:97], v[64:65] neg_lo:[0,1] neg_hi:[0,1]
v_pk_fma_f32 v[12:13], v[216:217], v[110:111], v[12:13]
v_pk_add_f32 v[64:65], v[64:65], v[30:31]
v_pk_fma_f32 v[14:15], v[216:217], v[108:109], v[14:15]
v_lshlrev_b32 v250, 16, v232
v_pk_add_f32 v[224:225], v[222:223], v[218:219]
v_and_b32 v251, v246, v232
v_pk_fma_f32 v[42:43], v[222:223], v[146:147], v[42:43]
v_pk_mul_f32 v[64:65], v[64:65], v[250:251]
v_pk_fma_f32 v[44:45], v[222:223], v[144:145], v[44:45]
v_cvt_pk_bf16_f32 v232, v64, v65
v_pk_fma_f32 v[46:47], v[222:223], v[142:143], v[46:47]
ds_write_b32 v249, v232 offset:5808
v_pk_fma_f32 v[48:49], v[222:223], v[140:141], v[48:49]
v_lshlrev_b32 v252, 16, v233
v_pk_fma_f32 v[74:75], v[224:225], v[176:177], v[74:75]
v_and_b32 v253, v246, v233
v_pk_fma_f32 v[76:77], v[224:225], v[174:175], v[76:77]
v_pk_mul_f32 v[96:97], v[96:97], v[252:253]
v_pk_fma_f32 v[78:79], v[224:225], v[172:173], v[78:79]
v_cvt_pk_bf16_f32 v233, v96, v97
v_pk_fma_f32 v[80:81], v[224:225], v[170:171], v[80:81]
ds_write_b32 v249, v233 offset:6072
s_waitcnt lgkmcnt(7)
v_lshlrev_b32 v220, 16, v236
v_and_b32 v221, v246, v236
v_pk_fma_f32 v[220:221], v[220:221], v[204:205], v[204:205] op_sel:[0,0,1] op_sel_hi:[1,0,1]
v_lshlrev_b32 v214, 16, v237
v_and_b32 v215, v246, v237
v_pk_fma_f32 v[214:215], v[214:215], v[206:207], v[206:207] op_sel:[0,0,1] op_sel_hi:[1,0,1]
ds_read_b128 v[200:203], v247 offset:464
s_waitcnt vmcnt(1)
ds_read2st64_b32 v[234:235], v244 offset0:2 offset1:3
ds_read2st64_b32 v[230:231], v248 offset0:4 offset1:5
v_pk_fma_f32 v[34:35], v[220:221], v[138:139], v[34:35]
v_pk_add_f32 v[80:81], v[80:81], v[16:17] neg_lo:[0,1] neg_hi:[0,1]
v_pk_add_f32 v[80:81], v[80:81], v[48:49] neg_lo:[0,1] neg_hi:[0,1]
v_pk_fma_f32 v[36:37], v[220:221], v[136:137], v[36:37]
v_pk_add_f32 v[48:49], v[48:49], v[14:15]
v_pk_fma_f32 v[38:39], v[220:221], v[134:135], v[38:39]
v_lshlrev_b32 v250, 16, v226
v_pk_fma_f32 v[40:41], v[220:221], v[132:133], v[40:41]
v_and_b32 v251, v246, v226
v_pk_add_f32 v[224:225], v[212:213], v[220:221]
v_pk_mul_f32 v[48:49], v[48:49], v[250:251]
v_pk_fma_f32 v[70:71], v[214:215], v[168:169], v[70:71]
v_cvt_pk_bf16_f32 v226, v48, v49
ds_write_b32 v249, v226 offset:1584
v_pk_fma_f32 v[72:73], v[214:215], v[166:167], v[72:73]
v_lshlrev_b32 v252, 16, v227
v_pk_fma_f32 v[98:99], v[224:225], v[138:139], v[98:99]
v_and_b32 v253, v246, v227
v_pk_fma_f32 v[100:101], v[224:225], v[198:199], v[100:101]
v_pk_mul_f32 v[80:81], v[80:81], v[252:253]
v_pk_fma_f32 v[102:103], v[224:225], v[196:197], v[102:103]
v_cvt_pk_bf16_f32 v227, v80, v81
v_pk_fma_f32 v[104:105], v[224:225], v[194:195], v[104:105]
ds_write_b32 v249, v227 offset:1848
s_waitcnt lgkmcnt(7)
v_lshlrev_b32 v218, 16, v238
v_and_b32 v219, v246, v238
v_pk_fma_f32 v[218:219], v[218:219], v[208:209], v[208:209] op_sel:[0,0,1] op_sel_hi:[1,0,1]
v_lshlrev_b32 v222, 16, v239
v_and_b32 v223, v246, v239
v_pk_fma_f32 v[222:223], v[222:223], v[210:211], v[210:211] op_sel:[0,0,1] op_sel_hi:[1,0,1]
ds_read_b128 v[204:207], v247 offset:16
s_waitcnt vmcnt(0)
ds_read2st64_b32 v[236:237], v244 offset0:60 offset1:61
ds_read2st64_b32 v[232:233], v248 offset0:26 offset1:27
v_pk_fma_f32 v[8:9], v[218:219], v[112:113], v[8:9]
v_pk_add_f32 v[98:99], v[98:99], v[34:35] neg_lo:[0,1] neg_hi:[0,1]
v_pk_add_f32 v[98:99], v[98:99], v[66:67] neg_lo:[0,1] neg_hi:[0,1]
v_pk_fma_f32 v[10:11], v[218:219], v[110:111], v[10:11]
v_pk_add_f32 v[66:67], v[66:67], v[32:33]
v_pk_fma_f32 v[12:13], v[218:219], v[108:109], v[12:13]
v_lshlrev_b32 v250, 16, v228
v_pk_fma_f32 v[42:43], v[222:223], v[144:145], v[42:43]
v_and_b32 v251, v246, v228
v_pk_mul_f32 v[66:67], v[66:67], v[250:251]
v_pk_add_f32 v[224:225], v[222:223], v[216:217]
v_cvt_pk_bf16_f32 v228, v66, v67
v_pk_fma_f32 v[44:45], v[222:223], v[142:143], v[44:45]
ds_write_b32 v249, v228 offset:6336
v_pk_fma_f32 v[46:47], v[222:223], v[140:141], v[46:47]
v_lshlrev_b32 v252, 16, v229
v_and_b32 v253, v246, v229
v_pk_fma_f32 v[74:75], v[224:225], v[174:175], v[74:75]
v_pk_mul_f32 v[98:99], v[98:99], v[252:253]
v_pk_fma_f32 v[76:77], v[224:225], v[172:173], v[76:77]
v_cvt_pk_bf16_f32 v229, v98, v99
v_pk_fma_f32 v[78:79], v[224:225], v[170:171], v[78:79]
ds_write_b32 v249, v229 offset:6600
s_waitcnt lgkmcnt(7)
v_lshlrev_b32 v220, 16, v240
v_and_b32 v221, v246, v240
v_pk_fma_f32 v[220:221], v[220:221], v[200:201], v[200:201] op_sel:[0,0,1] op_sel_hi:[1,0,1]
v_lshlrev_b32 v212, 16, v241
v_and_b32 v213, v246, v241
v_pk_fma_f32 v[212:213], v[212:213], v[202:203], v[202:203] op_sel:[0,0,1] op_sel_hi:[1,0,1]
ds_read_b128 v[208:211], v247 offset:480
ds_read2st64_b32 v[238:239], v244 offset0:0 offset1:1
ds_read2st64_b32 v[226:227], v248 offset0:2 offset1:3
v_pk_fma_f32 v[36:37], v[220:221], v[138:139], v[36:37]
v_pk_add_f32 v[78:79], v[78:79], v[14:15] neg_lo:[0,1] neg_hi:[0,1]
v_pk_add_f32 v[78:79], v[78:79], v[46:47] neg_lo:[0,1] neg_hi:[0,1]
v_pk_fma_f32 v[38:39], v[220:221], v[136:137], v[38:39]
v_pk_add_f32 v[46:47], v[46:47], v[12:13]
v_lshlrev_b32 v250, 16, v230
v_pk_fma_f32 v[40:41], v[220:221], v[134:135], v[40:41]
v_and_b32 v251, v246, v230
v_pk_fma_f32 v[72:73], v[212:213], v[168:169], v[72:73]
v_pk_mul_f32 v[46:47], v[46:47], v[250:251]
v_cvt_pk_bf16_f32 v230, v46, v47
v_pk_add_f32 v[224:225], v[214:215], v[220:221]
ds_write_b32 v249, v230 offset:1056
v_lshlrev_b32 v252, 16, v231
v_pk_fma_f32 v[100:101], v[224:225], v[138:139], v[100:101]
v_and_b32 v253, v246, v231
v_pk_fma_f32 v[102:103], v[224:225], v[198:199], v[102:103]
v_pk_mul_f32 v[78:79], v[78:79], v[252:253]
v_cvt_pk_bf16_f32 v231, v78, v79
v_pk_fma_f32 v[104:105], v[224:225], v[196:197], v[104:105]
ds_write_b32 v249, v231 offset:1320
s_waitcnt lgkmcnt(7)
v_lshlrev_b32 v216, 16, v234
v_and_b32 v217, v246, v234
v_pk_fma_f32 v[216:217], v[216:217], v[204:205], v[204:205] op_sel:[0,0,1] op_sel_hi:[1,0,1]
v_lshlrev_b32 v222, 16, v235
v_and_b32 v223, v246, v235
v_pk_fma_f32 v[222:223], v[222:223], v[206:207], v[206:207] op_sel:[0,0,1] op_sel_hi:[1,0,1]
ds_read_b128 v[200:203], v247 offset:0
ds_read2st64_b32 v[228:229], v248 offset0:28 offset1:29
ds_read2st64_b32 v[230:231], v248 offset0:30 offset1:31
v_pk_fma_f32 v[8:9], v[216:217], v[110:111], v[8:9]
v_pk_add_f32 v[100:101], v[100:101], v[36:37] neg_lo:[0,1] neg_hi:[0,1]
v_pk_add_f32 v[100:101], v[100:101], v[68:69] neg_lo:[0,1] neg_hi:[0,1]
v_pk_fma_f32 v[10:11], v[216:217], v[108:109], v[10:11]
v_pk_add_f32 v[68:69], v[68:69], v[34:35]
v_lshlrev_b32 v250, 16, v232
v_pk_fma_f32 v[42:43], v[222:223], v[142:143], v[42:43]
v_and_b32 v251, v246, v232
v_pk_mul_f32 v[68:69], v[68:69], v[250:251]
v_pk_fma_f32 v[44:45], v[222:223], v[140:141], v[44:45]
v_cvt_pk_bf16_f32 v232, v68, v69
ds_write_b32 v249, v232 offset:6864
v_pk_add_f32 v[224:225], v[222:223], v[218:219]
v_lshlrev_b32 v252, 16, v233
v_and_b32 v253, v246, v233
v_pk_fma_f32 v[74:75], v[224:225], v[172:173], v[74:75]
v_pk_mul_f32 v[100:101], v[100:101], v[252:253]
v_cvt_pk_bf16_f32 v233, v100, v101
v_pk_fma_f32 v[76:77], v[224:225], v[170:171], v[76:77]
ds_write_b32 v249, v233 offset:7128
s_waitcnt lgkmcnt(7)
v_lshlrev_b32 v220, 16, v236
v_and_b32 v221, v246, v236
v_pk_fma_f32 v[220:221], v[220:221], v[208:209], v[208:209] op_sel:[0,0,1] op_sel_hi:[1,0,1]
v_lshlrev_b32 v214, 16, v237
v_and_b32 v215, v246, v237
v_pk_fma_f32 v[214:215], v[214:215], v[210:211], v[210:211] op_sel:[0,0,1] op_sel_hi:[1,0,1]
ds_read2st64_b32 v[232:233], v248 offset0:0 offset1:1
v_pk_fma_f32 v[38:39], v[220:221], v[138:139], v[38:39]
v_pk_add_f32 v[76:77], v[76:77], v[12:13] neg_lo:[0,1] neg_hi:[0,1]
v_pk_add_f32 v[76:77], v[76:77], v[44:45] neg_lo:[0,1] neg_hi:[0,1]
v_pk_add_f32 v[44:45], v[44:45], v[10:11]
v_pk_fma_f32 v[40:41], v[220:221], v[136:137], v[40:41]
v_lshlrev_b32 v250, 16, v226
v_and_b32 v251, v246, v226
v_pk_add_f32 v[224:225], v[212:213], v[220:221]
v_pk_mul_f32 v[44:45], v[44:45], v[250:251]
v_cvt_pk_bf16_f32 v226, v44, v45
v_pk_fma_f32 v[102:103], v[224:225], v[138:139], v[102:103]
ds_write_b32 v249, v226 offset:528
v_lshlrev_b32 v252, 16, v227
v_pk_fma_f32 v[104:105], v[224:225], v[198:199], v[104:105]
v_and_b32 v253, v246, v227
v_pk_mul_f32 v[76:77], v[76:77], v[252:253]
v_pk_fma_f32 v[104:105], v[214:215], v[138:139], v[104:105]
v_cvt_pk_bf16_f32 v227, v76, v77
ds_write_b32 v249, v227 offset:792
s_waitcnt lgkmcnt(5)
v_lshlrev_b32 v218, 16, v238
v_and_b32 v219, v246, v238
v_pk_fma_f32 v[218:219], v[218:219], v[200:201], v[200:201] op_sel:[0,0,1] op_sel_hi:[1,0,1]
v_lshlrev_b32 v222, 16, v239
v_and_b32 v223, v246, v239
v_pk_fma_f32 v[222:223], v[222:223], v[202:203], v[202:203] op_sel:[0,0,1] op_sel_hi:[1,0,1]
v_pk_fma_f32 v[8:9], v[218:219], v[108:109], v[8:9]
v_pk_add_f32 v[102:103], v[102:103], v[38:39] neg_lo:[0,1] neg_hi:[0,1]
v_pk_add_f32 v[102:103], v[102:103], v[70:71] neg_lo:[0,1] neg_hi:[0,1]
v_pk_add_f32 v[70:71], v[70:71], v[36:37]
v_lshlrev_b32 v250, 16, v228
v_and_b32 v251, v246, v228
v_pk_mul_f32 v[70:71], v[70:71], v[250:251]
v_cvt_pk_bf16_f32 v228, v70, v71
v_pk_fma_f32 v[42:43], v[222:223], v[140:141], v[42:43]
ds_write_b32 v249, v228 offset:7392
v_lshlrev_b32 v252, 16, v229
v_and_b32 v253, v246, v229
v_pk_mul_f32 v[102:103], v[102:103], v[252:253]
v_cvt_pk_bf16_f32 v229, v102, v103
ds_write_b32 v249, v229 offset:7656
v_pk_add_f32 v[224:225], v[222:223], v[216:217]
v_pk_add_f32 v[104:105], v[104:105], v[40:41] neg_lo:[0,1] neg_hi:[0,1]
v_pk_add_f32 v[104:105], v[104:105], v[72:73] neg_lo:[0,1] neg_hi:[0,1]
v_pk_add_f32 v[72:73], v[72:73], v[38:39]
v_lshlrev_b32 v250, 16, v230
v_and_b32 v251, v246, v230
v_pk_mul_f32 v[72:73], v[72:73], v[250:251]
v_cvt_pk_bf16_f32 v230, v72, v73
v_pk_fma_f32 v[74:75], v[224:225], v[170:171], v[74:75]
ds_write_b32 v249, v230 offset:7920
v_lshlrev_b32 v252, 16, v231
v_and_b32 v253, v246, v231
v_pk_mul_f32 v[104:105], v[104:105], v[252:253]
v_cvt_pk_bf16_f32 v231, v104, v105
ds_write_b32 v249, v231 offset:8184
s_waitcnt lgkmcnt(0)
v_pk_add_f32 v[74:75], v[74:75], v[10:11] neg_lo:[0,1] neg_hi:[0,1]
v_pk_add_f32 v[74:75], v[74:75], v[42:43] neg_lo:[0,1] neg_hi:[0,1]
v_pk_add_f32 v[42:43], v[42:43], v[8:9]
v_lshlrev_b32 v250, 16, v232
v_and_b32 v251, v246, v232
v_pk_mul_f32 v[42:43], v[42:43], v[250:251]
v_cvt_pk_bf16_f32 v232, v42, v43
ds_write_b32 v249, v232 offset:0
v_lshlrev_b32 v252, 16, v233
v_and_b32 v253, v246, v233
v_pk_mul_f32 v[74:75], v[74:75], v[252:253]
v_cvt_pk_bf16_f32 v233, v74, v75
ds_write_b32 v249, v233 offset:264
v_and_b32 v3, 31, v1
v_mul_u32_u24 v3, 264, v3
v_lshrrev_b32 v5, 5, v1
v_lshl_add_u32 v3, v5, 3, v3
s_add_u32 s53, s59, 16128
v_add_u32 v245, s53, v3
s_waitcnt lgkmcnt(0)
ds_read2_b64 v[108:111], v245 offset0:0 offset1:2
ds_read2_b64 v[112:115], v245 offset0:4 offset1:6
ds_read2_b64 v[116:119], v245 offset0:8 offset1:10
ds_read2_b64 v[120:123], v245 offset0:12 offset1:14
ds_read2_b64 v[124:127], v245 offset0:16 offset1:18
ds_read2_b64 v[128:131], v245 offset0:20 offset1:22
ds_read2_b64 v[132:135], v245 offset0:24 offset1:26
ds_read2_b64 v[136:139], v245 offset0:28 offset1:30
s_lshl_b32 s53, s28, 13
s_add_u32 s43, s43, s53
s_waitcnt lgkmcnt(7)
s_add_u32 s48, s43, 0
buffer_store_dwordx4 v[108:111], v2, s[32:35], s48 offen offset:0 sc1
s_waitcnt lgkmcnt(6)
buffer_store_dwordx4 v[112:115], v2, s[32:35], s48 offen offset:1024 sc1
s_waitcnt lgkmcnt(5)
buffer_store_dwordx4 v[116:119], v2, s[32:35], s48 offen offset:2048 sc1
s_waitcnt lgkmcnt(4)
buffer_store_dwordx4 v[120:123], v2, s[32:35], s48 offen offset:3072 sc1
s_waitcnt lgkmcnt(3)
s_add_u32 s48, s43, 4096
buffer_store_dwordx4 v[124:127], v2, s[32:35], s48 offen offset:0 sc1
s_waitcnt lgkmcnt(2)
buffer_store_dwordx4 v[128:131], v2, s[32:35], s48 offen offset:1024 sc1
s_waitcnt lgkmcnt(1)
buffer_store_dwordx4 v[132:135], v2, s[32:35], s48 offen offset:2048 sc1
s_waitcnt lgkmcnt(0)
buffer_store_dwordx4 v[136:139], v2, s[32:35], s48 offen offset:3072 sc1
s_mov_b64 exec, -1
v_mov_b32 v5, 1
s_waitcnt vmcnt(0) lgkmcnt(0)
s_barrier
s_cmp_lg_u32 s28, 0
s_cbranch_scc1 L_p2_nopub_19
s_mov_b64 exec, 1
buffer_store_dword v5, off, s[32:35], s65 sc1
s_mov_b64 exec, -1
L_p2_nopub_19:
L_p3_start:
v_and_b32 v1, 63, v0
v_lshrrev_b32 v3, 6, v0
v_lshlrev_b32 v2, 4, v1
v_readfirstlane_b32 s28, v3
s_and_b32 s52, s2, 7
s_lshr_b32 s53, s2, 3
s_lshr_b32 s50, s52, 2
s_and_b32 s54, s52, 3
s_lshl_b32 s54, s54, 2
s_and_b32 s55, s53, 3
s_add_u32 s54, s54, s55
s_lshr_b32 s55, s53, 2
s_and_b32 s44, s28, 1
s_lshr_b32 s45, s28, 1
s_cmp_ge_u32 s28, 2
s_cbranch_scc1 L_p3_bsrc
s_lshl_b32 s56, s55, 1
s_add_u32 s56, s56, s28
s_lshl_b32 s57, s50, 4
s_add_u32 s57, s57, s56
s_lshl_b32 s57, s57, 16
s_add_u32 s46, s57, 0x1000000
s_lshl_b32 s57, s56, 15
s_add_u32 s47, s57, 0xa68000
s_branch L_p3_srcdone
L_p3_bsrc:
s_lshl_b32 s56, s54, 1
s_add_u32 s56, s56, s28
s_sub_u32 s56, s56, 2
s_lshl_b32 s57, s50, 5
s_add_u32 s56, s56, s57
s_lshl_b32 s57, s56, 16
s_add_u32 s46, s57, 0xc00000
s_lshl_b32 s57, s56, 15
s_add_u32 s47, s57, 0x1200000
L_p3_srcdone:
s_lshl_b32 s48, s28, 13
s_lshl_b32 s56, s50, 3
s_lshr_b32 s57, s54, 1
s_add_u32 s56, s56, s57
s_lshl_b32 s56, s56, 3
s_lshl_b32 s57, s50, 2
s_lshr_b32 s58, s55, 1
s_add_u32 s57, s57, s58
s_lshl_b32 s57, s57, 3
s_add_u32 s57, s57, 120
v_mov_b32 v11, s57
v_mov_b32 v4, s56
v_cmp_gt_u32 vcc, 8, v1
s_nop 1
v_cndmask_b32 v11, v11, v4, vcc
v_add_u32 v11, v11, v1
v_lshlrev_b32 v11, 7, v11
v_add_u32 v11, 0xb50000, v11
v_mov_b32 v4, 0x7ff00000
v_cmp_gt_u32 vcc, 16, v1
s_nop 1
v_cndmask_b32 v11, v4, v11, vcc
s_lshl_b32 s56, s50, 5
s_lshl_b32 s57, s54, 1
s_add_u32 s56, s56, s57
s_add_u32 s56, s56, 192
v_add_u32 v12, s56, v1
v_lshlrev_b32 v12, 7, v12
v_add_u32 v12, 0xb50000, v12
s_lshr_b32 s56, s55, 1
s_add_u32 s56, s56, 232
v_lshlrev_b32 v5, 2, v1
v_add_u32 v5, s56, v5
v_lshlrev_b32 v5, 7, v5
v_add_u32 v5, 0xb58000, v5
v_cmp_gt_u32 vcc, 2, v1
s_nop 1
v_cndmask_b32 v12, v5, v12, vcc
v_cmp_gt_u32 vcc, 6, v1
s_nop 1
v_cndmask_b32 v12, v4, v12, vcc
s_mov_b32 s60, 0x100000
L_p2_polla_21:
buffer_load_dword v13, v11, s[32:35], 0 offen sc1
s_waitcnt vmcnt(0)
v_cmp_eq_u32 vcc, 1, v13
s_nop 4
s_and_b32 vcc_lo, vcc_lo, 0xffff
s_cmp_eq_u32 vcc_lo, 0xffff
s_cbranch_scc1 L_p2_polloka_22
s_sub_u32 s60, s60, 1
s_cmp_eq_u32 s60, 0
s_cbranch_scc1 L_p2_polloka_22
s_sleep 2
s_branch L_p2_polla_21
L_p2_polloka_22:
L_p2_seen_20:
s_add_u32 s49, s46, 0
s_add_u32 m0, s48, 0
s_nop 0
buffer_load_dwordx4 v2, s[32:35], s49 offen offset:0 sc1 lds
buffer_load_dwordx4 v2, s[32:35], s49 offen offset:1024 sc1 lds
buffer_load_dwordx4 v2, s[32:35], s49 offen offset:2048 sc1 lds
buffer_load_dwordx4 v2, s[32:35], s49 offen offset:3072 sc1 lds
s_add_u32 s49, s46, 4096
s_add_u32 m0, s48, 4096
s_nop 0
buffer_load_dwordx4 v2, s[32:35], s49 offen offset:0 sc1 lds
buffer_load_dwordx4 v2, s[32:35], s49 offen offset:1024 sc1 lds
buffer_load_dwordx4 v2, s[32:35], s49 offen offset:2048 sc1 lds
buffer_load_dwordx4 v2, s[32:35], s49 offen offset:3072 sc1 lds
s_add_u32 s49, s46, 8192
s_add_u32 m0, s48, 32768
s_nop 0
buffer_load_dwordx4 v2, s[32:35], s49 offen offset:0 sc1 lds
buffer_load_dwordx4 v2, s[32:35], s49 offen offset:1024 sc1 lds
buffer_load_dwordx4 v2, s[32:35], s49 offen offset:2048 sc1 lds
buffer_load_dwordx4 v2, s[32:35], s49 offen offset:3072 sc1 lds
s_add_u32 s49, s46, 12288
s_add_u32 m0, s48, 36864
s_nop 0
buffer_load_dwordx4 v2, s[32:35], s49 offen offset:0 sc1 lds
buffer_load_dwordx4 v2, s[32:35], s49 offen offset:1024 sc1 lds
buffer_load_dwordx4 v2, s[32:35], s49 offen offset:2048 sc1 lds
buffer_load_dwordx4 v2, s[32:35], s49 offen offset:3072 sc1 lds
s_mov_b32 s36, s4
s_and_b32 s37, s5, 0xffff
s_mov_b32 s38, 0x1f4000
s_mov_b32 s39, 0x20000
s_mov_b32 s40, s22
s_and_b32 s41, s23, 0xffff
s_mov_b32 s42, 0x1f4000
s_mov_b32 s43, 0x20000
s_lshl_b32 s56, s50, 13
s_lshl_b32 s57, s54, 6
s_add_u32 s56, s56, s57
s_lshl_b32 s57, s45, 5
s_add_u32 s56, s56, s57
s_lshl_b32 s56, s56, 3
s_add_u32 s56, s56, 0x1400000
v_and_b32 v3, 31, v1
v_lshlrev_b32 v4, 3, v3
s_add_u32 s57, s56, 0
buffer_load_dwordx2 v[20:21], v4, s[32:35], s57 offen sc1
s_add_u32 s57, s56, 8192
buffer_load_dwordx2 v[22:23], v4, s[32:35], s57 offen sc1
s_add_u32 s57, s56, 16384
buffer_load_dwordx2 v[24:25], v4, s[32:35], s57 offen sc1
s_add_u32 s57, s56, 24576
buffer_load_dwordx2 v[26:27], v4, s[32:35], s57 offen sc1
s_add_u32 s57, s56, 32768
buffer_load_dwordx2 v[28:29], v4, s[32:35], s57 offen sc1
s_add_u32 s57, s56, 40960
buffer_load_dwordx2 v[30:31], v4, s[32:35], s57 offen sc1
s_add_u32 s57, s56, 49152
buffer_load_dwordx2 v[32:33], v4, s[32:35], s57 offen sc1
s_add_u32 s57, s56, 57344
buffer_load_dwordx2 v[34:35], v4, s[32:35], s57 offen sc1
s_and_b32 s56, s54, 1
s_lshl_b32 s56, s56, 6
s_lshl_b32 s57, s45, 5
s_add_u32 s56, s56, s57
v_add_u32 v3, s56, v3
s_lshl_b32 s56, s50, 3
s_lshr_b32 s57, s54, 1
s_add_u32 s56, s56, s57
s_mul_i32 s56, s56, 125
v_add_u32 v4, s56, v3
v_lshlrev_b32 v4, 10, v4
s_lshl_b32 s56, s55, 7
s_lshl_b32 s57, s44, 6
s_add_u32 s56, s56, s57
v_add_u32 v4, s56, v4
v_lshrrev_b32 v5, 5, v1
v_lshl_add_u32 v7, v5, 3, v4
v_lshl_add_u32 v8, v5, 4, v4
v_cmp_gt_u32 vcc, 125, v3
v_mov_b32 v6, 0x7ff00000
s_nop 0
v_cndmask_b32 v7, v6, v7, vcc
v_cndmask_b32 v8, v6, v8, vcc
s_lshl_b32 s56, s44, 13
s_lshl_b32 s57, s45, 13
s_add_u32 s57, s57, 16384
s_add_u32 s58, s56, 0
v_add_u32 v14, s58, v2
s_add_u32 s58, s57, 0
v_add_u32 v17, s58, v2
s_add_u32 s58, s56, 65536
v_add_u32 v15, s58, v2
s_add_u32 s58, s57, 65536
v_add_u32 v18, s58, v2
s_add_u32 s58, s56, 131072
v_add_u32 v16, s58, v2
s_add_u32 s58, s57, 131072
v_add_u32 v19, s58, v2
s_waitcnt vmcnt(16)
s_barrier
ds_read_b128 v[108:111], v14 offset:0
ds_read_b128 v[116:119], v17 offset:0
s_waitcnt lgkmcnt(0)
v_mfma_f32_32x32x16_bf16 v[76:91], v[108:111], v[116:119], 0
ds_read_b128 v[112:115], v14 offset:1024
ds_read_b128 v[120:123], v17 offset:1024
s_add_u32 s49, s46, 16384
s_add_u32 m0, s48, 65536
s_nop 0
buffer_load_dwordx4 v2, s[32:35], s49 offen offset:0 sc1 lds
s_waitcnt lgkmcnt(0)
v_mfma_f32_32x32x16_bf16 v[76:91], v[112:115], v[120:123], v[76:91]
ds_read_b128 v[108:111], v14 offset:2048
ds_read_b128 v[116:119], v17 offset:2048
buffer_load_dwordx4 v2, s[32:35], s49 offen offset:1024 sc1 lds
s_waitcnt lgkmcnt(0)
v_mfma_f32_32x32x16_bf16 v[76:91], v[108:111], v[116:119], v[76:91]
ds_read_b128 v[112:115], v14 offset:3072
ds_read_b128 v[120:123], v17 offset:3072
buffer_load_dwordx4 v2, s[32:35], s49 offen offset:2048 sc1 lds
s_waitcnt lgkmcnt(0)
v_mfma_f32_32x32x16_bf16 v[76:91], v[112:115], v[120:123], v[76:91]
ds_read_b128 v[108:111], v14 offset:4096
ds_read_b128 v[116:119], v17 offset:4096
buffer_load_dwordx4 v2, s[32:35], s49 offen offset:3072 sc1 lds
s_waitcnt lgkmcnt(0)
v_mfma_f32_32x32x16_bf16 v[76:91], v[108:111], v[116:119], v[76:91]
ds_read_b128 v[112:115], v14 offset:5120
ds_read_b128 v[120:123], v17 offset:5120
s_add_u32 s49, s46, 20480
s_add_u32 m0, s48, 69632
s_nop 0
buffer_load_dwordx4 v2, s[32:35], s49 offen offset:0 sc1 lds
s_waitcnt lgkmcnt(0)
v_mfma_f32_32x32x16_bf16 v[76:91], v[112:115], v[120:123], v[76:91]
ds_read_b128 v[108:111], v14 offset:6144
ds_read_b128 v[116:119], v17 offset:6144
buffer_load_dwordx4 v2, s[32:35], s49 offen offset:1024 sc1 lds
s_waitcnt lgkmcnt(0)
v_mfma_f32_32x32x16_bf16 v[76:91], v[108:111], v[116:119], v[76:91]
ds_read_b128 v[112:115], v14 offset:7168
ds_read_b128 v[120:123], v17 offset:7168
buffer_load_dwordx4 v2, s[32:35], s49 offen offset:2048 sc1 lds
s_waitcnt lgkmcnt(0)
v_mfma_f32_32x32x16_bf16 v[76:91], v[112:115], v[120:123], v[76:91]
s_waitcnt vmcnt(15)
s_barrier
ds_read_b128 v[108:111], v14 offset:32768
ds_read_b128 v[116:119], v17 offset:32768
buffer_load_dwordx4 v2, s[32:35], s49 offen offset:3072 sc1 lds
s_waitcnt lgkmcnt(0)
v_mfma_f32_32x32x16_bf16 v[92:107], v[108:111], v[116:119], 0
ds_read_b128 v[112:115], v14 offset:33792
ds_read_b128 v[120:123], v17 offset:33792
s_add_u32 s49, s46, 24576
s_add_u32 m0, s48, 98304
s_nop 0
buffer_load_dwordx4 v2, s[32:35], s49 offen offset:0 sc1 lds
s_waitcnt vmcnt(9)
v_max3_f32 v9, v20, v22, v24
v_max3_f32 v9, v9, v26, v28
v_max3_f32 v9, v9, v30, v32
v_max_f32 v9, v9, v34
v_sub_f32 v20, v20, v9
v_sub_f32 v22, v22, v9
v_sub_f32 v24, v24, v9
v_sub_f32 v26, v26, v9
v_sub_f32 v28, v28, v9
v_sub_f32 v30, v30, v9
v_sub_f32 v32, v32, v9
v_sub_f32 v34, v34, v9
v_exp_f32 v20, v20
s_waitcnt lgkmcnt(0)
v_mfma_f32_32x32x16_bf16 v[92:107], v[112:115], v[120:123], v[92:107]
ds_read_b128 v[108:111], v14 offset:34816
ds_read_b128 v[116:119], v17 offset:34816
buffer_load_dwordx4 v2, s[32:35], s49 offen offset:1024 sc1 lds
v_exp_f32 v22, v22
v_exp_f32 v24, v24
v_exp_f32 v26, v26
v_exp_f32 v28, v28
v_exp_f32 v30, v30
v_exp_f32 v32, v32
v_exp_f32 v34, v34
v_mul_f32 v10, v20, v21
v_fmac_f32 v10, v22, v23
v_fmac_f32 v10, v24, v25
v_fmac_f32 v10, v26, v27
v_fmac_f32 v10, v28, v29
v_fmac_f32 v10, v30, v31
s_waitcnt lgkmcnt(0)
v_mfma_f32_32x32x16_bf16 v[92:107], v[108:111], v[116:119], v[92:107]
ds_read_b128 v[112:115], v14 offset:35840
ds_read_b128 v[120:123], v17 offset:35840
buffer_load_dwordx4 v2, s[32:35], s49 offen offset:2048 sc1 lds
v_fmac_f32 v10, v32, v33
v_fmac_f32 v10, v34, v35
v_rcp_f32 v10, v10
s_nop 0
v_mul_f32 v20, v20, v10
v_mul_f32 v22, v22, v10
v_mul_f32 v24, v24, v10
v_mul_f32 v26, v26, v10
v_mul_f32 v28, v28, v10
v_mul_f32 v30, v30, v10
v_mul_f32 v32, v32, v10
v_mul_f32 v34, v34, v10
s_waitcnt lgkmcnt(0)
v_mfma_f32_32x32x16_bf16 v[92:107], v[112:115], v[120:123], v[92:107]
ds_read_b128 v[108:111], v14 offset:36864
ds_read_b128 v[116:119], v17 offset:36864
buffer_load_dwordx4 v2, s[32:35], s49 offen offset:3072 sc1 lds
v_mul_f32 v44, v20, v76
v_mul_f32 v45, v20, v77
v_mul_f32 v46, v20, v78
v_mul_f32 v47, v20, v79
s_waitcnt lgkmcnt(0)
v_mfma_f32_32x32x16_bf16 v[92:107], v[108:111], v[116:119], v[92:107]
ds_read_b128 v[112:115], v14 offset:37888
ds_read_b128 v[120:123], v17 offset:37888
s_add_u32 s49, s46, 28672
s_add_u32 m0, s48, 102400
s_nop 0
buffer_load_dwordx4 v2, s[32:35], s49 offen offset:0 sc1 lds
v_mul_f32 v48, v20, v80
v_mul_f32 v49, v20, v81
v_mul_f32 v50, v20, v82
v_mul_f32 v51, v20, v83
s_waitcnt lgkmcnt(0)
v_mfma_f32_32x32x16_bf16 v[92:107], v[112:115], v[120:123], v[92:107]
ds_read_b128 v[108:111], v14 offset:38912
ds_read_b128 v[116:119], v17 offset:38912
buffer_load_dwordx4 v2, s[32:35], s49 offen offset:1024 sc1 lds
v_mul_f32 v52, v20, v84
v_mul_f32 v53, v20, v85
v_mul_f32 v54, v20, v86
v_mul_f32 v55, v20, v87
s_waitcnt lgkmcnt(0)
v_mfma_f32_32x32x16_bf16 v[92:107], v[108:111], v[116:119], v[92:107]
ds_read_b128 v[112:115], v14 offset:39936
ds_read_b128 v[120:123], v17 offset:39936
buffer_load_dwordx4 v2, s[32:35], s49 offen offset:2048 sc1 lds
v_mul_f32 v56, v20, v88
v_mul_f32 v57, v20, v89
v_mul_f32 v58, v20, v90
v_mul_f32 v59, v20, v91
s_waitcnt lgkmcnt(0)
v_mfma_f32_32x32x16_bf16 v[92:107], v[112:115], v[120:123], v[92:107]
s_waitcnt vmcnt(7)
s_barrier
ds_read_b128 v[108:111], v15 offset:0
ds_read_b128 v[116:119], v18 offset:0
buffer_load_dwordx4 v2, s[32:35], s49 offen offset:3072 sc1 lds
s_waitcnt lgkmcnt(0)
v_mfma_f32_32x32x16_bf16 v[76:91], v[108:111], v[116:119], 0
ds_read_b128 v[112:115], v15 offset:1024
ds_read_b128 v[120:123], v18 offset:1024
s_add_u32 s49, s46, 32768
s_add_u32 m0, s48, 131072
s_nop 0
buffer_load_dwordx4 v2, s[32:35], s49 offen offset:0 sc1 lds
s_waitcnt lgkmcnt(0)
v_mfma_f32_32x32x16_bf16 v[76:91], v[112:115], v[120:123], v[76:91]
ds_read_b128 v[108:111], v15 offset:2048
ds_read_b128 v[116:119], v18 offset:2048
buffer_load_dwordx4 v2, s[32:35], s49 offen offset:1024 sc1 lds
s_waitcnt lgkmcnt(0)
v_mfma_f32_32x32x16_bf16 v[76:91], v[108:111], v[116:119], v[76:91]
ds_read_b128 v[112:115], v15 offset:3072
ds_read_b128 v[120:123], v18 offset:3072
buffer_load_dwordx4 v2, s[32:35], s49 offen offset:2048 sc1 lds
s_waitcnt lgkmcnt(0)
v_mfma_f32_32x32x16_bf16 v[76:91], v[112:115], v[120:123], v[76:91]
ds_read_b128 v[108:111], v15 offset:4096
ds_read_b128 v[116:119], v18 offset:4096
buffer_load_dwordx4 v2, s[32:35], s49 offen offset:3072 sc1 lds
v_fmac_f32 v44, v22, v92
v_fmac_f32 v45, v22, v93
v_fmac_f32 v46, v22, v94
v_fmac_f32 v47, v22, v95
s_waitcnt lgkmcnt(0)
v_mfma_f32_32x32x16_bf16 v[76:91], v[108:111], v[116:119], v[76:91]
ds_read_b128 v[112:115], v15 offset:5120
ds_read_b128 v[120:123], v18 offset:5120
s_add_u32 s49, s46, 36864
s_add_u32 m0, s48, 135168
s_nop 0
buffer_load_dwordx4 v2, s[32:35], s49 offen offset:0 sc1 lds
v_fmac_f32 v48, v22, v96
v_fmac_f32 v49, v22, v97
v_fmac_f32 v50, v22, v98
v_fmac_f32 v51, v22, v99
s_waitcnt lgkmcnt(0)
v_mfma_f32_32x32x16_bf16 v[76:91], v[112:115], v[120:123], v[76:91]
ds_read_b128 v[108:111], v15 offset:6144
ds_read_b128 v[116:119], v18 offset:6144
buffer_load_dwordx4 v2, s[32:35], s49 offen offset:1024 sc1 lds
v_fmac_f32 v52, v22, v100
v_fmac_f32 v53, v22, v101
v_fmac_f32 v54, v22, v102
v_fmac_f32 v55, v22, v103
s_waitcnt lgkmcnt(0)
v_mfma_f32_32x32x16_bf16 v[76:91], v[108:111], v[116:119], v[76:91]
ds_read_b128 v[112:115], v15 offset:7168
ds_read_b128 v[120:123], v18 offset:7168
buffer_load_dwordx4 v2, s[32:35], s49 offen offset:2048 sc1 lds
v_fmac_f32 v56, v22, v104
v_fmac_f32 v57, v22, v105
v_fmac_f32 v58, v22, v106
v_fmac_f32 v59, v22, v107
s_waitcnt lgkmcnt(0)
v_mfma_f32_32x32x16_bf16 v[76:91], v[112:115], v[120:123], v[76:91]
s_waitcnt vmcnt(7)
s_barrier
ds_read_b128 v[108:111], v15 offset:32768
ds_read_b128 v[116:119], v18 offset:32768
buffer_load_dwordx4 v2, s[32:35], s49 offen offset:3072 sc1 lds
s_waitcnt lgkmcnt(0)
v_mfma_f32_32x32x16_bf16 v[92:107], v[108:111], v[116:119], 0
ds_read_b128 v[112:115], v15 offset:33792
ds_read_b128 v[120:123], v18 offset:33792
s_add_u32 s49, s46, 40960
s_add_u32 m0, s48, 0
s_nop 0
buffer_load_dwordx4 v2, s[32:35], s49 offen offset:0 sc1 lds
s_waitcnt lgkmcnt(0)
v_mfma_f32_32x32x16_bf16 v[92:107], v[112:115], v[120:123], v[92:107]
ds_read_b128 v[108:111], v15 offset:34816
ds_read_b128 v[116:119], v18 offset:34816
buffer_load_dwordx4 v2, s[32:35], s49 offen offset:1024 sc1 lds
s_waitcnt lgkmcnt(0)
v_mfma_f32_32x32x16_bf16 v[92:107], v[108:111], v[116:119], v[92:107]
ds_read_b128 v[112:115], v15 offset:35840
ds_read_b128 v[120:123], v18 offset:35840
buffer_load_dwordx4 v2, s[32:35], s49 offen offset:2048 sc1 lds
s_waitcnt lgkmcnt(0)
v_mfma_f32_32x32x16_bf16 v[92:107], v[112:115], v[120:123], v[92:107]
ds_read_b128 v[108:111], v15 offset:36864
ds_read_b128 v[116:119], v18 offset:36864
buffer_load_dwordx4 v2, s[32:35], s49 offen offset:3072 sc1 lds
v_fmac_f32 v44, v24, v76
v_fmac_f32 v45, v24, v77
v_fmac_f32 v46, v24, v78
v_fmac_f32 v47, v24, v79
s_waitcnt lgkmcnt(0)
v_mfma_f32_32x32x16_bf16 v[92:107], v[108:111], v[116:119], v[92:107]
ds_read_b128 v[112:115], v15 offset:37888
ds_read_b128 v[120:123], v18 offset:37888
s_add_u32 s49, s46, 45056
s_add_u32 m0, s48, 4096
s_nop 0
buffer_load_dwordx4 v2, s[32:35], s49 offen offset:0 sc1 lds
v_fmac_f32 v48, v24, v80
v_fmac_f32 v49, v24, v81
v_fmac_f32 v50, v24, v82
v_fmac_f32 v51, v24, v83
s_waitcnt lgkmcnt(0)
v_mfma_f32_32x32x16_bf16 v[92:107], v[112:115], v[120:123], v[92:107]
ds_read_b128 v[108:111], v15 offset:38912
ds_read_b128 v[116:119], v18 offset:38912
buffer_load_dwordx4 v2, s[32:35], s49 offen offset:1024 sc1 lds
v_fmac_f32 v52, v24, v84
v_fmac_f32 v53, v24, v85
v_fmac_f32 v54, v24, v86
v_fmac_f32 v55, v24, v87
s_waitcnt lgkmcnt(0)
v_mfma_f32_32x32x16_bf16 v[92:107], v[108:111], v[116:119], v[92:107]
ds_read_b128 v[112:115], v15 offset:39936
ds_read_b128 v[120:123], v18 offset:39936
buffer_load_dwordx4 v2, s[32:35], s49 offen offset:2048 sc1 lds
v_fmac_f32 v56, v24, v88
v_fmac_f32 v57, v24, v89
v_fmac_f32 v58, v24, v90
v_fmac_f32 v59, v24, v91
s_waitcnt lgkmcnt(0)
v_mfma_f32_32x32x16_bf16 v[92:107], v[112:115], v[120:123], v[92:107]
s_waitcnt vmcnt(7)
s_barrier
ds_read_b128 v[108:111], v16 offset:0
ds_read_b128 v[116:119], v19 offset:0
buffer_load_dwordx4 v2, s[32:35], s49 offen offset:3072 sc1 lds
s_waitcnt lgkmcnt(0)
v_mfma_f32_32x32x16_bf16 v[76:91], v[108:111], v[116:119], 0
ds_read_b128 v[112:115], v16 offset:1024
ds_read_b128 v[120:123], v19 offset:1024
s_add_u32 s49, s46, 49152
s_add_u32 m0, s48, 32768
s_nop 0
buffer_load_dwordx4 v2, s[32:35], s49 offen offset:0 sc1 lds
buffer_load_dword v13, v12, s[32:35], 0 offen sc1
s_waitcnt lgkmcnt(0)
v_mfma_f32_32x32x16_bf16 v[76:91], v[112:115], v[120:123], v[76:91]
ds_read_b128 v[108:111], v16 offset:2048
ds_read_b128 v[116:119], v19 offset:2048
buffer_load_dwordx4 v2, s[32:35], s49 offen offset:1024 sc1 lds
s_waitcnt lgkmcnt(0)
v_mfma_f32_32x32x16_bf16 v[76:91], v[108:111], v[116:119], v[76:91]
ds_read_b128 v[112:115], v16 offset:3072
ds_read_b128 v[120:123], v19 offset:3072
buffer_load_dwordx4 v2, s[32:35], s49 offen offset:2048 sc1 lds
s_waitcnt lgkmcnt(0)
v_mfma_f32_32x32x16_bf16 v[76:91], v[112:115], v[120:123], v[76:91]
ds_read_b128 v[108:111], v16 offset:4096
ds_read_b128 v[116:119], v19 offset:4096
buffer_load_dwordx4 v2, s[32:35], s49 offen offset:3072 sc1 lds
v_fmac_f32 v44, v26, v92
v_fmac_f32 v45, v26, v93
v_fmac_f32 v46, v26, v94
v_fmac_f32 v47, v26, v95
s_waitcnt lgkmcnt(0)
v_mfma_f32_32x32x16_bf16 v[76:91], v[108:111], v[116:119], v[76:91]
ds_read_b128 v[112:115], v16 offset:5120
ds_read_b128 v[120:123], v19 offset:5120
s_add_u32 s49, s46, 53248
s_add_u32 m0, s48, 36864
s_nop 0
buffer_load_dwordx4 v2, s[32:35], s49 offen offset:0 sc1 lds
v_fmac_f32 v48, v26, v96
v_fmac_f32 v49, v26, v97
v_fmac_f32 v50, v26, v98
v_fmac_f32 v51, v26, v99
s_waitcnt lgkmcnt(0)
v_mfma_f32_32x32x16_bf16 v[76:91], v[112:115], v[120:123], v[76:91]
ds_read_b128 v[108:111], v16 offset:6144
ds_read_b128 v[116:119], v19 offset:6144
buffer_load_dwordx4 v2, s[32:35], s49 offen offset:1024 sc1 lds
v_fmac_f32 v52, v26, v100
v_fmac_f32 v53, v26, v101
v_fmac_f32 v54, v26, v102
v_fmac_f32 v55, v26, v103
s_waitcnt lgkmcnt(0)
v_mfma_f32_32x32x16_bf16 v[76:91], v[108:111], v[116:119], v[76:91]
ds_read_b128 v[112:115], v16 offset:7168
ds_read_b128 v[120:123], v19 offset:7168
buffer_load_dwordx4 v2, s[32:35], s49 offen offset:2048 sc1 lds
v_fmac_f32 v56, v26, v104
v_fmac_f32 v57, v26, v105
v_fmac_f32 v58, v26, v106
v_fmac_f32 v59, v26, v107
s_waitcnt lgkmcnt(0)
v_mfma_f32_32x32x16_bf16 v[76:91], v[112:115], v[120:123], v[76:91]
s_waitcnt vmcnt(8)
s_barrier
ds_read_b128 v[108:111], v14 offset:0
ds_read_b128 v[116:119], v17 offset:0
buffer_load_dwordx4 v2, s[32:35], s49 offen offset:3072 sc1 lds
s_waitcnt lgkmcnt(0)
v_mfma_f32_32x32x16_bf16 v[92:107], v[108:111], v[116:119], 0
ds_read_b128 v[112:115], v14 offset:1024
ds_read_b128 v[120:123], v17 offset:1024
s_add_u32 s49, s46, 57344
s_add_u32 m0, s48, 65536
s_nop 0
buffer_load_dwordx4 v2, s[32:35], s49 offen offset:0 sc1 lds
s_waitcnt lgkmcnt(0)
v_mfma_f32_32x32x16_bf16 v[92:107], v[112:115], v[120:123], v[92:107]
ds_read_b128 v[108:111], v14 offset:2048
ds_read_b128 v[116:119], v17 offset:2048
buffer_load_dwordx4 v2, s[32:35], s49 offen offset:1024 sc1 lds
s_waitcnt lgkmcnt(0)
v_mfma_f32_32x32x16_bf16 v[92:107], v[108:111], v[116:119], v[92:107]
ds_read_b128 v[112:115], v14 offset:3072
ds_read_b128 v[120:123], v17 offset:3072
buffer_load_dwordx4 v2, s[32:35], s49 offen offset:2048 sc1 lds
s_waitcnt lgkmcnt(0)
v_mfma_f32_32x32x16_bf16 v[92:107], v[112:115], v[120:123], v[92:107]
ds_read_b128 v[108:111], v14 offset:4096
ds_read_b128 v[116:119], v17 offset:4096
buffer_load_dwordx4 v2, s[32:35], s49 offen offset:3072 sc1 lds
v_fmac_f32 v44, v28, v76
v_fmac_f32 v45, v28, v77
v_fmac_f32 v46, v28, v78
v_fmac_f32 v47, v28, v79
s_waitcnt lgkmcnt(0)
v_mfma_f32_32x32x16_bf16 v[92:107], v[108:111], v[116:119], v[92:107]
ds_read_b128 v[112:115], v14 offset:5120
ds_read_b128 v[120:123], v17 offset:5120
s_add_u32 s49, s46, 61440
s_add_u32 m0, s48, 69632
s_nop 0
buffer_load_dwordx4 v2, s[32:35], s49 offen offset:0 sc1 lds
v_fmac_f32 v48, v28, v80
v_fmac_f32 v49, v28, v81
v_fmac_f32 v50, v28, v82
v_fmac_f32 v51, v28, v83
s_waitcnt lgkmcnt(0)
v_mfma_f32_32x32x16_bf16 v[92:107], v[112:115], v[120:123], v[92:107]
ds_read_b128 v[108:111], v14 offset:6144
ds_read_b128 v[116:119], v17 offset:6144
buffer_load_dwordx4 v2, s[32:35], s49 offen offset:1024 sc1 lds
v_fmac_f32 v52, v28, v84
v_fmac_f32 v53, v28, v85
v_fmac_f32 v54, v28, v86
v_fmac_f32 v55, v28, v87
s_waitcnt lgkmcnt(0)
v_mfma_f32_32x32x16_bf16 v[92:107], v[108:111], v[116:119], v[92:107]
ds_read_b128 v[112:115], v14 offset:7168
ds_read_b128 v[120:123], v17 offset:7168
buffer_load_dwordx4 v2, s[32:35], s49 offen offset:2048 sc1 lds
v_fmac_f32 v56, v28, v88
v_fmac_f32 v57, v28, v89
v_fmac_f32 v58, v28, v90
v_fmac_f32 v59, v28, v91
s_waitcnt lgkmcnt(0)
v_mfma_f32_32x32x16_bf16 v[92:107], v[112:115], v[120:123], v[92:107]
s_waitcnt vmcnt(7)
s_barrier
ds_read_b128 v[108:111], v14 offset:32768
ds_read_b128 v[116:119], v17 offset:32768
buffer_load_dwordx4 v2, s[32:35], s49 offen offset:3072 sc1 lds
s_waitcnt vmcnt(15)
v_cmp_eq_u32 vcc, 1, v13
s_nop 4
s_and_b32 vcc_lo, vcc_lo, 0x3f
s_cmp_eq_u32 vcc_lo, 0x3f
s_cbranch_scc1 L_p2_pollokc_24
s_mov_b32 s60, 0x100000
L_p2_pollc_23:
buffer_load_dword v13, v12, s[32:35], 0 offen sc1
s_waitcnt vmcnt(0)
v_cmp_eq_u32 vcc, 1, v13
s_nop 4
s_and_b32 vcc_lo, vcc_lo, 0x3f
s_cmp_eq_u32 vcc_lo, 0x3f
s_cbranch_scc1 L_p2_pollokc_24
s_sub_u32 s60, s60, 1
s_cmp_eq_u32 s60, 0
s_cbranch_scc1 L_p2_pollokc_24
s_sleep 2
s_branch L_p2_pollc_23
L_p2_pollokc_24:
s_waitcnt lgkmcnt(0)
v_mfma_f32_32x32x16_bf16 v[76:91], v[108:111], v[116:119], 0
ds_read_b128 v[112:115], v14 offset:33792
ds_read_b128 v[120:123], v17 offset:33792
s_add_u32 s49, s47, 0
s_add_u32 m0, s48, 98304
s_nop 0
buffer_load_dwordx4 v2, s[32:35], s49 offen offset:0 sc1 lds
s_waitcnt lgkmcnt(0)
v_mfma_f32_32x32x16_bf16 v[76:91], v[112:115], v[120:123], v[76:91]
ds_read_b128 v[108:111], v14 offset:34816
ds_read_b128 v[116:119], v17 offset:34816
buffer_load_dwordx4 v2, s[32:35], s49 offen offset:1024 sc1 lds
s_waitcnt lgkmcnt(0)
v_mfma_f32_32x32x16_bf16 v[76:91], v[108:111], v[116:119], v[76:91]
ds_read_b128 v[112:115], v14 offset:35840
ds_read_b128 v[120:123], v17 offset:35840
buffer_load_dwordx4 v2, s[32:35], s49 offen offset:2048 sc1 lds
s_waitcnt lgkmcnt(0)
v_mfma_f32_32x32x16_bf16 v[76:91], v[112:115], v[120:123], v[76:91]
ds_read_b128 v[108:111], v14 offset:36864
ds_read_b128 v[116:119], v17 offset:36864
buffer_load_dwordx4 v2, s[32:35], s49 offen offset:3072 sc1 lds
v_fmac_f32 v44, v30, v92
v_fmac_f32 v45, v30, v93
v_fmac_f32 v46, v30, v94
v_fmac_f32 v47, v30, v95
s_waitcnt lgkmcnt(0)
v_mfma_f32_32x32x16_bf16 v[76:91], v[108:111], v[116:119], v[76:91]
ds_read_b128 v[112:115], v14 offset:37888
ds_read_b128 v[120:123], v17 offset:37888
s_add_u32 s49, s47, 4096
s_add_u32 m0, s48, 102400
s_nop 0
buffer_load_dwordx4 v2, s[32:35], s49 offen offset:0 sc1 lds
v_fmac_f32 v48, v30, v96
v_fmac_f32 v49, v30, v97
v_fmac_f32 v50, v30, v98
v_fmac_f32 v51, v30, v99
s_waitcnt lgkmcnt(0)
v_mfma_f32_32x32x16_bf16 v[76:91], v[112:115], v[120:123], v[76:91]
ds_read_b128 v[108:111], v14 offset:38912
ds_read_b128 v[116:119], v17 offset:38912
buffer_load_dwordx4 v2, s[32:35], s49 offen offset:1024 sc1 lds
v_fmac_f32 v52, v30, v100
v_fmac_f32 v53, v30, v101
v_fmac_f32 v54, v30, v102
v_fmac_f32 v55, v30, v103
s_waitcnt lgkmcnt(0)
v_mfma_f32_32x32x16_bf16 v[76:91], v[108:111], v[116:119], v[76:91]
ds_read_b128 v[112:115], v14 offset:39936
ds_read_b128 v[120:123], v17 offset:39936
buffer_load_dwordx4 v2, s[32:35], s49 offen offset:2048 sc1 lds
v_fmac_f32 v56, v30, v104
v_fmac_f32 v57, v30, v105
v_fmac_f32 v58, v30, v106
v_fmac_f32 v59, v30, v107
s_waitcnt lgkmcnt(0)
v_mfma_f32_32x32x16_bf16 v[76:91], v[112:115], v[120:123], v[76:91]
s_waitcnt vmcnt(7)
s_barrier
ds_read_b128 v[108:111], v15 offset:0
ds_read_b128 v[116:119], v18 offset:0
buffer_load_dwordx4 v2, s[32:35], s49 offen offset:3072 sc1 lds
s_waitcnt lgkmcnt(0)
v_mfma_f32_32x32x16_bf16 v[92:107], v[108:111], v[116:119], 0
ds_read_b128 v[112:115], v15 offset:1024
ds_read_b128 v[120:123], v18 offset:1024
s_add_u32 s49, s47, 8192
s_add_u32 m0, s48, 131072
s_nop 0
buffer_load_dwordx4 v2, s[32:35], s49 offen offset:0 sc1 lds
s_waitcnt lgkmcnt(0)
v_mfma_f32_32x32x16_bf16 v[92:107], v[112:115], v[120:123], v[92:107]
ds_read_b128 v[108:111], v15 offset:2048
ds_read_b128 v[116:119], v18 offset:2048
buffer_load_dwordx4 v2, s[32:35], s49 offen offset:1024 sc1 lds
s_waitcnt lgkmcnt(0)
v_mfma_f32_32x32x16_bf16 v[92:107], v[108:111], v[116:119], v[92:107]
ds_read_b128 v[112:115], v15 offset:3072
ds_read_b128 v[120:123], v18 offset:3072
buffer_load_dwordx4 v2, s[32:35], s49 offen offset:2048 sc1 lds
s_waitcnt lgkmcnt(0)
v_mfma_f32_32x32x16_bf16 v[92:107], v[112:115], v[120:123], v[92:107]
ds_read_b128 v[108:111], v15 offset:4096
ds_read_b128 v[116:119], v18 offset:4096
buffer_load_dwordx4 v2, s[32:35], s49 offen offset:3072 sc1 lds
v_fmac_f32 v44, v32, v76
v_fmac_f32 v45, v32, v77
v_fmac_f32 v46, v32, v78
v_fmac_f32 v47, v32, v79
s_waitcnt lgkmcnt(0)
v_mfma_f32_32x32x16_bf16 v[92:107], v[108:111], v[116:119], v[92:107]
ds_read_b128 v[112:115], v15 offset:5120
ds_read_b128 v[120:123], v18 offset:5120
s_add_u32 s49, s47, 12288
s_add_u32 m0, s48, 135168
s_nop 0
buffer_load_dwordx4 v2, s[32:35], s49 offen offset:0 sc1 lds
v_fmac_f32 v48, v32, v80
v_fmac_f32 v49, v32, v81
v_fmac_f32 v50, v32, v82
v_fmac_f32 v51, v32, v83
s_waitcnt lgkmcnt(0)
v_mfma_f32_32x32x16_bf16 v[92:107], v[112:115], v[120:123], v[92:107]
ds_read_b128 v[108:111], v15 offset:6144
ds_read_b128 v[116:119], v18 offset:6144
buffer_load_dwordx4 v2, s[32:35], s49 offen offset:1024 sc1 lds
v_fmac_f32 v52, v32, v84
v_fmac_f32 v53, v32, v85
v_fmac_f32 v54, v32, v86
v_fmac_f32 v55, v32, v87
s_waitcnt lgkmcnt(0)
v_mfma_f32_32x32x16_bf16 v[92:107], v[108:111], v[116:119], v[92:107]
ds_read_b128 v[112:115], v15 offset:7168
ds_read_b128 v[120:123], v18 offset:7168
buffer_load_dwordx4 v2, s[32:35], s49 offen offset:2048 sc1 lds
v_fmac_f32 v56, v32, v88
v_fmac_f32 v57, v32, v89
v_fmac_f32 v58, v32, v90
v_fmac_f32 v59, v32, v91
s_waitcnt lgkmcnt(0)
v_mfma_f32_32x32x16_bf16 v[92:107], v[112:115], v[120:123], v[92:107]
s_waitcnt vmcnt(7)
s_barrier
ds_read_b128 v[108:111], v15 offset:32768
ds_read_b128 v[116:119], v18 offset:32768
buffer_load_dwordx4 v2, s[32:35], s49 offen offset:3072 sc1 lds
s_waitcnt lgkmcnt(0)
v_mfma_f32_32x32x16_bf16 v[60:75], v[108:111], v[116:119], 0
ds_read_b128 v[112:115], v15 offset:33792
ds_read_b128 v[120:123], v18 offset:33792
s_add_u32 s49, s47, 16384
s_add_u32 m0, s48, 0
s_nop 0
buffer_load_dwordx4 v2, s[32:35], s49 offen offset:0 sc1 lds
s_waitcnt lgkmcnt(0)
v_mfma_f32_32x32x16_bf16 v[60:75], v[112:115], v[120:123], v[60:75]
ds_read_b128 v[108:111], v15 offset:34816
ds_read_b128 v[116:119], v18 offset:34816
buffer_load_dwordx4 v2, s[32:35], s49 offen offset:1024 sc1 lds
s_waitcnt lgkmcnt(0)
v_mfma_f32_32x32x16_bf16 v[60:75], v[108:111], v[116:119], v[60:75]
ds_read_b128 v[112:115], v15 offset:35840
ds_read_b128 v[120:123], v18 offset:35840
buffer_load_dwordx4 v2, s[32:35], s49 offen offset:2048 sc1 lds
s_waitcnt lgkmcnt(0)
v_mfma_f32_32x32x16_bf16 v[60:75], v[112:115], v[120:123], v[60:75]
ds_read_b128 v[108:111], v15 offset:36864
ds_read_b128 v[116:119], v18 offset:36864
buffer_load_dwordx4 v2, s[32:35], s49 offen offset:3072 sc1 lds
v_fmac_f32 v44, v34, v92
v_fmac_f32 v45, v34, v93
v_fmac_f32 v46, v34, v94
v_fmac_f32 v47, v34, v95
s_waitcnt lgkmcnt(0)
v_mfma_f32_32x32x16_bf16 v[60:75], v[108:111], v[116:119], v[60:75]
ds_read_b128 v[112:115], v15 offset:37888
ds_read_b128 v[120:123], v18 offset:37888
s_add_u32 s49, s47, 20480
s_add_u32 m0, s48, 4096
s_nop 0
buffer_load_dwordx4 v2, s[32:35], s49 offen offset:0 sc1 lds
v_fmac_f32 v48, v34, v96
v_fmac_f32 v49, v34, v97
v_fmac_f32 v50, v34, v98
v_fmac_f32 v51, v34, v99
s_waitcnt lgkmcnt(0)
v_mfma_f32_32x32x16_bf16 v[60:75], v[112:115], v[120:123], v[60:75]
ds_read_b128 v[108:111], v15 offset:38912
ds_read_b128 v[116:119], v18 offset:38912
buffer_load_dwordx4 v2, s[32:35], s49 offen offset:1024 sc1 lds
v_fmac_f32 v52, v34, v100
v_fmac_f32 v53, v34, v101
v_fmac_f32 v54, v34, v102
v_fmac_f32 v55, v34, v103
s_waitcnt lgkmcnt(0)
v_mfma_f32_32x32x16_bf16 v[60:75], v[108:111], v[116:119], v[60:75]
ds_read_b128 v[112:115], v15 offset:39936
ds_read_b128 v[120:123], v18 offset:39936
buffer_load_dwordx4 v2, s[32:35], s49 offen offset:2048 sc1 lds
v_fmac_f32 v56, v34, v104
v_fmac_f32 v57, v34, v105
v_fmac_f32 v58, v34, v106
v_fmac_f32 v59, v34, v107
s_waitcnt lgkmcnt(0)
v_mfma_f32_32x32x16_bf16 v[60:75], v[112:115], v[120:123], v[60:75]
s_waitcnt vmcnt(7)
s_barrier
ds_read_b128 v[108:111], v16 offset:0
ds_read_b128 v[116:119], v19 offset:0
buffer_load_dwordx4 v2, s[32:35], s49 offen offset:3072 sc1 lds
s_waitcnt lgkmcnt(0)
v_mfma_f32_32x32x16_bf16 v[60:75], v[108:111], v[116:119], v[60:75]
ds_read_b128 v[112:115], v16 offset:1024
ds_read_b128 v[120:123], v19 offset:1024
s_add_u32 s49, s47, 24576
s_add_u32 m0, s48, 32768
s_nop 0
buffer_load_dwordx4 v2, s[32:35], s49 offen offset:0 sc1 lds
s_waitcnt lgkmcnt(0)
v_mfma_f32_32x32x16_bf16 v[60:75], v[112:115], v[120:123], v[60:75]
ds_read_b128 v[108:111], v16 offset:2048
ds_read_b128 v[116:119], v19 offset:2048
buffer_load_dwordx4 v2, s[32:35], s49 offen offset:1024 sc1 lds
s_waitcnt lgkmcnt(0)
v_mfma_f32_32x32x16_bf16 v[60:75], v[108:111], v[116:119], v[60:75]
ds_read_b128 v[112:115], v16 offset:3072
ds_read_b128 v[120:123], v19 offset:3072
buffer_load_dwordx4 v2, s[32:35], s49 offen offset:2048 sc1 lds
s_waitcnt lgkmcnt(0)
v_mfma_f32_32x32x16_bf16 v[60:75], v[112:115], v[120:123], v[60:75]
ds_read_b128 v[108:111], v16 offset:4096
ds_read_b128 v[116:119], v19 offset:4096
buffer_load_dwordx4 v2, s[32:35], s49 offen offset:3072 sc1 lds
s_waitcnt lgkmcnt(0)
v_mfma_f32_32x32x16_bf16 v[60:75], v[108:111], v[116:119], v[60:75]
ds_read_b128 v[112:115], v16 offset:5120
ds_read_b128 v[120:123], v19 offset:5120
s_add_u32 s49, s47, 28672
s_add_u32 m0, s48, 36864
s_nop 0
buffer_load_dwordx4 v2, s[32:35], s49 offen offset:0 sc1 lds
s_waitcnt lgkmcnt(0)
v_mfma_f32_32x32x16_bf16 v[60:75], v[112:115], v[120:123], v[60:75]
ds_read_b128 v[108:111], v16 offset:6144
ds_read_b128 v[116:119], v19 offset:6144
buffer_load_dwordx4 v2, s[32:35], s49 offen offset:1024 sc1 lds
s_waitcnt lgkmcnt(0)
v_mfma_f32_32x32x16_bf16 v[60:75], v[108:111], v[116:119], v[60:75]
ds_read_b128 v[112:115], v16 offset:7168
ds_read_b128 v[120:123], v19 offset:7168
buffer_load_dwordx4 v2, s[32:35], s49 offen offset:2048 sc1 lds
s_waitcnt lgkmcnt(0)
v_mfma_f32_32x32x16_bf16 v[60:75], v[112:115], v[120:123], v[60:75]
s_waitcnt vmcnt(7)
s_barrier
ds_read_b128 v[108:111], v14 offset:0
ds_read_b128 v[116:119], v17 offset:0
buffer_load_dwordx4 v2, s[32:35], s49 offen offset:3072 sc1 lds
s_waitcnt lgkmcnt(0)
v_mfma_f32_32x32x16_bf16 v[60:75], v[108:111], v[116:119], v[60:75]
ds_read_b128 v[112:115], v14 offset:1024
ds_read_b128 v[120:123], v17 offset:1024
buffer_load_dwordx2 v[36:37], v7, s[36:39], 0 offen offset:0
s_waitcnt lgkmcnt(0)
v_mfma_f32_32x32x16_bf16 v[60:75], v[112:115], v[120:123], v[60:75]
ds_read_b128 v[108:111], v14 offset:2048
ds_read_b128 v[116:119], v17 offset:2048
buffer_load_dwordx2 v[38:39], v7, s[36:39], 0 offen offset:16
s_waitcnt lgkmcnt(0)
v_mfma_f32_32x32x16_bf16 v[60:75], v[108:111], v[116:119], v[60:75]
ds_read_b128 v[112:115], v14 offset:3072
ds_read_b128 v[120:123], v17 offset:3072
buffer_load_dwordx2 v[40:41], v7, s[36:39], 0 offen offset:32
s_waitcnt lgkmcnt(0)
v_mfma_f32_32x32x16_bf16 v[60:75], v[112:115], v[120:123], v[60:75]
ds_read_b128 v[108:111], v14 offset:4096
ds_read_b128 v[116:119], v17 offset:4096
buffer_load_dwordx2 v[42:43], v7, s[36:39], 0 offen offset:48
s_waitcnt lgkmcnt(0)
v_mfma_f32_32x32x16_bf16 v[60:75], v[108:111], v[116:119], v[60:75]
ds_read_b128 v[112:115], v14 offset:5120
ds_read_b128 v[120:123], v17 offset:5120
s_waitcnt lgkmcnt(0)
v_mfma_f32_32x32x16_bf16 v[60:75], v[112:115], v[120:123], v[60:75]
ds_read_b128 v[108:111], v14 offset:6144
ds_read_b128 v[116:119], v17 offset:6144
s_waitcnt lgkmcnt(0)
v_mfma_f32_32x32x16_bf16 v[60:75], v[108:111], v[116:119], v[60:75]
ds_read_b128 v[112:115], v14 offset:7168
ds_read_b128 v[120:123], v17 offset:7168
s_waitcnt lgkmcnt(0)
v_mfma_f32_32x32x16_bf16 v[60:75], v[112:115], v[120:123], v[60:75]
s_waitcnt vmcnt(4)
s_barrier
ds_read_b128 v[108:111], v14 offset:32768
ds_read_b128 v[116:119], v17 offset:32768
s_waitcnt lgkmcnt(0)
v_mfma_f32_32x32x16_bf16 v[60:75], v[108:111], v[116:119], v[60:75]
ds_read_b128 v[112:115], v14 offset:33792
ds_read_b128 v[120:123], v17 offset:33792
s_waitcnt lgkmcnt(0)
v_mfma_f32_32x32x16_bf16 v[60:75], v[112:115], v[120:123], v[60:75]
ds_read_b128 v[108:111], v14 offset:34816
ds_read_b128 v[116:119], v17 offset:34816
s_waitcnt lgkmcnt(0)
v_mfma_f32_32x32x16_bf16 v[60:75], v[108:111], v[116:119], v[60:75]
ds_read_b128 v[112:115], v14 offset:35840
ds_read_b128 v[120:123], v17 offset:35840
s_waitcnt lgkmcnt(0)
v_mfma_f32_32x32x16_bf16 v[60:75], v[112:115], v[120:123], v[60:75]
ds_read_b128 v[108:111], v14 offset:36864
ds_read_b128 v[116:119], v17 offset:36864
s_waitcnt lgkmcnt(0)
v_mfma_f32_32x32x16_bf16 v[60:75], v[108:111], v[116:119], v[60:75]
ds_read_b128 v[112:115], v14 offset:37888
ds_read_b128 v[120:123], v17 offset:37888
s_waitcnt lgkmcnt(0)
v_mfma_f32_32x32x16_bf16 v[60:75], v[112:115], v[120:123], v[60:75]
ds_read_b128 v[108:111], v14 offset:38912
ds_read_b128 v[116:119], v17 offset:38912
s_waitcnt lgkmcnt(0)
v_mfma_f32_32x32x16_bf16 v[60:75], v[108:111], v[116:119], v[60:75]
ds_read_b128 v[112:115], v14 offset:39936
ds_read_b128 v[120:123], v17 offset:39936
s_waitcnt lgkmcnt(0)
v_mfma_f32_32x32x16_bf16 v[60:75], v[112:115], v[120:123], v[60:75]
s_waitcnt vmcnt(0)
v_lshlrev_b32 v132, 16, v36
v_and_b32 v133, 0xffff0000, v36
v_lshlrev_b32 v134, 16, v37
v_and_b32 v135, 0xffff0000, v37
v_lshlrev_b32 v136, 16, v38
v_and_b32 v137, 0xffff0000, v38
v_lshlrev_b32 v138, 16, v39
v_and_b32 v139, 0xffff0000, v39
v_lshlrev_b32 v140, 16, v40
v_and_b32 v141, 0xffff0000, v40
v_lshlrev_b32 v142, 16, v41
v_and_b32 v143, 0xffff0000, v41
v_lshlrev_b32 v144, 16, v42
v_and_b32 v145, 0xffff0000, v42
v_lshlrev_b32 v146, 16, v43
v_and_b32 v147, 0xffff0000, v43
v_pk_add_f32 v[132:133], v[132:133], v[44:45]
v_pk_add_f32 v[134:135], v[134:135], v[46:47]
v_pk_add_f32 v[136:137], v[136:137], v[48:49]
v_pk_add_f32 v[138:139], v[138:139], v[50:51]
v_pk_add_f32 v[140:141], v[140:141], v[52:53]
v_pk_add_f32 v[142:143], v[142:143], v[54:55]
v_pk_add_f32 v[144:145], v[144:145], v[56:57]
v_pk_add_f32 v[146:147], v[146:147], v[58:59]
v_pk_add_f32 v[132:133], v[132:133], v[60:61]
v_pk_add_f32 v[134:135], v[134:135], v[62:63]
v_pk_add_f32 v[136:137], v[136:137], v[64:65]
v_pk_add_f32 v[138:139], v[138:139], v[66:67]
v_pk_add_f32 v[140:141], v[140:141], v[68:69]
v_pk_add_f32 v[142:143], v[142:143], v[70:71]
v_pk_add_f32 v[144:145], v[144:145], v[72:73]
v_pk_add_f32 v[146:147], v[146:147], v[74:75]
v_cvt_pk_bf16_f32 v124, v132, v133
v_cvt_pk_bf16_f32 v125, v134, v135
v_cvt_pk_bf16_f32 v126, v136, v137
v_cvt_pk_bf16_f32 v127, v138, v139
v_cvt_pk_bf16_f32 v128, v140, v141
v_cvt_pk_bf16_f32 v129, v142, v143
v_cvt_pk_bf16_f32 v130, v144, v145
v_cvt_pk_bf16_f32 v131, v146, v147
v_permlane32_swap_b32 v124, v126
v_permlane32_swap_b32 v125, v127
v_permlane32_swap_b32 v128, v130
v_permlane32_swap_b32 v129, v131
buffer_store_dwordx4 v[124:127], v8, s[40:43], 0 offen offset:0
buffer_store_dwordx4 v[128:131], v8, s[40:43], 0 offen offset:32
L_EXIT_p3:
s_waitcnt vmcnt(0)
s_endpgm
L_EXIT_p2:
s_waitcnt vmcnt(0)
s_endpgm
.section .rodata,"a"
.p2align 6
.amdhsa_kernel standalone__conformer_family_branchformer__speech_kernel
  .amdhsa_next_free_vgpr 384
  .amdhsa_next_free_sgpr 102
  .amdhsa_accum_offset 256
  .amdhsa_group_segment_fixed_size 0
  .amdhsa_kernarg_size 96
  .amdhsa_user_sgpr_count 2
  .amdhsa_user_sgpr_kernarg_segment_ptr 1
  .amdhsa_system_sgpr_workgroup_id_x 1
  .amdhsa_float_denorm_mode_32 3
.end_amdhsa_kernel
.text
```
